```python
import torch

def _softmax(x, axis=-1):
    return torch.softmax(x, dim=axis)
def _gelu(x):
    return torch.nn.functional.gelu(x, approximate="tanh")
def _silu(x):
    return torch.nn.functional.silu(x)
def _sigmoid(x):
    return torch.sigmoid(x)
def _layernorm(x, axis=-1, eps=1e-5):
    m = x.mean(dim=axis, keepdim=True)
    v = x.var(dim=axis, keepdim=True, unbiased=False)
    return (x - m) / torch.sqrt(v + eps)
def _scatter_add(tgt, idx, src, axis=0):
    return tgt.clone().index_add_(axis, idx, src)
def _segment_sum(src, seg, n):
    out = torch.zeros((n,) + src.shape[1:], dtype=src.dtype)
    return out.index_add_(0, seg, src)
def _pad(x, pw):
    flat = tuple(v for pair in reversed(pw) for v in pair)
    return torch.nn.functional.pad(x, flat)

kernel_name = 'concat_heads__mha_block_cached__gqa_block_cached__near_ridge'

def setup_inputs():

    _w = (lambda a: (lambda t: t.to(torch.bfloat16) if t.is_floating_point() else t)(torch.as_tensor(a)))
    def _A_setup():
        B, Sq, D = 8, 96, 576
        H, Sk, Dh = 32, 1024, 128
        return {
            "x": _w((lambda *s: torch.randn(*s, dtype=torch.bfloat16) * 0.8)(B, Sq, D)),
            "k_cache": _w((lambda *s: torch.randn(*s, dtype=torch.bfloat16) * 0.8)(B, H, Sk, Dh)),
            "v_cache": _w((lambda *s: torch.randn(*s, dtype=torch.bfloat16) * 0.05)(B, H, Sk, Dh)),
            "wq": _w((lambda *s: torch.randn(*s, dtype=torch.bfloat16) * 0.8)(D, H * Dh) * (D ** -0.5)),
            "wo": _w((lambda *s: torch.randn(*s, dtype=torch.bfloat16) * 0.05)(H * Dh, D) * ((H * Dh) ** -0.5)),
        }
    _A_in = _A_setup()

    def _B_setup():
        B, Sq, D = 8, 96, 576
        Hq, Hkv, Sk, Dh = 32, 32, 1024, 128
        assert Hq % Hkv == 0, (Hq, Hkv)
        return {
            "x": _w((lambda *s: torch.randn(*s, dtype=torch.bfloat16) * 0.8)(B, Sq, D)),
            "k_cache": _w((lambda *s: torch.randn(*s, dtype=torch.bfloat16) * 0.8)(B, Hkv, Sk, Dh)),
            "v_cache": _w((lambda *s: torch.randn(*s, dtype=torch.bfloat16) * 0.05)(B, Hkv, Sk, Dh)),
            "wq": _w((lambda *s: torch.randn(*s, dtype=torch.bfloat16) * 0.8)(D, Hq * Dh) * (D ** -0.5)),
            "wo": _w((lambda *s: torch.randn(*s, dtype=torch.bfloat16) * 0.05)(Hq * Dh, D) * ((Hq * Dh) ** -0.5)),
        }
    _B_in = _B_setup()

    return {
        "A_x": _A_in["x"],
        "A_k_cache": _A_in["k_cache"],
        "A_v_cache": _A_in["v_cache"],
        "A_wq": _A_in["wq"],
        "A_wo": _A_in["wo"],
        "B_x": _B_in["x"],
        "B_k_cache": _B_in["k_cache"],
        "B_v_cache": _B_in["v_cache"],
        "B_wq": _B_in["wq"],
        "B_wo": _B_in["wo"],
    }

def reference(A_x, A_k_cache, A_v_cache, A_wq, A_wo, B_x, B_k_cache, B_v_cache, B_wq, B_wo):
    def _A_ref(x, k_cache, v_cache, wq, wo):
        B, Sq, D = x.shape
        H, Dh = 32, 128
        q = (lambda x, *d: x.permute(*d))((x @ wq).reshape(B, Sq, H, Dh), 0, 2, 1, 3)
        scores = torch.einsum("bhqd,bhkd->bhqk", q, k_cache) * (Dh ** -0.5)
        p = _softmax(scores, axis=-1)
        o = torch.einsum("bhqk,bhkd->bhqd", p, v_cache)
        return (lambda x, *d: x.permute(*d))(o, 0, 2, 1, 3).reshape(B, Sq, H * Dh) @ wo

    def _B_ref(x, k_cache, v_cache, wq, wo):
        B, Sq, D = x.shape
        Hq, Dh = 32, 128
        Hkv = k_cache.shape[1]
        rep = Hq // Hkv
        q = (lambda x, *d: x.permute(*d))((x @ wq).reshape(B, Sq, Hq, Dh), 0, 2, 1, 3)
        k = (lambda x, n, axis: torch.repeat_interleave(x, n, dim=axis))(k_cache, rep, axis=1)
        v = (lambda x, n, axis: torch.repeat_interleave(x, n, dim=axis))(v_cache, rep, axis=1)
        scores = torch.einsum("bhqd,bhkd->bhqk", q, k) * (Dh ** -0.5)
        p = _softmax(scores, axis=-1)
        o = torch.einsum("bhqk,bhkd->bhqd", p, v)
        return (lambda x, *d: x.permute(*d))(o, 0, 2, 1, 3).reshape(B, Sq, Hq * Dh) @ wo

    a = _A_ref(A_x, A_k_cache, A_v_cache, A_wq, A_wo)
    b = _B_ref(B_x, B_k_cache, B_v_cache, B_wq, B_wo)
    return torch.concatenate([a, b], axis=-1)
```

```asm
; @launch grid=(256,1,1) block=(256,1,1) lds=163840
.amdgcn_target "amdgcn-amd-amdhsa--gfx950"
.text
.globl concat_heads__mha_block_cached__gqa_block_cached__near_ridge_kernel
.p2align 8
.type concat_heads__mha_block_cached__gqa_block_cached__near_ridge_kernel,@function
concat_heads__mha_block_cached__gqa_block_cached__near_ridge_kernel:
    s_load_dwordx8 s[56:63], s[0:1], 0
    s_load_dwordx8 s[64:71], s[0:1], 40
    s_load_dwordx2 s[72:73], s[0:1], 96
    s_load_dwordx2 s[40:41], s[0:1], 32
    s_load_dwordx2 s[42:43], s[0:1], 72
    s_load_dwordx4 s[44:47], s[0:1], 80
    s_memrealtime s[48:49]
    s_cmp_ge_u32 s2, 256
    s_cbranch_scc1 L_done
    v_lshrrev_b32 v1, 6, v0
    s_and_b32 s3, s2, 7
    s_lshr_b32 s29, s3, 2
    s_and_b32 s30, s3, 3
    v_readfirstlane_b32 s28, v1
    s_lshr_b32 s3, s2, 3
    s_lshr_b32 s31, s3, 2
    s_and_b32 s32, s3, 3
    v_and_b32 v1, 63, v0
    v_lshrrev_b32 v88, 4, v1
    v_and_b32 v89, 15, v1
    v_lshrrev_b32 v56, 3, v1
    v_and_b32 v57, 7, v1
    v_and_b32 v92, 1, v88
    v_lshlrev_b32 v59, 2, v92
    v_xor_b32 v59, v57, v59
    v_lshlrev_b32 v59, 4, v59
    v_lshl_add_u32 v72, v56, 13, v59
    v_mul_u32_u24 v60, 1152, v56
    v_xor_b32 v61, v57, v88
    s_and_b32 s6, s28, 1
    s_lshr_b32 s7, s28, 1
    s_lshl_b32 s3, s6, 2
    v_xor_b32 v61, s3, v61
    v_lshl_add_u32 v73, v61, 4, v60
    v_xor_b32 v61, 4, v61
    v_lshl_add_u32 v74, v61, 4, v60
    s_mul_i32 s37, s7, 49152
    s_lshl_b32 s3, s6, 13
    s_add_u32 s37, s37, s3
    s_lshl_b32 s33, s30, 3
    s_lshl_b32 s3, s32, 1
    s_add_u32 s33, s33, s3
    s_add_u32 s74, s3, s31
    s_lshl_b32 s52, s33, 8
    s_lshl_b32 s3, s28, 7
    s_add_u32 s52, s52, s3
    s_mul_i32 s53, s31, 110592
    s_mul_i32 s3, s28, 27648
    s_add_u32 s53, s53, s3
    s_mul_i32 s55, s28, 3072
    s_mov_b32 s18, 884736
    s_mov_b32 s19, 0x20000
    s_mov_b32 s22, 4718592
    s_mov_b32 s23, 0x20000
    s_add_u32 s74, s31, s32
    s_and_b32 s74, s74, 3
    s_mul_i32 s74, s74, 9
    s_lshr_b32 s74, s74, 2
    s_cmp_eq_u32 s29, 0
    s_waitcnt lgkmcnt(0)
    s_cselect_b32 s20, s62, s70
    s_cselect_b32 s21, s63, s71
    s_cselect_b32 s16, s56, s64
    s_cselect_b32 s17, s57, s65
    s_cselect_b32 s8, s58, s66
    s_cselect_b32 s9, s59, s67
    s_cselect_b32 s12, s60, s68
    s_cselect_b32 s13, s61, s69
    s_cselect_b32 s76, s40, s42
    s_cselect_b32 s77, s41, s43
    s_mov_b64 s[78:79], s[44:45]
    s_mov_b64 s[80:81], s[46:47]
    s_or_b32 s75, s48, 1
    v_mov_b32 v32, v72
    v_add_u32 v33, 64512, v72
    v_add_u32 v34, 129024, v72
    v_add_u32 v35, 193536, v72
    v_mov_b32 v36, v73
    v_add_u32 v37, 8192, v74
    v_add_u32 v38, 16384, v73
    s_lshl_b32 s4, s74, 19
    s_add_u32 s4, s4, s52
    s_lshl_b32 s5, s74, 7
    s_add_u32 s5, s5, s53
    s_sub_u32 s74, 9, s74
    s_mov_b32 s60, s76
    s_mov_b32 s61, s77
    s_mov_b32 s62, 4718592
    s_mov_b32 s63, 0x20000
    s_add_u32 m0, s37, 0
    s_nop 0
    buffer_load_dwordx4 v32, s[20:23], s4 offen offset:0 lds
    buffer_load_dwordx4 v33, s[20:23], s4 offen offset:1024 lds
    buffer_load_dwordx4 v34, s[20:23], s4 offen offset:2048 lds
    buffer_load_dwordx4 v35, s[20:23], s4 offen offset:3072 lds
    s_add_u32 m0, s37, 4096
    s_add_u32 s4, s4, 262144
    buffer_load_dwordx4 v32, s[20:23], s4 offen offset:0 lds
    buffer_load_dwordx4 v33, s[20:23], s4 offen offset:1024 lds
    buffer_load_dwordx4 v34, s[20:23], s4 offen offset:2048 lds
    buffer_load_dwordx4 v35, s[20:23], s4 offen offset:3072 lds
    s_add_u32 m0, s55, 98304
    s_add_u32 s4, s4, 262144
    buffer_load_dwordx4 v36, s[16:19], s5 offen offset:0 lds
    buffer_load_dwordx4 v37, s[16:19], s5 offen offset:1024 lds
    buffer_load_dwordx4 v38, s[16:19], s5 offen offset:2048 lds
    s_add_u32 s5, s5, 128
    s_sub_u32 s74, s74, 1
    s_cmp_lg_u32 s74, 0
    s_cbranch_scc1 L_nw0
    s_mov_b32 s4, s52
    s_mov_b32 s5, s53
L_nw0:
    s_mov_b32 s56, s80
    s_mov_b32 s57, s81
    s_mov_b32 s58, 256
    s_mov_b32 s59, 0x20000
    s_lshl_b32 s3, s2, 8
    v_add_u32 v106, s3, v0
    v_min_u32 v106, 1, v106
    v_lshlrev_b32 v106, 12, v106
    v_mov_b32 v107, s75
    buffer_store_dword v107, v106, s[56:59], 0 offen sc1
    s_add_u32 m0, s37, 16384
    s_nop 0
    buffer_load_dwordx4 v32, s[20:23], s4 offen offset:0 lds
    buffer_load_dwordx4 v33, s[20:23], s4 offen offset:1024 lds
    buffer_load_dwordx4 v34, s[20:23], s4 offen offset:2048 lds
    buffer_load_dwordx4 v35, s[20:23], s4 offen offset:3072 lds
    s_add_u32 m0, s37, 20480
    s_add_u32 s4, s4, 262144
    buffer_load_dwordx4 v32, s[20:23], s4 offen offset:0 lds
    buffer_load_dwordx4 v33, s[20:23], s4 offen offset:1024 lds
    buffer_load_dwordx4 v34, s[20:23], s4 offen offset:2048 lds
    buffer_load_dwordx4 v35, s[20:23], s4 offen offset:3072 lds
    s_add_u32 m0, s55, 110592
    s_add_u32 s4, s4, 262144
    buffer_load_dwordx4 v36, s[16:19], s5 offen offset:0 lds
    buffer_load_dwordx4 v37, s[16:19], s5 offen offset:1024 lds
    buffer_load_dwordx4 v38, s[16:19], s5 offen offset:2048 lds
    s_add_u32 s5, s5, 128
    s_sub_u32 s74, s74, 1
    s_cmp_lg_u32 s74, 0
    s_cbranch_scc1 L_nw1
    s_mov_b32 s4, s52
    s_mov_b32 s5, s53
L_nw1:
    s_mov_b32 s10, 67108864
    s_mov_b32 s11, 0x20000
    s_mov_b32 s14, 67108864
    s_mov_b32 s15, 0x20000
    s_mov_b32 s24, s72
    s_mov_b32 s25, s73
    s_mov_b32 s26, 289079296
    s_mov_b32 s27, 0x20000
    s_mov_b32 s60, s76
    s_mov_b32 s61, s77
    s_mov_b32 s62, 4718592
    s_mov_b32 s63, 0x20000
    v_lshrrev_b32 v90, 5, v1
    v_and_b32 v91, 31, v1
    v_lshrrev_b32 v81, 2, v89
    v_and_b32 v82, 3, v1
    v_lshl_add_u32 v59, v90, 3, v81
    v_lshlrev_b32 v59, 7, v59
    v_lshrrev_b32 v60, 1, v81
    v_lshl_add_u32 v59, v60, 6, v59
    v_lshl_add_u32 v59, v92, 5, v59
    v_lshl_add_u32 v59, v82, 3, v59
    v_add_u32 v76, s37, v59
    v_xor_b32 v77, 64, v76
    v_bfe_u32 v60, v1, 1, 3
    v_xor_b32 v60, v60, v90
    v_lshlrev_b32 v60, 4, v60
    v_lshl_add_u32 v60, v91, 7, v60
    v_add_u32 v64, 98304, v60
    v_xor_b32 v65, 32, v64
    v_xor_b32 v66, 64, v64
    v_xor_b32 v67, 96, v64
    s_lshl_b32 s3, s28, 2
    s_add_u32 s3, s3, 162816
    v_mov_b32 v109, s3
    v_xor_b32 v110, 4, v109
    v_mov_b32 v61, 0
    ds_write_b32 v109, v61
    ds_write_b32 v109, v61 offset:16
    s_mov_b32 s44, 0
    s_mov_b32 s45, 0
    v_lshlrev_b32 v49, 4, v1
    v_add_u32 v48, s37, v49
    s_add_u32 s3, s55, 98304
    v_add_u32 v49, s3, v49
    s_lshl_b32 s54, s28, 13
    s_add_u32 s54, s54, 126976
    s_waitcnt vmcnt(11) lgkmcnt(0)
    s_barrier
    ds_read_b64_tr_b16 v[208:209], v76 offset:0
    ds_read_b64_tr_b16 v[210:211], v76 offset:512
    ds_read_b64_tr_b16 v[212:213], v77 offset:0
    ds_read_b64_tr_b16 v[214:215], v77 offset:512
    ds_read_b128 v[216:219], v64 offset:0
    ds_read_b128 v[220:223], v64 offset:4096
    ds_read_b128 v[224:227], v64 offset:8192
    s_waitcnt lgkmcnt(0)
    v_mfma_f32_32x32x16_bf16 v[112:127], v[208:211], v[216:219], 0
    ds_read_b64_tr_b16 v[230:231], v76 offset:2560
    ds_read_b64_tr_b16 v[228:229], v76 offset:2048
    s_add_u32 m0, s37, 32768
    s_nop 0
    buffer_load_dwordx4 v32, s[20:23], s4 offen offset:0 lds
    v_mfma_f32_32x32x16_bf16 v[128:143], v[208:211], v[220:223], 0
    ds_read_b64_tr_b16 v[234:235], v77 offset:2560
    ds_read_b64_tr_b16 v[232:233], v77 offset:2048
    buffer_load_dwordx4 v33, s[20:23], s4 offen offset:1024 lds
    v_mfma_f32_32x32x16_bf16 v[144:159], v[208:211], v[224:227], 0
    ds_read_b128 v[236:239], v65 offset:0
    buffer_load_dwordx4 v34, s[20:23], s4 offen offset:2048 lds
    v_mfma_f32_32x32x16_bf16 v[160:175], v[212:215], v[216:219], 0
    ds_read_b128 v[240:243], v65 offset:4096
    buffer_load_dwordx4 v35, s[20:23], s4 offen offset:3072 lds
    v_mfma_f32_32x32x16_bf16 v[176:191], v[212:215], v[220:223], 0
    ds_read_b128 v[244:247], v65 offset:8192
    s_add_u32 m0, s37, 36864
    s_add_u32 s4, s4, 262144
    buffer_load_dwordx4 v32, s[20:23], s4 offen offset:0 lds
    v_mfma_f32_32x32x16_bf16 v[192:207], v[212:215], v[224:227], 0
    buffer_load_dwordx4 v33, s[20:23], s4 offen offset:1024 lds
    s_waitcnt lgkmcnt(0)
    v_mfma_f32_32x32x16_bf16 v[112:127], v[228:231], v[236:239], v[112:127]
    ds_read_b64_tr_b16 v[210:211], v76 offset:4608
    ds_read_b64_tr_b16 v[208:209], v76 offset:4096
    buffer_load_dwordx4 v34, s[20:23], s4 offen offset:2048 lds
    v_lshlrev_b32 v26, 8, v88
    v_mfma_f32_32x32x16_bf16 v[128:143], v[228:231], v[240:243], v[128:143]
    ds_read_b64_tr_b16 v[214:215], v77 offset:4608
    ds_read_b64_tr_b16 v[212:213], v77 offset:4096
    buffer_load_dwordx4 v35, s[20:23], s4 offen offset:3072 lds
    v_xor_b32 v27, v89, v88
    v_mfma_f32_32x32x16_bf16 v[144:159], v[228:231], v[244:247], v[144:159]
    ds_read_b128 v[216:219], v66 offset:0
    s_add_u32 m0, s55, 122880
    s_add_u32 s4, s4, 262144
    buffer_load_dwordx4 v36, s[16:19], s5 offen offset:0 lds
    v_mfma_f32_32x32x16_bf16 v[160:175], v[232:235], v[236:239], v[160:175]
    ds_read_b128 v[220:223], v66 offset:4096
    buffer_load_dwordx4 v37, s[16:19], s5 offen offset:1024 lds
    v_lshl_add_u32 v2, v27, 4, v26
    v_mfma_f32_32x32x16_bf16 v[176:191], v[232:235], v[240:243], v[176:191]
    ds_read_b128 v[224:227], v66 offset:8192
    buffer_load_dwordx4 v38, s[16:19], s5 offen offset:2048 lds
    s_add_u32 s5, s5, 128
    s_sub_u32 s74, s74, 1
    s_cmp_lg_u32 s74, 0
    s_cbranch_scc1 L_nw2
    s_mov_b32 s4, s52
    s_mov_b32 s5, s53
L_nw2:
    v_xor_b32 v3, 64, v2
    v_mfma_f32_32x32x16_bf16 v[192:207], v[232:235], v[244:247], v[192:207]
    v_xor_b32 v4, 128, v2
    s_waitcnt lgkmcnt(0)
    v_mfma_f32_32x32x16_bf16 v[112:127], v[208:211], v[216:219], v[112:127]
    ds_read_b64_tr_b16 v[230:231], v76 offset:6656
    ds_read_b64_tr_b16 v[228:229], v76 offset:6144
    buffer_load_dwordx4 a[0:3], v32, s[20:23], s4 offen offset:0
    v_xor_b32 v5, 192, v2
    v_mfma_f32_32x32x16_bf16 v[128:143], v[208:211], v[220:223], v[128:143]
    ds_read_b64_tr_b16 v[234:235], v77 offset:6656
    ds_read_b64_tr_b16 v[232:233], v77 offset:6144
    buffer_load_dwordx4 a[4:7], v33, s[20:23], s4 offen offset:1024
    v_lshlrev_b32 v27, 2, v88
    v_mfma_f32_32x32x16_bf16 v[144:159], v[208:211], v[224:227], v[144:159]
    ds_read_b128 v[236:239], v67 offset:0
    buffer_load_dwordx4 a[8:11], v34, s[20:23], s4 offen offset:2048
    v_mfma_f32_32x32x16_bf16 v[160:175], v[212:215], v[216:219], v[160:175]
    ds_read_b128 v[240:243], v67 offset:4096
    buffer_load_dwordx4 a[12:15], v35, s[20:23], s4 offen offset:3072
    v_xor_b32 v27, v89, v27
    v_mfma_f32_32x32x16_bf16 v[176:191], v[212:215], v[220:223], v[176:191]
    ds_read_b128 v[244:247], v67 offset:8192
    s_add_u32 s4, s4, 262144
    buffer_load_dwordx4 a[16:19], v32, s[20:23], s4 offen offset:0
    v_lshl_add_u32 v6, v27, 4, v26
    v_mfma_f32_32x32x16_bf16 v[192:207], v[212:215], v[224:227], v[192:207]
    buffer_load_dwordx4 a[20:23], v33, s[20:23], s4 offen offset:1024
    buffer_load_dwordx4 a[24:27], v34, s[20:23], s4 offen offset:2048
    s_lshl_b32 s3, s6, 13
    s_add_u32 s33, s33, s7
    s_waitcnt vmcnt(11) lgkmcnt(0)
    s_barrier
    v_mfma_f32_32x32x16_bf16 v[112:127], v[228:231], v[236:239], v[112:127]
    ds_read_b64_tr_b16 v[210:211], v76 offset:16896
    ds_read_b64_tr_b16 v[208:209], v76 offset:16384
    buffer_load_dwordx4 a[28:31], v35, s[20:23], s4 offen offset:3072
    s_lshl_b32 s34, s31, 5
    s_add_u32 s34, s34, s33
    v_mfma_f32_32x32x16_bf16 v[128:143], v[228:231], v[240:243], v[128:143]
    ds_read_b64_tr_b16 v[214:215], v77 offset:16896
    ds_read_b64_tr_b16 v[212:213], v77 offset:16384
    s_add_u32 s4, s4, 262144
    buffer_load_dwordx4 a[192:195], v36, s[16:19], s5 offen offset:0
    s_lshl_b32 s34, s34, 18
    v_mfma_f32_32x32x16_bf16 v[144:159], v[228:231], v[244:247], v[144:159]
    ds_read_b128 v[216:219], v64 offset:12288
    buffer_load_dwordx4 a[196:199], v37, s[16:19], s5 offen offset:1024
    s_add_u32 s34, s34, s3
    s_lshl_b32 s3, s2, 2
    v_mfma_f32_32x32x16_bf16 v[160:175], v[232:235], v[236:239], v[160:175]
    ds_read_b128 v[220:223], v64 offset:16384
    s_add_u32 s3, s3, s7
    v_mfma_f32_32x32x16_bf16 v[176:191], v[232:235], v[240:243], v[176:191]
    ds_read_b128 v[224:227], v64 offset:20480
    buffer_load_dwordx4 a[200:203], v38, s[16:19], s5 offen offset:2048
    s_add_u32 s5, s5, 128
    s_sub_u32 s74, s74, 1
    s_cmp_lg_u32 s74, 0
    s_cbranch_scc1 L_nw3
    s_mov_b32 s4, s52
    s_mov_b32 s5, s53
L_nw3:
    s_mul_i32 s3, s3, 0x1e3779b1
    s_lshr_b32 s47, s3, 15
    v_mfma_f32_32x32x16_bf16 v[192:207], v[232:235], v[244:247], v[192:207]
    buffer_load_dwordx4 a[32:35], v32, s[20:23], s4 offen offset:0
    s_xor_b32 s3, s3, s47
    s_mul_i32 s3, s3, 0x2c1b3c6d
    s_waitcnt lgkmcnt(0)
    v_mfma_f32_32x32x16_bf16 v[112:127], v[208:211], v[216:219], v[112:127]
    ds_read_b64_tr_b16 v[230:231], v76 offset:18944
    ds_read_b64_tr_b16 v[228:229], v76 offset:18432
    buffer_load_dwordx4 a[36:39], v33, s[20:23], s4 offen offset:1024
    s_lshr_b32 s3, s3, 20
    v_mfma_f32_32x32x16_bf16 v[128:143], v[208:211], v[220:223], v[128:143]
    ds_read_b64_tr_b16 v[234:235], v77 offset:18944
    ds_read_b64_tr_b16 v[232:233], v77 offset:18432
    buffer_load_dwordx4 a[40:43], v34, s[20:23], s4 offen offset:2048
    s_and_b32 s3, s3, 15
    s_lshl_b32 s35, s3, 14
    v_mfma_f32_32x32x16_bf16 v[144:159], v[208:211], v[224:227], v[144:159]
    ds_read_b128 v[236:239], v65 offset:12288
    buffer_load_dwordx4 a[44:47], v35, s[20:23], s4 offen offset:3072
    s_mov_b32 s36, s35
    s_mov_b32 s69, s35
    v_mfma_f32_32x32x16_bf16 v[160:175], v[212:215], v[216:219], v[160:175]
    ds_read_b128 v[240:243], v65 offset:16384
    s_add_u32 s4, s4, 262144
    buffer_load_dwordx4 a[48:51], v32, s[20:23], s4 offen offset:0
    v_lshlrev_b32 v50, 7, v1
    v_mfma_f32_32x32x16_bf16 v[176:191], v[212:215], v[220:223], v[176:191]
    ds_read_b128 v[244:247], v65 offset:20480
    buffer_load_dwordx4 a[52:55], v33, s[20:23], s4 offen offset:1024
    v_xor_b32 v27, v90, v89
    v_mfma_f32_32x32x16_bf16 v[192:207], v[212:215], v[224:227], v[192:207]
    buffer_load_dwordx4 a[56:59], v34, s[20:23], s4 offen offset:2048
    s_waitcnt lgkmcnt(0)
    v_mfma_f32_32x32x16_bf16 v[112:127], v[228:231], v[236:239], v[112:127]
    ds_read_b64_tr_b16 v[210:211], v76 offset:20992
    ds_read_b64_tr_b16 v[208:209], v76 offset:20480
    buffer_load_dwordx4 a[60:63], v35, s[20:23], s4 offen offset:3072
    v_lshlrev_b32 v27, 4, v27
    v_mfma_f32_32x32x16_bf16 v[128:143], v[228:231], v[240:243], v[128:143]
    ds_read_b64_tr_b16 v[214:215], v77 offset:20992
    ds_read_b64_tr_b16 v[212:213], v77 offset:20480
    s_add_u32 s4, s4, 262144
    buffer_load_dwordx4 a[204:207], v36, s[16:19], s5 offen offset:0
    v_lshl_add_u32 v27, v91, 8, v27
    v_mfma_f32_32x32x16_bf16 v[144:159], v[228:231], v[244:247], v[144:159]
    ds_read_b128 v[216:219], v66 offset:12288
    buffer_load_dwordx4 a[208:211], v37, s[16:19], s5 offen offset:1024
    v_add_u32 v8, s37, v27
    v_mfma_f32_32x32x16_bf16 v[160:175], v[232:235], v[236:239], v[160:175]
    ds_read_b128 v[220:223], v66 offset:16384
    buffer_load_dwordx4 a[212:215], v38, s[16:19], s5 offen offset:2048
    s_add_u32 s5, s5, 128
    s_sub_u32 s74, s74, 1
    s_cmp_lg_u32 s74, 0
    s_cbranch_scc1 L_nw4
    s_mov_b32 s4, s52
    s_mov_b32 s5, s53
L_nw4:
    v_xor_b32 v9, 32, v8
    v_mfma_f32_32x32x16_bf16 v[176:191], v[232:235], v[240:243], v[176:191]
    ds_read_b128 v[224:227], v66 offset:20480
    v_mfma_f32_32x32x16_bf16 v[192:207], v[232:235], v[244:247], v[192:207]
    buffer_load_dwordx4 a[64:67], v32, s[20:23], s4 offen offset:0
    buffer_load_dwordx4 a[68:71], v33, s[20:23], s4 offen offset:1024
    v_xor_b32 v10, 64, v8
    s_waitcnt lgkmcnt(0)
    v_mfma_f32_32x32x16_bf16 v[112:127], v[208:211], v[216:219], v[112:127]
    ds_read_b64_tr_b16 v[230:231], v76 offset:23040
    ds_read_b64_tr_b16 v[228:229], v76 offset:22528
    buffer_load_dwordx4 a[72:75], v34, s[20:23], s4 offen offset:2048
    v_xor_b32 v11, 96, v8
    v_mfma_f32_32x32x16_bf16 v[128:143], v[208:211], v[220:223], v[128:143]
    ds_read_b64_tr_b16 v[234:235], v77 offset:23040
    ds_read_b64_tr_b16 v[232:233], v77 offset:22528
    buffer_load_dwordx4 a[76:79], v35, s[20:23], s4 offen offset:3072
    v_xor_b32 v12, 128, v8
    v_mfma_f32_32x32x16_bf16 v[144:159], v[208:211], v[224:227], v[144:159]
    ds_read_b128 v[236:239], v67 offset:12288
    s_add_u32 s4, s4, 262144
    buffer_load_dwordx4 a[80:83], v32, s[20:23], s4 offen offset:0
    v_xor_b32 v13, 160, v8
    v_mfma_f32_32x32x16_bf16 v[160:175], v[212:215], v[216:219], v[160:175]
    ds_read_b128 v[240:243], v67 offset:16384
    buffer_load_dwordx4 a[84:87], v33, s[20:23], s4 offen offset:1024
    v_xor_b32 v14, 192, v8
    v_mfma_f32_32x32x16_bf16 v[176:191], v[212:215], v[220:223], v[176:191]
    ds_read_b128 v[244:247], v67 offset:20480
    buffer_load_dwordx4 a[88:91], v34, s[20:23], s4 offen offset:2048
    v_mfma_f32_32x32x16_bf16 v[192:207], v[212:215], v[224:227], v[192:207]
    buffer_load_dwordx4 a[92:95], v35, s[20:23], s4 offen offset:3072
    v_xor_b32 v15, 224, v8
    s_waitcnt vmcnt(0) lgkmcnt(0)
    s_barrier
    v_mfma_f32_32x32x16_bf16 v[112:127], v[228:231], v[236:239], v[112:127]
    ds_read_b64_tr_b16 v[210:211], v76 offset:33280
    ds_read_b64_tr_b16 v[208:209], v76 offset:32768
    s_add_u32 s4, s4, 262144
    buffer_load_dwordx4 a[216:219], v36, s[16:19], s5 offen offset:0
    v_lshl_add_u32 v28, v90, 2, v81
    v_mfma_f32_32x32x16_bf16 v[128:143], v[228:231], v[240:243], v[128:143]
    ds_read_b64_tr_b16 v[214:215], v77 offset:33280
    ds_read_b64_tr_b16 v[212:213], v77 offset:32768
    buffer_load_dwordx4 a[220:223], v37, s[16:19], s5 offen offset:1024
    v_lshlrev_b32 v28, 8, v28
    v_mfma_f32_32x32x16_bf16 v[144:159], v[228:231], v[244:247], v[144:159]
    ds_read_b128 v[216:219], v64 offset:24576
    buffer_load_dwordx4 a[224:227], v38, s[16:19], s5 offen offset:2048
    s_add_u32 s5, s5, 128
    s_sub_u32 s74, s74, 1
    s_cmp_lg_u32 s74, 0
    s_cbranch_scc1 L_nw5
    s_mov_b32 s4, s52
    s_mov_b32 s5, s53
L_nw5:
    v_lshl_add_u32 v28, v81, 6, v28
    v_mfma_f32_32x32x16_bf16 v[160:175], v[232:235], v[236:239], v[160:175]
    ds_read_b128 v[220:223], v64 offset:28672
    v_lshl_add_u32 v28, v92, 5, v28
    v_mfma_f32_32x32x16_bf16 v[176:191], v[232:235], v[240:243], v[176:191]
    ds_read_b128 v[224:227], v64 offset:32768
    buffer_load_dwordx4 a[96:99], v32, s[20:23], s4 offen offset:0
    v_mfma_f32_32x32x16_bf16 v[192:207], v[232:235], v[244:247], v[192:207]
    buffer_load_dwordx4 a[100:103], v33, s[20:23], s4 offen offset:1024
    v_lshl_add_u32 v28, v82, 3, v28
    s_lshl_b32 s47, s6, 7
    s_waitcnt lgkmcnt(0)
    v_mfma_f32_32x32x16_bf16 v[112:127], v[208:211], v[216:219], v[112:127]
    ds_read_b64_tr_b16 v[230:231], v76 offset:35328
    ds_read_b64_tr_b16 v[228:229], v76 offset:34816
    buffer_load_dwordx4 a[104:107], v34, s[20:23], s4 offen offset:2048
    v_xor_b32 v28, s47, v28
    v_mfma_f32_32x32x16_bf16 v[128:143], v[208:211], v[220:223], v[128:143]
    ds_read_b64_tr_b16 v[234:235], v77 offset:35328
    ds_read_b64_tr_b16 v[232:233], v77 offset:34816
    buffer_load_dwordx4 a[108:111], v35, s[20:23], s4 offen offset:3072
    v_mfma_f32_32x32x16_bf16 v[144:159], v[208:211], v[224:227], v[144:159]
    ds_read_b128 v[236:239], v65 offset:24576
    s_add_u32 s4, s4, 262144
    buffer_load_dwordx4 a[112:115], v32, s[20:23], s4 offen offset:0
    v_add_u32 v16, s37, v28
    v_mfma_f32_32x32x16_bf16 v[160:175], v[212:215], v[216:219], v[160:175]
    ds_read_b128 v[240:243], v65 offset:28672
    buffer_load_dwordx4 a[116:119], v33, s[20:23], s4 offen offset:1024
    buffer_load_dwordx4 a[120:123], v34, s[20:23], s4 offen offset:2048
    v_xor_b32 v17, 64, v16
    ds_write_b128 v48, a[0:3] offset:16384
    v_mfma_f32_32x32x16_bf16 v[176:191], v[212:215], v[220:223], v[176:191]
    ds_read_b128 v[244:247], v65 offset:32768
    buffer_load_dwordx4 a[124:127], v35, s[20:23], s4 offen offset:3072
    v_xor_b32 v18, 128, v16
    ds_write_b128 v48, a[4:7] offset:17408
    v_mfma_f32_32x32x16_bf16 v[192:207], v[212:215], v[224:227], v[192:207]
    s_add_u32 s4, s4, 262144
    buffer_load_dwordx4 a[228:231], v36, s[16:19], s5 offen offset:0
    v_xor_b32 v19, 192, v16
    s_waitcnt lgkmcnt(1)
    v_mfma_f32_32x32x16_bf16 v[112:127], v[228:231], v[236:239], v[112:127]
    ds_read_b64_tr_b16 v[210:211], v76 offset:37376
    ds_read_b64_tr_b16 v[208:209], v76 offset:36864
    buffer_load_dwordx4 a[232:235], v37, s[16:19], s5 offen offset:1024
    v_add_u32 v28, s54, v28
    ds_write_b128 v48, a[8:11] offset:18432
    v_mfma_f32_32x32x16_bf16 v[128:143], v[228:231], v[240:243], v[128:143]
    ds_read_b64_tr_b16 v[214:215], v77 offset:37376
    ds_read_b64_tr_b16 v[212:213], v77 offset:36864
    ds_write_b128 v48, a[12:15] offset:19456
    v_mfma_f32_32x32x16_bf16 v[144:159], v[228:231], v[244:247], v[144:159]
    ds_read_b128 v[216:219], v66 offset:24576
    buffer_load_dwordx4 a[236:239], v38, s[16:19], s5 offen offset:2048
    s_add_u32 s5, s5, 128
    s_sub_u32 s74, s74, 1
    s_cmp_lg_u32 s74, 0
    s_cbranch_scc1 L_nw6
    s_mov_b32 s4, s52
    s_mov_b32 s5, s53
L_nw6:
    v_xor_b32 v29, 64, v28
    ds_write_b128 v48, a[16:19] offset:20480
    v_mfma_f32_32x32x16_bf16 v[160:175], v[232:235], v[236:239], v[160:175]
    ds_read_b128 v[220:223], v66 offset:28672
    buffer_load_dwordx4 a[128:131], v32, s[20:23], s4 offen offset:0
    v_xor_b32 v30, 128, v28
    ds_write_b128 v48, a[20:23] offset:21504
    v_mfma_f32_32x32x16_bf16 v[176:191], v[232:235], v[240:243], v[176:191]
    ds_read_b128 v[224:227], v66 offset:32768
    buffer_load_dwordx4 a[132:135], v33, s[20:23], s4 offen offset:1024
    v_xor_b32 v31, 192, v28
    ds_write_b128 v48, a[24:27] offset:22528
    v_mfma_f32_32x32x16_bf16 v[192:207], v[232:235], v[244:247], v[192:207]
    buffer_load_dwordx4 a[136:139], v34, s[20:23], s4 offen offset:2048
    s_mov_b32 s42, 0x3e0293ee
    ds_write_b128 v48, a[28:31] offset:23552
    s_waitcnt lgkmcnt(2)
    v_mfma_f32_32x32x16_bf16 v[112:127], v[208:211], v[216:219], v[112:127]
    ds_read_b64_tr_b16 v[230:231], v76 offset:39424
    ds_read_b64_tr_b16 v[228:229], v76 offset:38912
    buffer_load_dwordx4 a[140:143], v35, s[20:23], s4 offen offset:3072
    s_mov_b32 s43, 0x41000000
    v_mov_b32 v20, 0
    v_mfma_f32_32x32x16_bf16 v[128:143], v[208:211], v[220:223], v[128:143]
    ds_read_b64_tr_b16 v[234:235], v77 offset:39424
    ds_read_b64_tr_b16 v[232:233], v77 offset:38912
    s_add_u32 s4, s4, 262144
    buffer_load_dwordx4 a[144:147], v32, s[20:23], s4 offen offset:0
    ds_write_b128 v49, a[192:195] offset:12288
    v_mfma_f32_32x32x16_bf16 v[144:159], v[208:211], v[224:227], v[144:159]
    ds_read_b128 v[236:239], v67 offset:24576
    buffer_load_dwordx4 a[148:151], v33, s[20:23], s4 offen offset:1024
    v_mov_b32 v21, 0
    ds_write_b128 v49, a[196:199] offset:13312
    v_mfma_f32_32x32x16_bf16 v[160:175], v[212:215], v[216:219], v[160:175]
    ds_read_b128 v[240:243], v67 offset:28672
    buffer_load_dwordx4 a[152:155], v34, s[20:23], s4 offen offset:2048
    v_mov_b32 v22, 0
    ds_write_b128 v49, a[200:203] offset:14336
    v_mfma_f32_32x32x16_bf16 v[176:191], v[212:215], v[220:223], v[176:191]
    ds_read_b128 v[244:247], v67 offset:32768
    buffer_load_dwordx4 a[156:159], v35, s[20:23], s4 offen offset:3072
    v_mfma_f32_32x32x16_bf16 v[192:207], v[212:215], v[224:227], v[192:207]
    s_add_u32 s4, s4, 262144
    buffer_load_dwordx4 a[240:243], v36, s[16:19], s5 offen offset:0
    s_waitcnt lgkmcnt(0)
    s_barrier
    v_mfma_f32_32x32x16_bf16 v[112:127], v[228:231], v[236:239], v[112:127]
    ds_read_b64_tr_b16 v[210:211], v76 offset:16896
    ds_read_b64_tr_b16 v[208:209], v76 offset:16384
    buffer_load_dwordx4 a[244:247], v37, s[16:19], s5 offen offset:1024
    v_mfma_f32_32x32x16_bf16 v[128:143], v[228:231], v[240:243], v[128:143]
    ds_read_b64_tr_b16 v[214:215], v77 offset:16896
    ds_read_b64_tr_b16 v[212:213], v77 offset:16384
    buffer_load_dwordx4 a[248:251], v38, s[16:19], s5 offen offset:2048
    s_add_u32 s5, s5, 128
    s_sub_u32 s74, s74, 1
    s_cmp_lg_u32 s74, 0
    s_cbranch_scc1 L_nw7
    s_mov_b32 s4, s52
    s_mov_b32 s5, s53
L_nw7:
    v_mfma_f32_32x32x16_bf16 v[144:159], v[228:231], v[244:247], v[144:159]
    ds_read_b128 v[216:219], v64 offset:12288
    v_mfma_f32_32x32x16_bf16 v[160:175], v[232:235], v[236:239], v[160:175]
    ds_read_b128 v[220:223], v64 offset:16384
    buffer_load_dwordx4 a[160:163], v32, s[20:23], s4 offen offset:0
    ds_write_b128 v48, a[32:35] offset:0
    v_mfma_f32_32x32x16_bf16 v[176:191], v[232:235], v[240:243], v[176:191]
    ds_read_b128 v[224:227], v64 offset:20480
    buffer_load_dwordx4 a[164:167], v33, s[20:23], s4 offen offset:1024
    buffer_load_dwordx4 a[168:171], v34, s[20:23], s4 offen offset:2048
    v_mfma_f32_32x32x16_bf16 v[192:207], v[232:235], v[244:247], v[192:207]
    buffer_load_dwordx4 a[172:175], v35, s[20:23], s4 offen offset:3072
    ds_write_b128 v48, a[36:39] offset:1024
    s_waitcnt lgkmcnt(1)
    v_mfma_f32_32x32x16_bf16 v[112:127], v[208:211], v[216:219], v[112:127]
    ds_read_b64_tr_b16 v[230:231], v76 offset:18944
    ds_read_b64_tr_b16 v[228:229], v76 offset:18432
    s_add_u32 s4, s4, 262144
    buffer_load_dwordx4 a[176:179], v32, s[20:23], s4 offen offset:0
    v_mfma_f32_32x32x16_bf16 v[128:143], v[208:211], v[220:223], v[128:143]
    ds_read_b64_tr_b16 v[234:235], v77 offset:18944
    ds_read_b64_tr_b16 v[232:233], v77 offset:18432
    buffer_load_dwordx4 a[180:183], v33, s[20:23], s4 offen offset:1024
    ds_write_b128 v48, a[40:43] offset:2048
    v_mfma_f32_32x32x16_bf16 v[144:159], v[208:211], v[224:227], v[144:159]
    ds_read_b128 v[236:239], v65 offset:12288
    buffer_load_dwordx4 a[184:187], v34, s[20:23], s4 offen offset:2048
    ds_write_b128 v48, a[44:47] offset:3072
    v_mfma_f32_32x32x16_bf16 v[160:175], v[212:215], v[216:219], v[160:175]
    ds_read_b128 v[240:243], v65 offset:16384
    buffer_load_dwordx4 a[188:191], v35, s[20:23], s4 offen offset:3072
    v_mfma_f32_32x32x16_bf16 v[176:191], v[212:215], v[220:223], v[176:191]
    ds_read_b128 v[244:247], v65 offset:20480
    s_add_u32 s4, s4, 262144
    buffer_load_dwordx4 a[252:255], v36, s[16:19], s5 offen offset:0
    ds_write_b128 v48, a[48:51] offset:4096
    v_mfma_f32_32x32x16_bf16 v[192:207], v[212:215], v[224:227], v[192:207]
    buffer_load_dwordx4 v[40:43], v37, s[16:19], s5 offen offset:1024
    s_waitcnt lgkmcnt(1)
    v_mfma_f32_32x32x16_bf16 v[112:127], v[228:231], v[236:239], v[112:127]
    ds_read_b64_tr_b16 v[210:211], v76 offset:20992
    ds_read_b64_tr_b16 v[208:209], v76 offset:20480
    buffer_load_dwordx4 v[44:47], v38, s[16:19], s5 offen offset:2048
    s_add_u32 s5, s5, 128
    s_sub_u32 s74, s74, 1
    s_cmp_lg_u32 s74, 0
    s_cbranch_scc1 L_nw8
    s_mov_b32 s4, s52
    s_mov_b32 s5, s53
L_nw8:
    ds_write_b128 v48, a[52:55] offset:5120
    v_mfma_f32_32x32x16_bf16 v[128:143], v[228:231], v[240:243], v[128:143]
    ds_read_b64_tr_b16 v[214:215], v77 offset:20992
    ds_read_b64_tr_b16 v[212:213], v77 offset:20480
    v_mfma_f32_32x32x16_bf16 v[144:159], v[228:231], v[244:247], v[144:159]
    ds_read_b128 v[216:219], v66 offset:12288
    ds_write_b128 v48, a[56:59] offset:6144
    v_mfma_f32_32x32x16_bf16 v[160:175], v[232:235], v[236:239], v[160:175]
    ds_read_b128 v[220:223], v66 offset:16384
    ds_write_b128 v48, a[60:63] offset:7168
    s_add_u32 m0, s37, 32768
    s_add_u32 s51, s34, s36
    buffer_load_dwordx4 v2, s[8:11], s51 offen offset:0 nt lds
    v_mfma_f32_32x32x16_bf16 v[176:191], v[232:235], v[240:243], v[176:191]
    ds_read_b128 v[224:227], v66 offset:20480
    v_mfma_f32_32x32x16_bf16 v[192:207], v[232:235], v[244:247], v[192:207]
    ds_write_b128 v49, a[204:207] offset:0
    s_add_u32 s36, s36, 16384
    s_and_b32 s36, s36, 0x3ffff
    buffer_load_dwordx4 v3, s[8:11], s51 offen offset:1024 nt lds
    s_waitcnt lgkmcnt(1)
    v_mfma_f32_32x32x16_bf16 v[112:127], v[208:211], v[216:219], v[112:127]
    ds_read_b64_tr_b16 v[230:231], v76 offset:23040
    ds_read_b64_tr_b16 v[228:229], v76 offset:22528
    v_mfma_f32_32x32x16_bf16 v[128:143], v[208:211], v[220:223], v[128:143]
    ds_read_b64_tr_b16 v[234:235], v77 offset:23040
    ds_read_b64_tr_b16 v[232:233], v77 offset:22528
    ds_write_b128 v49, a[208:211] offset:1024
    buffer_load_dwordx4 v4, s[8:11], s51 offen offset:2048 nt lds
    v_mfma_f32_32x32x16_bf16 v[144:159], v[208:211], v[224:227], v[144:159]
    ds_read_b128 v[236:239], v67 offset:12288
    buffer_load_dwordx4 v5, s[8:11], s51 offen offset:3072 nt lds
    v_mfma_f32_32x32x16_bf16 v[160:175], v[212:215], v[216:219], v[160:175]
    ds_read_b128 v[240:243], v67 offset:16384
    ds_write_b128 v49, a[212:215] offset:2048
    v_mfma_f32_32x32x16_bf16 v[176:191], v[212:215], v[220:223], v[176:191]
    ds_read_b128 v[244:247], v67 offset:20480
    s_add_u32 m0, s37, 36864
    s_add_u32 s51, s51, 4096
    buffer_load_dwordx4 v2, s[8:11], s51 offen offset:0 nt lds
    v_mfma_f32_32x32x16_bf16 v[192:207], v[212:215], v[224:227], v[192:207]
    s_waitcnt lgkmcnt(0)
    s_barrier
    v_mfma_f32_32x32x16_bf16 v[112:127], v[228:231], v[236:239], v[112:127]
    ds_read_b64_tr_b16 v[210:211], v76 offset:512
    ds_read_b64_tr_b16 v[208:209], v76 offset:0
    buffer_load_dwordx4 v3, s[8:11], s51 offen offset:1024 nt lds
    v_mfma_f32_32x32x16_bf16 v[128:143], v[228:231], v[240:243], v[128:143]
    ds_read_b64_tr_b16 v[214:215], v77 offset:512
    ds_read_b64_tr_b16 v[212:213], v77 offset:0
    s_waitcnt vmcnt(33)
    v_mfma_f32_32x32x16_bf16 v[144:159], v[228:231], v[244:247], v[144:159]
    ds_read_b128 v[216:219], v64 offset:0
    buffer_load_dwordx4 v4, s[8:11], s51 offen offset:2048 nt lds
    v_mfma_f32_32x32x16_bf16 v[160:175], v[232:235], v[236:239], v[160:175]
    ds_read_b128 v[220:223], v64 offset:4096
    ds_write_b128 v48, a[64:67] offset:16384
    v_mfma_f32_32x32x16_bf16 v[176:191], v[232:235], v[240:243], v[176:191]
    ds_read_b128 v[224:227], v64 offset:8192
    buffer_load_dwordx4 v5, s[8:11], s51 offen offset:3072 nt lds
    v_mfma_f32_32x32x16_bf16 v[192:207], v[232:235], v[244:247], v[192:207]
    ds_write_b128 v48, a[68:71] offset:17408
    s_waitcnt lgkmcnt(1)
    v_mfma_f32_32x32x16_bf16 v[112:127], v[208:211], v[216:219], v[112:127]
    ds_read_b64_tr_b16 v[230:231], v76 offset:2560
    ds_read_b64_tr_b16 v[228:229], v76 offset:2048
    s_add_u32 m0, s54, 0
    s_add_u32 s51, s34, s35
    buffer_load_dwordx4 v6, s[12:15], s51 offen offset:0 nt lds
    v_mfma_f32_32x32x16_bf16 v[128:143], v[208:211], v[220:223], v[128:143]
    ds_read_b64_tr_b16 v[234:235], v77 offset:2560
    ds_read_b64_tr_b16 v[232:233], v77 offset:2048
    ds_write_b128 v48, a[72:75] offset:18432
    v_mfma_f32_32x32x16_bf16 v[144:159], v[208:211], v[224:227], v[144:159]
    ds_read_b128 v[236:239], v65 offset:0
    s_add_u32 s35, s35, 16384
    s_and_b32 s35, s35, 0x3ffff
    buffer_load_dwordx4 v6, s[12:15], s51 offen offset:1024 nt lds
    ds_write_b128 v48, a[76:79] offset:19456
    v_mfma_f32_32x32x16_bf16 v[160:175], v[212:215], v[216:219], v[160:175]
    ds_read_b128 v[240:243], v65 offset:4096
    v_mfma_f32_32x32x16_bf16 v[176:191], v[212:215], v[220:223], v[176:191]
    ds_read_b128 v[244:247], v65 offset:8192
    buffer_load_dwordx4 v6, s[12:15], s51 offen offset:2048 nt lds
    ds_write_b128 v48, a[80:83] offset:20480
    v_mfma_f32_32x32x16_bf16 v[192:207], v[212:215], v[224:227], v[192:207]
    buffer_load_dwordx4 v6, s[12:15], s51 offen offset:3072 nt lds
    s_waitcnt lgkmcnt(1)
    v_mfma_f32_32x32x16_bf16 v[112:127], v[228:231], v[236:239], v[112:127]
    ds_read_b64_tr_b16 v[210:211], v76 offset:4608
    ds_read_b64_tr_b16 v[208:209], v76 offset:4096
    ds_write_b128 v48, a[84:87] offset:21504
    v_mfma_f32_32x32x16_bf16 v[128:143], v[228:231], v[240:243], v[128:143]
    ds_read_b64_tr_b16 v[214:215], v77 offset:4608
    ds_read_b64_tr_b16 v[212:213], v77 offset:4096
    s_add_u32 m0, s54, 4096
    s_add_u32 s51, s51, 4096
    buffer_load_dwordx4 v6, s[12:15], s51 offen offset:0 nt lds
    v_mfma_f32_32x32x16_bf16 v[144:159], v[228:231], v[244:247], v[144:159]
    ds_read_b128 v[216:219], v66 offset:0
    ds_write_b128 v48, a[88:91] offset:22528
    v_mfma_f32_32x32x16_bf16 v[160:175], v[232:235], v[236:239], v[160:175]
    ds_read_b128 v[220:223], v66 offset:4096
    buffer_load_dwordx4 v6, s[12:15], s51 offen offset:1024 nt lds
    ds_write_b128 v48, a[92:95] offset:23552
    v_mfma_f32_32x32x16_bf16 v[176:191], v[232:235], v[240:243], v[176:191]
    ds_read_b128 v[224:227], v66 offset:8192
    v_mfma_f32_32x32x16_bf16 v[192:207], v[232:235], v[244:247], v[192:207]
    buffer_load_dwordx4 v6, s[12:15], s51 offen offset:2048 nt lds
    ds_write_b128 v49, a[216:219] offset:12288
    s_waitcnt lgkmcnt(1)
    v_mfma_f32_32x32x16_bf16 v[112:127], v[208:211], v[216:219], v[112:127]
    ds_read_b64_tr_b16 v[230:231], v76 offset:6656
    ds_read_b64_tr_b16 v[228:229], v76 offset:6144
    v_mfma_f32_32x32x16_bf16 v[128:143], v[208:211], v[220:223], v[128:143]
    ds_read_b64_tr_b16 v[234:235], v77 offset:6656
    ds_read_b64_tr_b16 v[232:233], v77 offset:6144
    buffer_load_dwordx4 v6, s[12:15], s51 offen offset:3072 nt lds
    ds_write_b128 v49, a[220:223] offset:13312
    v_mfma_f32_32x32x16_bf16 v[144:159], v[208:211], v[224:227], v[144:159]
    ds_read_b128 v[236:239], v67 offset:0
    v_mfma_f32_32x32x16_bf16 v[160:175], v[212:215], v[216:219], v[160:175]
    ds_read_b128 v[240:243], v67 offset:4096
    ds_write_b128 v49, a[224:227] offset:14336
    v_mfma_f32_32x32x16_bf16 v[176:191], v[212:215], v[220:223], v[176:191]
    ds_read_b128 v[244:247], v67 offset:8192
    v_mfma_f32_32x32x16_bf16 v[192:207], v[212:215], v[224:227], v[192:207]
    s_waitcnt lgkmcnt(0)
    s_barrier
    v_mfma_f32_32x32x16_bf16 v[112:127], v[228:231], v[236:239], v[112:127]
    ds_read_b64_tr_b16 v[210:211], v76 offset:16896
    ds_read_b64_tr_b16 v[208:209], v76 offset:16384
    v_mfma_f32_32x32x16_bf16 v[128:143], v[228:231], v[240:243], v[128:143]
    ds_read_b64_tr_b16 v[214:215], v77 offset:16896
    ds_read_b64_tr_b16 v[212:213], v77 offset:16384
    s_waitcnt vmcnt(22)
    v_mfma_f32_32x32x16_bf16 v[144:159], v[228:231], v[244:247], v[144:159]
    ds_read_b128 v[216:219], v64 offset:12288
    v_mfma_f32_32x32x16_bf16 v[160:175], v[232:235], v[236:239], v[160:175]
    ds_read_b128 v[220:223], v64 offset:16384
    ds_write_b128 v48, a[96:99] offset:0
    v_mfma_f32_32x32x16_bf16 v[176:191], v[232:235], v[240:243], v[176:191]
    ds_read_b128 v[224:227], v64 offset:20480
    v_mfma_f32_32x32x16_bf16 v[192:207], v[232:235], v[244:247], v[192:207]
    ds_write_b128 v48, a[100:103] offset:1024
    s_waitcnt lgkmcnt(1)
    v_mfma_f32_32x32x16_bf16 v[112:127], v[208:211], v[216:219], v[112:127]
    ds_read_b64_tr_b16 v[230:231], v76 offset:18944
    ds_read_b64_tr_b16 v[228:229], v76 offset:18432
    v_mfma_f32_32x32x16_bf16 v[128:143], v[208:211], v[220:223], v[128:143]
    ds_read_b64_tr_b16 v[234:235], v77 offset:18944
    ds_read_b64_tr_b16 v[232:233], v77 offset:18432
    ds_write_b128 v48, a[104:107] offset:2048
    v_mfma_f32_32x32x16_bf16 v[144:159], v[208:211], v[224:227], v[144:159]
    ds_read_b128 v[236:239], v65 offset:12288
    ds_write_b128 v48, a[108:111] offset:3072
    v_mfma_f32_32x32x16_bf16 v[160:175], v[212:215], v[216:219], v[160:175]
    ds_read_b128 v[240:243], v65 offset:16384
    v_mfma_f32_32x32x16_bf16 v[176:191], v[212:215], v[220:223], v[176:191]
    ds_read_b128 v[244:247], v65 offset:20480
    ds_write_b128 v48, a[112:115] offset:4096
    v_mfma_f32_32x32x16_bf16 v[192:207], v[212:215], v[224:227], v[192:207]
    s_waitcnt lgkmcnt(1)
    v_mfma_f32_32x32x16_bf16 v[112:127], v[228:231], v[236:239], v[112:127]
    ds_read_b64_tr_b16 v[210:211], v76 offset:20992
    ds_read_b64_tr_b16 v[208:209], v76 offset:20480
    ds_write_b128 v48, a[116:119] offset:5120
    v_mfma_f32_32x32x16_bf16 v[128:143], v[228:231], v[240:243], v[128:143]
    ds_read_b64_tr_b16 v[214:215], v77 offset:20992
    ds_read_b64_tr_b16 v[212:213], v77 offset:20480
    v_mfma_f32_32x32x16_bf16 v[144:159], v[228:231], v[244:247], v[144:159]
    ds_read_b128 v[216:219], v66 offset:12288
    ds_write_b128 v48, a[120:123] offset:6144
    v_mfma_f32_32x32x16_bf16 v[160:175], v[232:235], v[236:239], v[160:175]
    ds_read_b128 v[220:223], v66 offset:16384
    ds_write_b128 v48, a[124:127] offset:7168
    s_lshr_b32 s3, s2, 3
    s_lshl_b32 s3, s3, 2
    s_add_u32 s3, s3, s28
    s_mul_i32 s3, s3, 9216
    s_mul_i32 s47, s30, 1179648
    v_lshlrev_b32 v24, 7, v1
    v_add_u32 v24, s3, v24
    v_add_u32 v25, 8192, v24
    v_cmp_gt_u32 s[70:71], 8, v1
    s_nop 1
    v_cndmask_b32 v25, -1, v25, s[70:71]
    buffer_load_dword v23, v24, s[60:63], s47 offen
    v_mfma_f32_32x32x16_bf16 v[176:191], v[232:235], v[240:243], v[176:191]
    ds_read_b128 v[224:227], v66 offset:20480
    v_mfma_f32_32x32x16_bf16 v[192:207], v[232:235], v[244:247], v[192:207]
    ds_write_b128 v49, a[228:231] offset:0
    s_waitcnt lgkmcnt(1)
    v_mfma_f32_32x32x16_bf16 v[112:127], v[208:211], v[216:219], v[112:127]
    ds_read_b64_tr_b16 v[230:231], v76 offset:23040
    ds_read_b64_tr_b16 v[228:229], v76 offset:22528
    v_mfma_f32_32x32x16_bf16 v[128:143], v[208:211], v[220:223], v[128:143]
    ds_read_b64_tr_b16 v[234:235], v77 offset:23040
    ds_read_b64_tr_b16 v[232:233], v77 offset:22528
    ds_write_b128 v49, a[232:235] offset:1024
    v_mfma_f32_32x32x16_bf16 v[144:159], v[208:211], v[224:227], v[144:159]
    ds_read_b128 v[236:239], v67 offset:12288
    s_mul_i32 s47, s30, 1179648
    buffer_load_dword v23, v25, s[60:63], s47 offen
    v_mfma_f32_32x32x16_bf16 v[160:175], v[212:215], v[216:219], v[160:175]
    ds_read_b128 v[240:243], v67 offset:16384
    ds_write_b128 v49, a[236:239] offset:2048
    v_mfma_f32_32x32x16_bf16 v[176:191], v[212:215], v[220:223], v[176:191]
    ds_read_b128 v[244:247], v67 offset:20480
    v_mfma_f32_32x32x16_bf16 v[192:207], v[212:215], v[224:227], v[192:207]
    s_waitcnt lgkmcnt(0)
    s_barrier
    v_mfma_f32_32x32x16_bf16 v[112:127], v[228:231], v[236:239], v[112:127]
    ds_read_b64_tr_b16 v[210:211], v76 offset:512
    ds_read_b64_tr_b16 v[208:209], v76 offset:0
    v_mfma_f32_32x32x16_bf16 v[128:143], v[228:231], v[240:243], v[128:143]
    ds_read_b64_tr_b16 v[214:215], v77 offset:512
    ds_read_b64_tr_b16 v[212:213], v77 offset:0
    s_waitcnt vmcnt(13)
    v_mfma_f32_32x32x16_bf16 v[144:159], v[228:231], v[244:247], v[144:159]
    ds_read_b128 v[216:219], v64 offset:0
    v_mfma_f32_32x32x16_bf16 v[160:175], v[232:235], v[236:239], v[160:175]
    ds_read_b128 v[220:223], v64 offset:4096
    ds_write_b128 v48, a[128:131] offset:16384
    v_mfma_f32_32x32x16_bf16 v[176:191], v[232:235], v[240:243], v[176:191]
    ds_read_b128 v[224:227], v64 offset:8192
    v_mfma_f32_32x32x16_bf16 v[192:207], v[232:235], v[244:247], v[192:207]
    ds_write_b128 v48, a[132:135] offset:17408
    s_waitcnt lgkmcnt(1)
    v_mfma_f32_32x32x16_bf16 v[112:127], v[208:211], v[216:219], v[112:127]
    ds_read_b64_tr_b16 v[230:231], v76 offset:2560
    ds_read_b64_tr_b16 v[228:229], v76 offset:2048
    v_mfma_f32_32x32x16_bf16 v[128:143], v[208:211], v[220:223], v[128:143]
    ds_read_b64_tr_b16 v[234:235], v77 offset:2560
    ds_read_b64_tr_b16 v[232:233], v77 offset:2048
    ds_write_b128 v48, a[136:139] offset:18432
    v_mfma_f32_32x32x16_bf16 v[144:159], v[208:211], v[224:227], v[144:159]
    ds_read_b128 v[236:239], v65 offset:0
    ds_write_b128 v48, a[140:143] offset:19456
    v_mfma_f32_32x32x16_bf16 v[160:175], v[212:215], v[216:219], v[160:175]
    ds_read_b128 v[240:243], v65 offset:4096
    v_mfma_f32_32x32x16_bf16 v[176:191], v[212:215], v[220:223], v[176:191]
    ds_read_b128 v[244:247], v65 offset:8192
    ds_write_b128 v48, a[144:147] offset:20480
    v_mfma_f32_32x32x16_bf16 v[192:207], v[212:215], v[224:227], v[192:207]
    s_waitcnt lgkmcnt(1)
    v_mfma_f32_32x32x16_bf16 v[112:127], v[228:231], v[236:239], v[112:127]
    ds_read_b64_tr_b16 v[210:211], v76 offset:4608
    ds_read_b64_tr_b16 v[208:209], v76 offset:4096
    ds_write_b128 v48, a[148:151] offset:21504
    v_mfma_f32_32x32x16_bf16 v[128:143], v[228:231], v[240:243], v[128:143]
    ds_read_b64_tr_b16 v[214:215], v77 offset:4608
    ds_read_b64_tr_b16 v[212:213], v77 offset:4096
    v_mfma_f32_32x32x16_bf16 v[144:159], v[228:231], v[244:247], v[144:159]
    ds_read_b128 v[216:219], v66 offset:0
    ds_write_b128 v48, a[152:155] offset:22528
    v_mfma_f32_32x32x16_bf16 v[160:175], v[232:235], v[236:239], v[160:175]
    ds_read_b128 v[220:223], v66 offset:4096
    ds_write_b128 v48, a[156:159] offset:23552
    v_mfma_f32_32x32x16_bf16 v[176:191], v[232:235], v[240:243], v[176:191]
    ds_read_b128 v[224:227], v66 offset:8192
    v_mfma_f32_32x32x16_bf16 v[192:207], v[232:235], v[244:247], v[192:207]
    ds_write_b128 v49, a[240:243] offset:12288
    s_waitcnt lgkmcnt(1)
    v_mfma_f32_32x32x16_bf16 v[112:127], v[208:211], v[216:219], v[112:127]
    ds_read_b64_tr_b16 v[230:231], v76 offset:6656
    ds_read_b64_tr_b16 v[228:229], v76 offset:6144
    v_mfma_f32_32x32x16_bf16 v[128:143], v[208:211], v[220:223], v[128:143]
    ds_read_b64_tr_b16 v[234:235], v77 offset:6656
    ds_read_b64_tr_b16 v[232:233], v77 offset:6144
    ds_write_b128 v49, a[244:247] offset:13312
    v_mfma_f32_32x32x16_bf16 v[144:159], v[208:211], v[224:227], v[144:159]
    ds_read_b128 v[236:239], v67 offset:0
    v_mfma_f32_32x32x16_bf16 v[160:175], v[212:215], v[216:219], v[160:175]
    ds_read_b128 v[240:243], v67 offset:4096
    ds_write_b128 v49, a[248:251] offset:14336
    v_mfma_f32_32x32x16_bf16 v[176:191], v[212:215], v[220:223], v[176:191]
    ds_read_b128 v[244:247], v67 offset:8192
    v_mfma_f32_32x32x16_bf16 v[192:207], v[212:215], v[224:227], v[192:207]
    s_waitcnt lgkmcnt(0)
    s_barrier
    v_mfma_f32_32x32x16_bf16 v[112:127], v[228:231], v[236:239], v[112:127]
    ds_read_b64_tr_b16 v[210:211], v76 offset:16896
    ds_read_b64_tr_b16 v[208:209], v76 offset:16384
    v_mfma_f32_32x32x16_bf16 v[128:143], v[228:231], v[240:243], v[128:143]
    ds_read_b64_tr_b16 v[214:215], v77 offset:16896
    ds_read_b64_tr_b16 v[212:213], v77 offset:16384
    s_waitcnt vmcnt(2)
    v_mfma_f32_32x32x16_bf16 v[144:159], v[228:231], v[244:247], v[144:159]
    ds_read_b128 v[216:219], v64 offset:12288
    v_mfma_f32_32x32x16_bf16 v[160:175], v[232:235], v[236:239], v[160:175]
    ds_read_b128 v[220:223], v64 offset:16384
    ds_write_b128 v48, a[160:163] offset:0
    v_mfma_f32_32x32x16_bf16 v[176:191], v[232:235], v[240:243], v[176:191]
    ds_read_b128 v[224:227], v64 offset:20480
    v_mfma_f32_32x32x16_bf16 v[192:207], v[232:235], v[244:247], v[192:207]
    ds_write_b128 v48, a[164:167] offset:1024
    s_waitcnt lgkmcnt(1)
    v_mfma_f32_32x32x16_bf16 v[112:127], v[208:211], v[216:219], v[112:127]
    ds_read_b64_tr_b16 v[230:231], v76 offset:18944
    ds_read_b64_tr_b16 v[228:229], v76 offset:18432
    v_mfma_f32_32x32x16_bf16 v[128:143], v[208:211], v[220:223], v[128:143]
    ds_read_b64_tr_b16 v[234:235], v77 offset:18944
    ds_read_b64_tr_b16 v[232:233], v77 offset:18432
    ds_write_b128 v48, a[168:171] offset:2048
    v_mfma_f32_32x32x16_bf16 v[144:159], v[208:211], v[224:227], v[144:159]
    ds_read_b128 v[236:239], v65 offset:12288
    ds_write_b128 v48, a[172:175] offset:3072
    v_mfma_f32_32x32x16_bf16 v[160:175], v[212:215], v[216:219], v[160:175]
    ds_read_b128 v[240:243], v65 offset:16384
    v_mfma_f32_32x32x16_bf16 v[176:191], v[212:215], v[220:223], v[176:191]
    ds_read_b128 v[244:247], v65 offset:20480
    ds_write_b128 v48, a[176:179] offset:4096
    v_mfma_f32_32x32x16_bf16 v[192:207], v[212:215], v[224:227], v[192:207]
    s_waitcnt lgkmcnt(1)
    v_mfma_f32_32x32x16_bf16 v[112:127], v[228:231], v[236:239], v[112:127]
    ds_read_b64_tr_b16 v[210:211], v76 offset:20992
    ds_read_b64_tr_b16 v[208:209], v76 offset:20480
    ds_write_b128 v48, a[180:183] offset:5120
    v_mfma_f32_32x32x16_bf16 v[128:143], v[228:231], v[240:243], v[128:143]
    ds_read_b64_tr_b16 v[214:215], v77 offset:20992
    ds_read_b64_tr_b16 v[212:213], v77 offset:20480
    v_mfma_f32_32x32x16_bf16 v[144:159], v[228:231], v[244:247], v[144:159]
    ds_read_b128 v[216:219], v66 offset:12288
    ds_write_b128 v48, a[184:187] offset:6144
    v_mfma_f32_32x32x16_bf16 v[160:175], v[232:235], v[236:239], v[160:175]
    ds_read_b128 v[220:223], v66 offset:16384
    ds_write_b128 v48, a[188:191] offset:7168
    v_mfma_f32_32x32x16_bf16 v[176:191], v[232:235], v[240:243], v[176:191]
    ds_read_b128 v[224:227], v66 offset:20480
    v_mfma_f32_32x32x16_bf16 v[192:207], v[232:235], v[244:247], v[192:207]
    ds_write_b128 v49, a[252:255] offset:0
    s_waitcnt lgkmcnt(1)
    v_mfma_f32_32x32x16_bf16 v[112:127], v[208:211], v[216:219], v[112:127]
    ds_read_b64_tr_b16 v[230:231], v76 offset:23040
    ds_read_b64_tr_b16 v[228:229], v76 offset:22528
    v_mfma_f32_32x32x16_bf16 v[128:143], v[208:211], v[220:223], v[128:143]
    ds_read_b64_tr_b16 v[234:235], v77 offset:23040
    ds_read_b64_tr_b16 v[232:233], v77 offset:22528
    ds_write_b128 v49, v[40:43] offset:1024
    v_mfma_f32_32x32x16_bf16 v[144:159], v[208:211], v[224:227], v[144:159]
    ds_read_b128 v[236:239], v67 offset:12288
    v_mfma_f32_32x32x16_bf16 v[160:175], v[212:215], v[216:219], v[160:175]
    ds_read_b128 v[240:243], v67 offset:16384
    ds_write_b128 v49, v[44:47] offset:2048
    v_mfma_f32_32x32x16_bf16 v[176:191], v[212:215], v[220:223], v[176:191]
    ds_read_b128 v[244:247], v67 offset:20480
    v_mfma_f32_32x32x16_bf16 v[192:207], v[212:215], v[224:227], v[192:207]
    s_waitcnt lgkmcnt(0)
    s_barrier
    v_mfma_f32_32x32x16_bf16 v[112:127], v[228:231], v[236:239], v[112:127]
    ds_read_b64_tr_b16 v[210:211], v76 offset:512
    ds_read_b64_tr_b16 v[208:209], v76 offset:0
    v_mfma_f32_32x32x16_bf16 v[128:143], v[228:231], v[240:243], v[128:143]
    ds_read_b64_tr_b16 v[214:215], v77 offset:512
    ds_read_b64_tr_b16 v[212:213], v77 offset:0
    s_add_u32 m0, s37, 16384
    s_add_u32 s51, s34, s36
    buffer_load_dwordx4 v2, s[8:11], s51 offen offset:0 nt lds
    v_mfma_f32_32x32x16_bf16 v[144:159], v[228:231], v[244:247], v[144:159]
    ds_read_b128 v[216:219], v64 offset:0
    v_mfma_f32_32x32x16_bf16 v[160:175], v[232:235], v[236:239], v[160:175]
    ds_read_b128 v[220:223], v64 offset:4096
    v_mfma_f32_32x32x16_bf16 v[176:191], v[232:235], v[240:243], v[176:191]
    ds_read_b128 v[224:227], v64 offset:8192
    s_add_u32 s36, s36, 16384
    s_and_b32 s36, s36, 0x3ffff
    buffer_load_dwordx4 v3, s[8:11], s51 offen offset:1024 nt lds
    v_mfma_f32_32x32x16_bf16 v[192:207], v[232:235], v[244:247], v[192:207]
    s_waitcnt lgkmcnt(0)
    v_mfma_f32_32x32x16_bf16 v[112:127], v[208:211], v[216:219], v[112:127]
    ds_read_b64_tr_b16 v[230:231], v76 offset:2560
    ds_read_b64_tr_b16 v[228:229], v76 offset:2048
    buffer_load_dwordx4 v4, s[8:11], s51 offen offset:2048 nt lds
    v_mfma_f32_32x32x16_bf16 v[128:143], v[208:211], v[220:223], v[128:143]
    ds_read_b64_tr_b16 v[234:235], v77 offset:2560
    ds_read_b64_tr_b16 v[232:233], v77 offset:2048
    v_mfma_f32_32x32x16_bf16 v[144:159], v[208:211], v[224:227], v[144:159]
    ds_read_b128 v[236:239], v65 offset:0
    buffer_load_dwordx4 v5, s[8:11], s51 offen offset:3072 nt lds
    v_mfma_f32_32x32x16_bf16 v[160:175], v[212:215], v[216:219], v[160:175]
    ds_read_b128 v[240:243], v65 offset:4096
    v_mfma_f32_32x32x16_bf16 v[176:191], v[212:215], v[220:223], v[176:191]
    ds_read_b128 v[244:247], v65 offset:8192
    s_add_u32 m0, s37, 20480
    s_add_u32 s51, s51, 4096
    buffer_load_dwordx4 v2, s[8:11], s51 offen offset:0 nt lds
    v_mfma_f32_32x32x16_bf16 v[192:207], v[212:215], v[224:227], v[192:207]
    s_waitcnt lgkmcnt(0)
    v_mfma_f32_32x32x16_bf16 v[112:127], v[228:231], v[236:239], v[112:127]
    ds_read_b64_tr_b16 v[210:211], v76 offset:4608
    ds_read_b64_tr_b16 v[208:209], v76 offset:4096
    v_mfma_f32_32x32x16_bf16 v[128:143], v[228:231], v[240:243], v[128:143]
    ds_read_b64_tr_b16 v[214:215], v77 offset:4608
    ds_read_b64_tr_b16 v[212:213], v77 offset:4096
    buffer_load_dwordx4 v3, s[8:11], s51 offen offset:1024 nt lds
    v_mfma_f32_32x32x16_bf16 v[144:159], v[228:231], v[244:247], v[144:159]
    ds_read_b128 v[216:219], v66 offset:0
    v_mfma_f32_32x32x16_bf16 v[160:175], v[232:235], v[236:239], v[160:175]
    ds_read_b128 v[220:223], v66 offset:4096
    buffer_load_dwordx4 v4, s[8:11], s51 offen offset:2048 nt lds
    v_mfma_f32_32x32x16_bf16 v[176:191], v[232:235], v[240:243], v[176:191]
    ds_read_b128 v[224:227], v66 offset:8192
    v_mfma_f32_32x32x16_bf16 v[192:207], v[232:235], v[244:247], v[192:207]
    buffer_load_dwordx4 v5, s[8:11], s51 offen offset:3072 nt lds
    s_waitcnt lgkmcnt(0)
    v_mfma_f32_32x32x16_bf16 v[112:127], v[208:211], v[216:219], v[112:127]
    ds_read_b64_tr_b16 v[230:231], v76 offset:6656
    ds_read_b64_tr_b16 v[228:229], v76 offset:6144
    v_mfma_f32_32x32x16_bf16 v[128:143], v[208:211], v[220:223], v[128:143]
    ds_read_b64_tr_b16 v[234:235], v77 offset:6656
    ds_read_b64_tr_b16 v[232:233], v77 offset:6144
    v_mfma_f32_32x32x16_bf16 v[144:159], v[208:211], v[224:227], v[144:159]
    ds_read_b128 v[236:239], v67 offset:0
    v_mfma_f32_32x32x16_bf16 v[160:175], v[212:215], v[216:219], v[160:175]
    ds_read_b128 v[240:243], v67 offset:4096
    v_mfma_f32_32x32x16_bf16 v[176:191], v[212:215], v[220:223], v[176:191]
    ds_read_b128 v[244:247], v67 offset:8192
    v_mfma_f32_32x32x16_bf16 v[192:207], v[212:215], v[224:227], v[192:207]
    s_waitcnt lgkmcnt(0)
    s_barrier
    v_mfma_f32_32x32x16_bf16 v[112:127], v[228:231], v[236:239], v[112:127]
    v_mfma_f32_32x32x16_bf16 v[128:143], v[228:231], v[240:243], v[128:143]
    v_mfma_f32_32x32x16_bf16 v[144:159], v[228:231], v[244:247], v[144:159]
    v_mfma_f32_32x32x16_bf16 v[160:175], v[232:235], v[236:239], v[160:175]
    v_mfma_f32_32x32x16_bf16 v[176:191], v[232:235], v[240:243], v[176:191]
    v_mfma_f32_32x32x16_bf16 v[192:207], v[232:235], v[244:247], v[192:207]
L_qcode:
    s_lshl_b32 s3, s6, 3
    s_cmp_eq_u32 s7, 1
    s_cbranch_scc1 L_qy
    v_xor_b32 v55, s3, v89
    v_lshlrev_b32 v55, 4, v55
    v_lshl_add_u32 v55, v91, 8, v55
    v_lshl_add_u32 v55, v90, 3, v55
    v_add_u32 v55, 98304, v55
    v_mov_b32 v62, s42
    v_xor_b32 v54, 0, v55
    s_add_u32 m0, s37, 0
    s_add_u32 s51, s34, s35
    buffer_load_dwordx4 v6, s[12:15], s51 offen offset:0 nt lds
    v_pk_mul_f32 v[112:113], v[112:113], v[62:63] op_sel_hi:[1,0]
    v_pk_mul_f32 v[114:115], v[114:115], v[62:63] op_sel_hi:[1,0]
    v_cvt_pk_bf16_f32 v56, v112, v113
    v_cvt_pk_bf16_f32 v57, v114, v115
    ds_write_b64 v54, v[56:57] offset:0
    v_pk_mul_f32 v[128:129], v[128:129], v[62:63] op_sel_hi:[1,0]
    v_pk_mul_f32 v[130:131], v[130:131], v[62:63] op_sel_hi:[1,0]
    v_cvt_pk_bf16_f32 v58, v128, v129
    v_cvt_pk_bf16_f32 v59, v130, v131
    ds_write_b64 v54, v[58:59] offset:8192
    v_pk_mul_f32 v[144:145], v[144:145], v[62:63] op_sel_hi:[1,0]
    v_pk_mul_f32 v[146:147], v[146:147], v[62:63] op_sel_hi:[1,0]
    v_cvt_pk_bf16_f32 v60, v144, v145
    v_cvt_pk_bf16_f32 v61, v146, v147
    ds_write_b64 v54, v[60:61] offset:16384
    v_xor_b32 v54, 16, v55
    s_add_u32 s35, s35, 16384
    s_and_b32 s35, s35, 0x3ffff
    buffer_load_dwordx4 v6, s[12:15], s51 offen offset:1024 nt lds
    v_pk_mul_f32 v[116:117], v[116:117], v[62:63] op_sel_hi:[1,0]
    v_pk_mul_f32 v[118:119], v[118:119], v[62:63] op_sel_hi:[1,0]
    v_cvt_pk_bf16_f32 v56, v116, v117
    v_cvt_pk_bf16_f32 v57, v118, v119
    ds_write_b64 v54, v[56:57] offset:0
    v_pk_mul_f32 v[132:133], v[132:133], v[62:63] op_sel_hi:[1,0]
    v_pk_mul_f32 v[134:135], v[134:135], v[62:63] op_sel_hi:[1,0]
    v_cvt_pk_bf16_f32 v58, v132, v133
    v_cvt_pk_bf16_f32 v59, v134, v135
    ds_write_b64 v54, v[58:59] offset:8192
    v_pk_mul_f32 v[148:149], v[148:149], v[62:63] op_sel_hi:[1,0]
    v_pk_mul_f32 v[150:151], v[150:151], v[62:63] op_sel_hi:[1,0]
    v_cvt_pk_bf16_f32 v60, v148, v149
    v_cvt_pk_bf16_f32 v61, v150, v151
    ds_write_b64 v54, v[60:61] offset:16384
    v_xor_b32 v54, 32, v55
    buffer_load_dwordx4 v6, s[12:15], s51 offen offset:2048 nt lds
    v_pk_mul_f32 v[120:121], v[120:121], v[62:63] op_sel_hi:[1,0]
    v_pk_mul_f32 v[122:123], v[122:123], v[62:63] op_sel_hi:[1,0]
    v_cvt_pk_bf16_f32 v56, v120, v121
    v_cvt_pk_bf16_f32 v57, v122, v123
    ds_write_b64 v54, v[56:57] offset:0
    v_pk_mul_f32 v[136:137], v[136:137], v[62:63] op_sel_hi:[1,0]
    v_pk_mul_f32 v[138:139], v[138:139], v[62:63] op_sel_hi:[1,0]
    v_cvt_pk_bf16_f32 v58, v136, v137
    v_cvt_pk_bf16_f32 v59, v138, v139
    ds_write_b64 v54, v[58:59] offset:8192
    v_pk_mul_f32 v[152:153], v[152:153], v[62:63] op_sel_hi:[1,0]
    v_pk_mul_f32 v[154:155], v[154:155], v[62:63] op_sel_hi:[1,0]
    v_cvt_pk_bf16_f32 v60, v152, v153
    v_cvt_pk_bf16_f32 v61, v154, v155
    ds_write_b64 v54, v[60:61] offset:16384
    v_xor_b32 v54, 48, v55
    buffer_load_dwordx4 v6, s[12:15], s51 offen offset:3072 nt lds
    v_pk_mul_f32 v[124:125], v[124:125], v[62:63] op_sel_hi:[1,0]
    v_pk_mul_f32 v[126:127], v[126:127], v[62:63] op_sel_hi:[1,0]
    v_cvt_pk_bf16_f32 v56, v124, v125
    v_cvt_pk_bf16_f32 v57, v126, v127
    ds_write_b64 v54, v[56:57] offset:0
    v_pk_mul_f32 v[140:141], v[140:141], v[62:63] op_sel_hi:[1,0]
    v_pk_mul_f32 v[142:143], v[142:143], v[62:63] op_sel_hi:[1,0]
    v_cvt_pk_bf16_f32 v58, v140, v141
    v_cvt_pk_bf16_f32 v59, v142, v143
    ds_write_b64 v54, v[58:59] offset:8192
    v_pk_mul_f32 v[156:157], v[156:157], v[62:63] op_sel_hi:[1,0]
    v_pk_mul_f32 v[158:159], v[158:159], v[62:63] op_sel_hi:[1,0]
    v_cvt_pk_bf16_f32 v60, v156, v157
    v_cvt_pk_bf16_f32 v61, v158, v159
    ds_write_b64 v54, v[60:61] offset:16384
    v_xor_b32 v54, 64, v55
    s_add_u32 m0, s37, 4096
    s_add_u32 s51, s51, 4096
    buffer_load_dwordx4 v6, s[12:15], s51 offen offset:0 nt lds
    v_pk_mul_f32 v[160:161], v[160:161], v[62:63] op_sel_hi:[1,0]
    v_pk_mul_f32 v[162:163], v[162:163], v[62:63] op_sel_hi:[1,0]
    v_cvt_pk_bf16_f32 v56, v160, v161
    v_cvt_pk_bf16_f32 v57, v162, v163
    ds_write_b64 v54, v[56:57] offset:0
    v_pk_mul_f32 v[176:177], v[176:177], v[62:63] op_sel_hi:[1,0]
    v_pk_mul_f32 v[178:179], v[178:179], v[62:63] op_sel_hi:[1,0]
    v_cvt_pk_bf16_f32 v58, v176, v177
    v_cvt_pk_bf16_f32 v59, v178, v179
    ds_write_b64 v54, v[58:59] offset:8192
    v_pk_mul_f32 v[192:193], v[192:193], v[62:63] op_sel_hi:[1,0]
    v_pk_mul_f32 v[194:195], v[194:195], v[62:63] op_sel_hi:[1,0]
    v_cvt_pk_bf16_f32 v60, v192, v193
    v_cvt_pk_bf16_f32 v61, v194, v195
    ds_write_b64 v54, v[60:61] offset:16384
    v_xor_b32 v54, 80, v55
    buffer_load_dwordx4 v6, s[12:15], s51 offen offset:1024 nt lds
    v_pk_mul_f32 v[164:165], v[164:165], v[62:63] op_sel_hi:[1,0]
    v_pk_mul_f32 v[166:167], v[166:167], v[62:63] op_sel_hi:[1,0]
    v_cvt_pk_bf16_f32 v56, v164, v165
    v_cvt_pk_bf16_f32 v57, v166, v167
    ds_write_b64 v54, v[56:57] offset:0
    v_pk_mul_f32 v[180:181], v[180:181], v[62:63] op_sel_hi:[1,0]
    v_pk_mul_f32 v[182:183], v[182:183], v[62:63] op_sel_hi:[1,0]
    v_cvt_pk_bf16_f32 v58, v180, v181
    v_cvt_pk_bf16_f32 v59, v182, v183
    ds_write_b64 v54, v[58:59] offset:8192
    v_pk_mul_f32 v[196:197], v[196:197], v[62:63] op_sel_hi:[1,0]
    v_pk_mul_f32 v[198:199], v[198:199], v[62:63] op_sel_hi:[1,0]
    v_cvt_pk_bf16_f32 v60, v196, v197
    v_cvt_pk_bf16_f32 v61, v198, v199
    ds_write_b64 v54, v[60:61] offset:16384
    v_xor_b32 v54, 96, v55
    buffer_load_dwordx4 v6, s[12:15], s51 offen offset:2048 nt lds
    v_pk_mul_f32 v[168:169], v[168:169], v[62:63] op_sel_hi:[1,0]
    v_pk_mul_f32 v[170:171], v[170:171], v[62:63] op_sel_hi:[1,0]
    v_cvt_pk_bf16_f32 v56, v168, v169
    v_cvt_pk_bf16_f32 v57, v170, v171
    ds_write_b64 v54, v[56:57] offset:0
    v_pk_mul_f32 v[184:185], v[184:185], v[62:63] op_sel_hi:[1,0]
    v_pk_mul_f32 v[186:187], v[186:187], v[62:63] op_sel_hi:[1,0]
    v_cvt_pk_bf16_f32 v58, v184, v185
    v_cvt_pk_bf16_f32 v59, v186, v187
    ds_write_b64 v54, v[58:59] offset:8192
    v_pk_mul_f32 v[200:201], v[200:201], v[62:63] op_sel_hi:[1,0]
    v_pk_mul_f32 v[202:203], v[202:203], v[62:63] op_sel_hi:[1,0]
    v_cvt_pk_bf16_f32 v60, v200, v201
    v_cvt_pk_bf16_f32 v61, v202, v203
    ds_write_b64 v54, v[60:61] offset:16384
    v_xor_b32 v54, 112, v55
    buffer_load_dwordx4 v6, s[12:15], s51 offen offset:3072 nt lds
    v_pk_mul_f32 v[172:173], v[172:173], v[62:63] op_sel_hi:[1,0]
    v_pk_mul_f32 v[174:175], v[174:175], v[62:63] op_sel_hi:[1,0]
    v_cvt_pk_bf16_f32 v56, v172, v173
    v_cvt_pk_bf16_f32 v57, v174, v175
    ds_write_b64 v54, v[56:57] offset:0
    v_pk_mul_f32 v[188:189], v[188:189], v[62:63] op_sel_hi:[1,0]
    v_pk_mul_f32 v[190:191], v[190:191], v[62:63] op_sel_hi:[1,0]
    v_cvt_pk_bf16_f32 v58, v188, v189
    v_cvt_pk_bf16_f32 v59, v190, v191
    ds_write_b64 v54, v[58:59] offset:8192
    v_pk_mul_f32 v[204:205], v[204:205], v[62:63] op_sel_hi:[1,0]
    v_pk_mul_f32 v[206:207], v[206:207], v[62:63] op_sel_hi:[1,0]
    v_cvt_pk_bf16_f32 v60, v204, v205
    v_cvt_pk_bf16_f32 v61, v206, v207
    ds_write_b64 v54, v[60:61] offset:16384
    s_waitcnt lgkmcnt(0)
    s_barrier
    s_sub_u32 s3, 98304, s37
    v_add_u32 v32, s3, v8
    v_add_u32 v33, s3, v9
    v_add_u32 v34, s3, v10
    v_add_u32 v35, s3, v11
    v_add_u32 v36, s3, v12
    v_add_u32 v37, s3, v13
    v_add_u32 v38, s3, v14
    v_add_u32 v39, s3, v15
    ds_read_b128 v[160:163], v32 offset:0
    ds_read_b128 v[164:167], v33 offset:0
    ds_read_b128 v[168:171], v34 offset:0
    ds_read_b128 v[172:175], v35 offset:0
    ds_read_b128 v[176:179], v36 offset:0
    ds_read_b128 v[180:183], v37 offset:0
    ds_read_b128 v[184:187], v38 offset:0
    ds_read_b128 v[188:191], v39 offset:0
    ds_read_b128 v[192:195], v32 offset:8192
    ds_read_b128 v[196:199], v33 offset:8192
    ds_read_b128 v[200:203], v34 offset:8192
    ds_read_b128 v[204:207], v35 offset:8192
    ds_read_b128 v[208:211], v36 offset:8192
    ds_read_b128 v[212:215], v37 offset:8192
    ds_read_b128 v[216:219], v38 offset:8192
    ds_read_b128 v[220:223], v39 offset:8192
    ds_read_b128 v[224:227], v32 offset:16384
    ds_read_b128 v[228:231], v33 offset:16384
    ds_read_b128 v[232:235], v34 offset:16384
    ds_read_b128 v[236:239], v35 offset:16384
    ds_read_b128 v[240:243], v36 offset:16384
    ds_read_b128 v[244:247], v37 offset:16384
    ds_read_b128 v[248:251], v38 offset:16384
    ds_read_b128 v[252:255], v39 offset:16384
    s_waitcnt lgkmcnt(0)
    s_barrier
    s_branch L_qdone
L_qy:
    s_add_u32 m0, s37, 0
    s_add_u32 s51, s34, s35
    buffer_load_dwordx4 v6, s[12:15], s51 offen offset:0 nt lds
    s_add_u32 s35, s35, 16384
    s_and_b32 s35, s35, 0x3ffff
    buffer_load_dwordx4 v6, s[12:15], s51 offen offset:1024 nt lds
    buffer_load_dwordx4 v6, s[12:15], s51 offen offset:2048 nt lds
    buffer_load_dwordx4 v6, s[12:15], s51 offen offset:3072 nt lds
    s_add_u32 m0, s37, 4096
    s_add_u32 s51, s51, 4096
    buffer_load_dwordx4 v6, s[12:15], s51 offen offset:0 nt lds
    buffer_load_dwordx4 v6, s[12:15], s51 offen offset:1024 nt lds
    buffer_load_dwordx4 v6, s[12:15], s51 offen offset:2048 nt lds
    buffer_load_dwordx4 v6, s[12:15], s51 offen offset:3072 nt lds
    s_barrier
    s_barrier
    s_lshl_b32 s3, s6, 3
    v_xor_b32 v55, s3, v89
    v_lshlrev_b32 v55, 4, v55
    v_lshl_add_u32 v55, v91, 8, v55
    v_lshl_add_u32 v55, v90, 3, v55
    v_add_u32 v55, 98304, v55
    v_mov_b32 v62, s42
    v_xor_b32 v54, 0, v55
    v_pk_mul_f32 v[112:113], v[112:113], v[62:63] op_sel_hi:[1,0]
    v_pk_mul_f32 v[114:115], v[114:115], v[62:63] op_sel_hi:[1,0]
    v_cvt_pk_bf16_f32 v56, v112, v113
    v_cvt_pk_bf16_f32 v57, v114, v115
    ds_write_b64 v54, v[56:57] offset:0
    v_pk_mul_f32 v[128:129], v[128:129], v[62:63] op_sel_hi:[1,0]
    v_pk_mul_f32 v[130:131], v[130:131], v[62:63] op_sel_hi:[1,0]
    v_cvt_pk_bf16_f32 v58, v128, v129
    v_cvt_pk_bf16_f32 v59, v130, v131
    ds_write_b64 v54, v[58:59] offset:8192
    v_pk_mul_f32 v[144:145], v[144:145], v[62:63] op_sel_hi:[1,0]
    v_pk_mul_f32 v[146:147], v[146:147], v[62:63] op_sel_hi:[1,0]
    v_cvt_pk_bf16_f32 v60, v144, v145
    v_cvt_pk_bf16_f32 v61, v146, v147
    ds_write_b64 v54, v[60:61] offset:16384
    v_xor_b32 v54, 16, v55
    v_pk_mul_f32 v[116:117], v[116:117], v[62:63] op_sel_hi:[1,0]
    v_pk_mul_f32 v[118:119], v[118:119], v[62:63] op_sel_hi:[1,0]
    v_cvt_pk_bf16_f32 v56, v116, v117
    v_cvt_pk_bf16_f32 v57, v118, v119
    ds_write_b64 v54, v[56:57] offset:0
    v_pk_mul_f32 v[132:133], v[132:133], v[62:63] op_sel_hi:[1,0]
    v_pk_mul_f32 v[134:135], v[134:135], v[62:63] op_sel_hi:[1,0]
    v_cvt_pk_bf16_f32 v58, v132, v133
    v_cvt_pk_bf16_f32 v59, v134, v135
    ds_write_b64 v54, v[58:59] offset:8192
    v_pk_mul_f32 v[148:149], v[148:149], v[62:63] op_sel_hi:[1,0]
    v_pk_mul_f32 v[150:151], v[150:151], v[62:63] op_sel_hi:[1,0]
    v_cvt_pk_bf16_f32 v60, v148, v149
    v_cvt_pk_bf16_f32 v61, v150, v151
    ds_write_b64 v54, v[60:61] offset:16384
    v_xor_b32 v54, 32, v55
    v_pk_mul_f32 v[120:121], v[120:121], v[62:63] op_sel_hi:[1,0]
    v_pk_mul_f32 v[122:123], v[122:123], v[62:63] op_sel_hi:[1,0]
    v_cvt_pk_bf16_f32 v56, v120, v121
    v_cvt_pk_bf16_f32 v57, v122, v123
    ds_write_b64 v54, v[56:57] offset:0
    v_pk_mul_f32 v[136:137], v[136:137], v[62:63] op_sel_hi:[1,0]
    v_pk_mul_f32 v[138:139], v[138:139], v[62:63] op_sel_hi:[1,0]
    v_cvt_pk_bf16_f32 v58, v136, v137
    v_cvt_pk_bf16_f32 v59, v138, v139
    ds_write_b64 v54, v[58:59] offset:8192
    v_pk_mul_f32 v[152:153], v[152:153], v[62:63] op_sel_hi:[1,0]
    v_pk_mul_f32 v[154:155], v[154:155], v[62:63] op_sel_hi:[1,0]
    v_cvt_pk_bf16_f32 v60, v152, v153
    v_cvt_pk_bf16_f32 v61, v154, v155
    ds_write_b64 v54, v[60:61] offset:16384
    v_xor_b32 v54, 48, v55
    v_pk_mul_f32 v[124:125], v[124:125], v[62:63] op_sel_hi:[1,0]
    v_pk_mul_f32 v[126:127], v[126:127], v[62:63] op_sel_hi:[1,0]
    v_cvt_pk_bf16_f32 v56, v124, v125
    v_cvt_pk_bf16_f32 v57, v126, v127
    ds_write_b64 v54, v[56:57] offset:0
    v_pk_mul_f32 v[140:141], v[140:141], v[62:63] op_sel_hi:[1,0]
    v_pk_mul_f32 v[142:143], v[142:143], v[62:63] op_sel_hi:[1,0]
    v_cvt_pk_bf16_f32 v58, v140, v141
    v_cvt_pk_bf16_f32 v59, v142, v143
    ds_write_b64 v54, v[58:59] offset:8192
    v_pk_mul_f32 v[156:157], v[156:157], v[62:63] op_sel_hi:[1,0]
    v_pk_mul_f32 v[158:159], v[158:159], v[62:63] op_sel_hi:[1,0]
    v_cvt_pk_bf16_f32 v60, v156, v157
    v_cvt_pk_bf16_f32 v61, v158, v159
    ds_write_b64 v54, v[60:61] offset:16384
    v_xor_b32 v54, 64, v55
    v_pk_mul_f32 v[160:161], v[160:161], v[62:63] op_sel_hi:[1,0]
    v_pk_mul_f32 v[162:163], v[162:163], v[62:63] op_sel_hi:[1,0]
    v_cvt_pk_bf16_f32 v56, v160, v161
    v_cvt_pk_bf16_f32 v57, v162, v163
    ds_write_b64 v54, v[56:57] offset:0
    v_pk_mul_f32 v[176:177], v[176:177], v[62:63] op_sel_hi:[1,0]
    v_pk_mul_f32 v[178:179], v[178:179], v[62:63] op_sel_hi:[1,0]
    v_cvt_pk_bf16_f32 v58, v176, v177
    v_cvt_pk_bf16_f32 v59, v178, v179
    ds_write_b64 v54, v[58:59] offset:8192
    v_pk_mul_f32 v[192:193], v[192:193], v[62:63] op_sel_hi:[1,0]
    v_pk_mul_f32 v[194:195], v[194:195], v[62:63] op_sel_hi:[1,0]
    v_cvt_pk_bf16_f32 v60, v192, v193
    v_cvt_pk_bf16_f32 v61, v194, v195
    ds_write_b64 v54, v[60:61] offset:16384
    v_xor_b32 v54, 80, v55
    v_pk_mul_f32 v[164:165], v[164:165], v[62:63] op_sel_hi:[1,0]
    v_pk_mul_f32 v[166:167], v[166:167], v[62:63] op_sel_hi:[1,0]
    v_cvt_pk_bf16_f32 v56, v164, v165
    v_cvt_pk_bf16_f32 v57, v166, v167
    ds_write_b64 v54, v[56:57] offset:0
    v_pk_mul_f32 v[180:181], v[180:181], v[62:63] op_sel_hi:[1,0]
    v_pk_mul_f32 v[182:183], v[182:183], v[62:63] op_sel_hi:[1,0]
    v_cvt_pk_bf16_f32 v58, v180, v181
    v_cvt_pk_bf16_f32 v59, v182, v183
    ds_write_b64 v54, v[58:59] offset:8192
    v_pk_mul_f32 v[196:197], v[196:197], v[62:63] op_sel_hi:[1,0]
    v_pk_mul_f32 v[198:199], v[198:199], v[62:63] op_sel_hi:[1,0]
    v_cvt_pk_bf16_f32 v60, v196, v197
    v_cvt_pk_bf16_f32 v61, v198, v199
    ds_write_b64 v54, v[60:61] offset:16384
    v_xor_b32 v54, 96, v55
    v_pk_mul_f32 v[168:169], v[168:169], v[62:63] op_sel_hi:[1,0]
    v_pk_mul_f32 v[170:171], v[170:171], v[62:63] op_sel_hi:[1,0]
    v_cvt_pk_bf16_f32 v56, v168, v169
    v_cvt_pk_bf16_f32 v57, v170, v171
    ds_write_b64 v54, v[56:57] offset:0
    v_pk_mul_f32 v[184:185], v[184:185], v[62:63] op_sel_hi:[1,0]
    v_pk_mul_f32 v[186:187], v[186:187], v[62:63] op_sel_hi:[1,0]
    v_cvt_pk_bf16_f32 v58, v184, v185
    v_cvt_pk_bf16_f32 v59, v186, v187
    ds_write_b64 v54, v[58:59] offset:8192
    v_pk_mul_f32 v[200:201], v[200:201], v[62:63] op_sel_hi:[1,0]
    v_pk_mul_f32 v[202:203], v[202:203], v[62:63] op_sel_hi:[1,0]
    v_cvt_pk_bf16_f32 v60, v200, v201
    v_cvt_pk_bf16_f32 v61, v202, v203
    ds_write_b64 v54, v[60:61] offset:16384
    v_xor_b32 v54, 112, v55
    v_pk_mul_f32 v[172:173], v[172:173], v[62:63] op_sel_hi:[1,0]
    v_pk_mul_f32 v[174:175], v[174:175], v[62:63] op_sel_hi:[1,0]
    v_cvt_pk_bf16_f32 v56, v172, v173
    v_cvt_pk_bf16_f32 v57, v174, v175
    ds_write_b64 v54, v[56:57] offset:0
    v_pk_mul_f32 v[188:189], v[188:189], v[62:63] op_sel_hi:[1,0]
    v_pk_mul_f32 v[190:191], v[190:191], v[62:63] op_sel_hi:[1,0]
    v_cvt_pk_bf16_f32 v58, v188, v189
    v_cvt_pk_bf16_f32 v59, v190, v191
    ds_write_b64 v54, v[58:59] offset:8192
    v_pk_mul_f32 v[204:205], v[204:205], v[62:63] op_sel_hi:[1,0]
    v_pk_mul_f32 v[206:207], v[206:207], v[62:63] op_sel_hi:[1,0]
    v_cvt_pk_bf16_f32 v60, v204, v205
    v_cvt_pk_bf16_f32 v61, v206, v207
    ds_write_b64 v54, v[60:61] offset:16384
    s_waitcnt lgkmcnt(0)
    s_add_u32 s44, s44, 1
    v_mov_b32 v111, s44
    ds_write_b32 v109, v111
    s_mov_b32 s47, 0x400000
L_ps1:
    ds_read_b32 v111, v110
    s_sub_u32 s47, s47, 1
    s_waitcnt lgkmcnt(0)
    v_readfirstlane_b32 s3, v111
    s_cmp_eq_u32 s47, 0
    s_cselect_b32 s3, s44, s3
    s_cmp_lt_u32 s3, s44
    s_cbranch_scc1 L_ps1
    s_sub_u32 s3, 98304, s37
    v_add_u32 v32, s3, v8
    v_add_u32 v33, s3, v9
    v_add_u32 v34, s3, v10
    v_add_u32 v35, s3, v11
    v_add_u32 v36, s3, v12
    v_add_u32 v37, s3, v13
    v_add_u32 v38, s3, v14
    v_add_u32 v39, s3, v15
    ds_read_b128 v[160:163], v32 offset:0
    ds_read_b128 v[164:167], v33 offset:0
    ds_read_b128 v[168:171], v34 offset:0
    ds_read_b128 v[172:175], v35 offset:0
    ds_read_b128 v[176:179], v36 offset:0
    ds_read_b128 v[180:183], v37 offset:0
    ds_read_b128 v[184:187], v38 offset:0
    ds_read_b128 v[188:191], v39 offset:0
    ds_read_b128 v[192:195], v32 offset:8192
    ds_read_b128 v[196:199], v33 offset:8192
    ds_read_b128 v[200:203], v34 offset:8192
    ds_read_b128 v[204:207], v35 offset:8192
    ds_read_b128 v[208:211], v36 offset:8192
    ds_read_b128 v[212:215], v37 offset:8192
    ds_read_b128 v[216:219], v38 offset:8192
    ds_read_b128 v[220:223], v39 offset:8192
    ds_read_b128 v[224:227], v32 offset:16384
    ds_read_b128 v[228:231], v33 offset:16384
    ds_read_b128 v[232:235], v34 offset:16384
    ds_read_b128 v[236:239], v35 offset:16384
    ds_read_b128 v[240:243], v36 offset:16384
    ds_read_b128 v[244:247], v37 offset:16384
    ds_read_b128 v[248:251], v38 offset:16384
    ds_read_b128 v[252:255], v39 offset:16384
L_qdone:
    s_waitcnt lgkmcnt(0)
    ds_read_b128 a[192:195], v8 offset:32768
    ds_read_b128 a[196:199], v9 offset:32768
    ds_read_b128 a[200:203], v10 offset:32768
    ds_read_b128 a[204:207], v11 offset:32768
    ds_read_b128 a[208:211], v12 offset:32768
    ds_read_b128 a[212:215], v13 offset:32768
    ds_read_b128 a[216:219], v14 offset:32768
    ds_read_b128 a[220:223], v15 offset:32768
    v_mov_b32 v26, 162832
    s_cmp_eq_u32 s7, 1
    s_cselect_b32 s50, 20, 0
    s_cselect_b32 s38, 20, -1
    s_lshl_b32 s50, s7, 1
    s_add_u32 s50, s50, 2
    s_sub_u32 s50, s50, s29
    s_mov_b32 s38, s50
    s_waitcnt lgkmcnt(0)
    v_mfma_f32_32x32x16_bf16 v[112:127], a[192:195], v[160:163], 0
    v_mfma_f32_32x32x16_bf16 v[112:127], a[196:199], v[164:167], v[112:127]
    s_add_u32 m0, s37, 32768
    s_add_u32 s51, s34, s36
    s_cmp_le_u32 s50, 0
    s_cbranch_scc1 L_cap1
    s_waitcnt vmcnt(5)
    s_cmp_le_u32 s50, 2
    s_cbranch_scc1 L_cap1
    s_waitcnt vmcnt(4)
L_cap1:
    buffer_load_dwordx4 v2, s[8:11], s51 offen offset:0 nt lds
    v_mfma_f32_32x32x16_bf16 v[112:127], a[200:203], v[168:171], v[112:127]
    v_mfma_f32_32x32x16_bf16 v[112:127], a[204:207], v[172:175], v[112:127]
    v_mfma_f32_32x32x16_bf16 v[112:127], a[208:211], v[176:179], v[112:127]
    s_add_u32 s36, s36, 16384
    s_and_b32 s36, s36, 0x3ffff
    s_cmp_le_u32 s50, 0
    s_cbranch_scc1 L_cap2
    s_waitcnt vmcnt(5)
    s_cmp_le_u32 s50, 2
    s_cbranch_scc1 L_cap2
    s_waitcnt vmcnt(4)
L_cap2:
    buffer_load_dwordx4 v3, s[8:11], s51 offen offset:1024 nt lds
    v_mfma_f32_32x32x16_bf16 v[112:127], a[212:215], v[180:183], v[112:127]
    v_mfma_f32_32x32x16_bf16 v[112:127], a[216:219], v[184:187], v[112:127]
    v_mfma_f32_32x32x16_bf16 v[112:127], a[220:223], v[188:191], v[112:127]
    s_cmp_le_u32 s50, 0
    s_cbranch_scc1 L_cap3
    s_waitcnt vmcnt(6)
    s_cmp_le_u32 s50, 2
    s_cbranch_scc1 L_cap3
    s_waitcnt vmcnt(4)
L_cap3:
    buffer_load_dwordx4 v4, s[8:11], s51 offen offset:2048 nt lds
    s_cmp_le_u32 s50, 0
    s_cbranch_scc1 L_cap4
    s_waitcnt vmcnt(5)
    s_cmp_le_u32 s50, 2
    s_cbranch_scc1 L_cap4
    s_waitcnt vmcnt(4)
L_cap4:
    buffer_load_dwordx4 v5, s[8:11], s51 offen offset:3072 nt lds
    s_nop 5
    v_max3_f32 v23, v112, v113, v114
    v_max3_f32 v23, v23, v115, v116
    v_max3_f32 v23, v23, v117, v118
    v_max3_f32 v23, v23, v119, v120
    v_max3_f32 v23, v23, v121, v122
    v_max3_f32 v23, v23, v123, v124
    v_max3_f32 v23, v23, v125, v126
    v_max_f32 v23, v23, v127
    v_mov_b32 v84, v23
    s_nop 1
    v_permlane32_swap_b32 v23, v84
    v_max_f32 v23, v23, v84
    v_sub_f32 v32, 0, v23
    v_sub_f32 v33, 0, v23
    v_sub_f32 v34, 0, v23
    v_sub_f32 v35, 0, v23
    v_sub_f32 v36, 0, v23
    v_sub_f32 v37, 0, v23
    v_sub_f32 v38, 0, v23
    v_sub_f32 v39, 0, v23
    v_sub_f32 v40, 0, v23
    v_sub_f32 v41, 0, v23
    v_sub_f32 v42, 0, v23
    v_sub_f32 v43, 0, v23
    v_sub_f32 v44, 0, v23
    s_add_u32 m0, s37, 36864
    s_add_u32 s51, s51, 4096
    s_cmp_le_u32 s50, 0
    s_cbranch_scc1 L_cap5
    s_waitcnt vmcnt(5)
    s_cmp_le_u32 s50, 2
    s_cbranch_scc1 L_cap5
    s_waitcnt vmcnt(4)
L_cap5:
    buffer_load_dwordx4 v2, s[8:11], s51 offen offset:0 nt lds
    v_sub_f32 v45, 0, v23
    v_sub_f32 v46, 0, v23
    v_sub_f32 v47, 0, v23
    v_sub_f32 v112, v112, v23
    v_sub_f32 v113, v113, v23
    v_sub_f32 v114, v114, v23
    v_sub_f32 v115, v115, v23
    v_sub_f32 v116, v116, v23
    v_sub_f32 v117, v117, v23
    v_sub_f32 v118, v118, v23
    v_sub_f32 v119, v119, v23
    v_sub_f32 v120, v120, v23
    v_sub_f32 v121, v121, v23
    v_sub_f32 v122, v122, v23
    v_sub_f32 v123, v123, v23
    v_sub_f32 v124, v124, v23
    v_sub_f32 v125, v125, v23
    v_sub_f32 v126, v126, v23
    v_sub_f32 v127, v127, v23
    v_exp_f32 v112, v112
    v_mfma_f32_32x32x16_bf16 v[128:143], a[192:195], v[192:195], 0
    s_cmp_le_u32 s50, 0
    s_cbranch_scc1 L_cap6
    s_waitcnt vmcnt(6)
    s_cmp_le_u32 s50, 2
    s_cbranch_scc1 L_cap6
    s_waitcnt vmcnt(4)
L_cap6:
    buffer_load_dwordx4 v3, s[8:11], s51 offen offset:1024 nt lds
    s_waitcnt vmcnt(22)
    ds_read_b64_tr_b16 a[224:225], v28 offset:0
    ds_read_b64_tr_b16 a[226:227], v28 offset:2048
    v_mfma_f32_32x32x16_bf16 v[128:143], a[196:199], v[196:199], v[128:143]
    ds_read_b64_tr_b16 a[232:233], v29 offset:0
    ds_read_b64_tr_b16 a[234:235], v29 offset:2048
    ds_read_b64_tr_b16 a[240:241], v30 offset:0
    v_exp_f32 v113, v113
    v_exp_f32 v114, v114
    v_exp_f32 v115, v115
    v_add_f32 v20, v20, v112
    v_mfma_f32_32x32x16_bf16 v[128:143], a[200:203], v[200:203], v[128:143]
    ds_read_b64_tr_b16 a[242:243], v30 offset:2048
    ds_read_b64_tr_b16 a[248:249], v31 offset:0
    v_add_f32 v20, v20, v113
    v_cvt_pk_bf16_f32 v112, v112, v113
    v_exp_f32 v116, v116
    v_exp_f32 v117, v117
    v_add_f32 v20, v20, v114
    v_add_f32 v20, v20, v115
    v_mfma_f32_32x32x16_bf16 v[128:143], a[204:207], v[204:207], v[128:143]
    s_cmp_le_u32 s50, 0
    s_cbranch_scc1 L_cap7
    s_waitcnt vmcnt(5)
    s_cmp_le_u32 s50, 2
    s_cbranch_scc1 L_cap7
    s_waitcnt vmcnt(4)
L_cap7:
    buffer_load_dwordx4 v4, s[8:11], s51 offen offset:2048 nt lds
    ds_read_b64_tr_b16 a[250:251], v31 offset:2048
    ds_read_b64_tr_b16 a[228:229], v28 offset:4096
    ds_read_b64_tr_b16 a[230:231], v28 offset:6144
    v_cvt_pk_bf16_f32 v113, v114, v115
    v_mfma_f32_32x32x16_bf16 v[128:143], a[208:211], v[208:211], v[128:143]
    ds_read_b64_tr_b16 a[236:237], v29 offset:4096
    ds_read_b64_tr_b16 a[238:239], v29 offset:6144
    ds_read_b64_tr_b16 a[244:245], v30 offset:4096
    v_exp_f32 v118, v118
    v_exp_f32 v119, v119
    v_add_f32 v20, v20, v116
    v_add_f32 v20, v20, v117
    v_cvt_pk_bf16_f32 v114, v116, v117
    v_mfma_f32_32x32x16_bf16 v[128:143], a[212:215], v[212:215], v[128:143]
    ds_read_b64_tr_b16 a[246:247], v30 offset:6144
    ds_read_b64_tr_b16 a[252:253], v31 offset:4096
    ds_read_b64_tr_b16 a[254:255], v31 offset:6144
    v_exp_f32 v120, v120
    v_exp_f32 v121, v121
    v_add_f32 v20, v20, v118
    v_add_f32 v20, v20, v119
    v_cvt_pk_bf16_f32 v115, v118, v119
    v_mfma_f32_32x32x16_bf16 v[128:143], a[216:219], v[216:219], v[128:143]
    s_cmp_le_u32 s50, 0
    s_cbranch_scc1 L_cap8
    s_waitcnt vmcnt(5)
    s_cmp_le_u32 s50, 2
    s_cbranch_scc1 L_cap8
    s_waitcnt vmcnt(4)
L_cap8:
    buffer_load_dwordx4 v5, s[8:11], s51 offen offset:3072 nt lds
    v_exp_f32 v122, v122
    v_exp_f32 v123, v123
    v_mfma_f32_32x32x16_bf16 v[128:143], a[220:223], v[220:223], v[128:143]
    v_add_f32 v20, v20, v120
    v_add_f32 v20, v20, v121
    v_cvt_pk_bf16_f32 v120, v120, v121
    v_exp_f32 v124, v124
    v_exp_f32 v125, v125
    v_add_f32 v20, v20, v122
    v_add_f32 v20, v20, v123
    v_cvt_pk_bf16_f32 v121, v122, v123
    s_waitcnt lgkmcnt(0)
    v_mfma_f32_32x32x16_bf16 a[0:15], a[224:227], v[112:115], 0
    v_exp_f32 v126, v126
    v_exp_f32 v127, v127
    v_add_f32 v20, v20, v124
    v_add_f32 v20, v20, v125
    v_cvt_pk_bf16_f32 v122, v124, v125
    v_add_f32 v20, v20, v126
    v_add_f32 v20, v20, v127
    v_cvt_pk_bf16_f32 v123, v126, v127
    v_mfma_f32_32x32x16_bf16 a[48:63], a[232:235], v[112:115], 0
    v_mfma_f32_32x32x16_bf16 a[96:111], a[240:243], v[112:115], 0
    v_max3_f32 v24, v128, v129, v130
    v_max3_f32 v24, v24, v131, v132
    v_max3_f32 v24, v24, v133, v134
    v_max3_f32 v24, v24, v135, v136
    v_max3_f32 v24, v24, v137, v138
    v_max3_f32 v24, v24, v139, v140
    v_max3_f32 v24, v24, v141, v142
    v_mfma_f32_32x32x16_bf16 a[144:159], a[248:251], v[112:115], 0
    v_max_f32 v24, v24, v143
    v_mov_b32 v84, v24
    s_nop 1
    v_permlane32_swap_b32 v24, v84
    v_max_f32 v24, v24, v84
    v_sub_f32 v48, 0, v24
    v_sub_f32 v49, 0, v24
    v_sub_f32 v50, 0, v24
    v_mfma_f32_32x32x16_bf16 a[0:15], a[228:231], v[120:123], a[0:15]
    v_sub_f32 v51, 0, v24
    v_sub_f32 v52, 0, v24
    v_sub_f32 v53, 0, v24
    v_sub_f32 v54, 0, v24
    v_sub_f32 v55, 0, v24
    v_sub_f32 v56, 0, v24
    v_sub_f32 v57, 0, v24
    v_mfma_f32_32x32x16_bf16 a[48:63], a[236:239], v[120:123], a[48:63]
    v_sub_f32 v58, 0, v24
    v_sub_f32 v59, 0, v24
    v_sub_f32 v60, 0, v24
    v_sub_f32 v61, 0, v24
    v_sub_f32 v62, 0, v24
    v_sub_f32 v63, 0, v24
    v_sub_f32 v128, v128, v24
    v_mfma_f32_32x32x16_bf16 a[96:111], a[244:247], v[120:123], a[96:111]
    v_sub_f32 v129, v129, v24
    v_sub_f32 v130, v130, v24
    v_sub_f32 v131, v131, v24
    v_sub_f32 v132, v132, v24
    v_sub_f32 v133, v133, v24
    v_sub_f32 v134, v134, v24
    v_sub_f32 v135, v135, v24
    v_mfma_f32_32x32x16_bf16 a[144:159], a[252:255], v[120:123], a[144:159]
    v_sub_f32 v136, v136, v24
    v_sub_f32 v137, v137, v24
    v_sub_f32 v138, v138, v24
    v_sub_f32 v139, v139, v24
    v_sub_f32 v140, v140, v24
    v_sub_f32 v141, v141, v24
    v_sub_f32 v142, v142, v24
    v_mfma_f32_32x32x16_bf16 v[144:159], a[192:195], v[224:227], 0
    v_sub_f32 v143, v143, v24
    v_exp_f32 v128, v128
    v_exp_f32 v129, v129
    v_exp_f32 v130, v130
    v_mfma_f32_32x32x16_bf16 v[144:159], a[196:199], v[228:231], v[144:159]
    v_exp_f32 v131, v131
    v_add_f32 v21, v21, v128
    v_add_f32 v21, v21, v129
    v_cvt_pk_bf16_f32 v128, v128, v129
    v_exp_f32 v132, v132
    v_mfma_f32_32x32x16_bf16 v[144:159], a[200:203], v[232:235], v[144:159]
    v_exp_f32 v133, v133
    v_add_f32 v21, v21, v130
    v_add_f32 v21, v21, v131
    v_cvt_pk_bf16_f32 v129, v130, v131
    v_exp_f32 v134, v134
    v_mfma_f32_32x32x16_bf16 v[144:159], a[204:207], v[236:239], v[144:159]
    v_exp_f32 v135, v135
    v_add_f32 v21, v21, v132
    v_add_f32 v21, v21, v133
    v_cvt_pk_bf16_f32 v130, v132, v133
    v_exp_f32 v136, v136
    v_mfma_f32_32x32x16_bf16 v[144:159], a[208:211], v[240:243], v[144:159]
    v_exp_f32 v137, v137
    v_add_f32 v21, v21, v134
    v_add_f32 v21, v21, v135
    v_cvt_pk_bf16_f32 v131, v134, v135
    v_exp_f32 v138, v138
    v_mfma_f32_32x32x16_bf16 v[144:159], a[212:215], v[244:247], v[144:159]
    v_exp_f32 v139, v139
    v_add_f32 v21, v21, v136
    v_add_f32 v21, v21, v137
    v_cvt_pk_bf16_f32 v136, v136, v137
    v_exp_f32 v140, v140
    v_mfma_f32_32x32x16_bf16 v[144:159], a[216:219], v[248:251], v[144:159]
    v_exp_f32 v141, v141
    v_add_f32 v21, v21, v138
    v_add_f32 v21, v21, v139
    v_cvt_pk_bf16_f32 v137, v138, v139
    v_exp_f32 v142, v142
    v_mfma_f32_32x32x16_bf16 v[144:159], a[220:223], v[252:255], v[144:159]
    v_exp_f32 v143, v143
    v_add_f32 v21, v21, v140
    v_add_f32 v21, v21, v141
    v_cvt_pk_bf16_f32 v138, v140, v141
    v_add_f32 v21, v21, v142
    v_add_f32 v21, v21, v143
    v_mfma_f32_32x32x16_bf16 a[16:31], a[224:227], v[128:131], 0
    s_waitcnt vmcnt(16)
    ds_read_b128 a[192:195], v8 offset:16384
    v_cvt_pk_bf16_f32 v139, v142, v143
    v_mfma_f32_32x32x16_bf16 a[64:79], a[232:235], v[128:131], 0
    ds_read_b128 a[196:199], v9 offset:16384
    ds_read_b128 a[200:203], v10 offset:16384
    v_mfma_f32_32x32x16_bf16 a[112:127], a[240:243], v[128:131], 0
    ds_read_b128 a[204:207], v11 offset:16384
    ds_read_b128 a[208:211], v12 offset:16384
    ds_read_b128 a[212:215], v13 offset:16384
    v_max3_f32 v25, v144, v145, v146
    v_max3_f32 v25, v25, v147, v148
    v_max3_f32 v25, v25, v149, v150
    v_max3_f32 v25, v25, v151, v152
    v_max3_f32 v25, v25, v153, v154
    v_max3_f32 v25, v25, v155, v156
    v_mfma_f32_32x32x16_bf16 a[160:175], a[248:251], v[128:131], 0
    ds_read_b128 a[216:219], v14 offset:16384
    ds_read_b128 a[220:223], v15 offset:16384
    v_max3_f32 v25, v25, v157, v158
    v_max_f32 v25, v25, v159
    v_mov_b32 v84, v25
    s_nop 1
    v_permlane32_swap_b32 v25, v84
    v_max_f32 v25, v25, v84
    v_sub_f32 v64, 0, v25
    v_sub_f32 v65, 0, v25
    v_mfma_f32_32x32x16_bf16 a[16:31], a[228:231], v[136:139], a[16:31]
    v_sub_f32 v66, 0, v25
    v_sub_f32 v67, 0, v25
    v_sub_f32 v68, 0, v25
    v_sub_f32 v69, 0, v25
    v_sub_f32 v70, 0, v25
    v_sub_f32 v71, 0, v25
    v_sub_f32 v72, 0, v25
    v_sub_f32 v73, 0, v25
    v_sub_f32 v74, 0, v25
    v_mfma_f32_32x32x16_bf16 a[64:79], a[236:239], v[136:139], a[64:79]
    v_sub_f32 v75, 0, v25
    v_sub_f32 v76, 0, v25
    v_sub_f32 v77, 0, v25
    v_sub_f32 v78, 0, v25
    v_sub_f32 v79, 0, v25
    v_sub_f32 v144, v144, v25
    v_sub_f32 v145, v145, v25
    v_sub_f32 v146, v146, v25
    v_sub_f32 v147, v147, v25
    v_mfma_f32_32x32x16_bf16 a[112:127], a[244:247], v[136:139], a[112:127]
    s_add_u32 s45, s45, 1
    v_mov_b32 v27, s45
    ds_write_b32 v109, v27 offset:16
    v_sub_f32 v148, v148, v25
    v_sub_f32 v149, v149, v25
    v_sub_f32 v150, v150, v25
    v_sub_f32 v151, v151, v25
    v_sub_f32 v152, v152, v25
    v_sub_f32 v153, v153, v25
    v_mfma_f32_32x32x16_bf16 a[160:175], a[252:255], v[136:139], a[160:175]
    v_sub_f32 v154, v154, v25
    v_sub_f32 v155, v155, v25
    v_sub_f32 v156, v156, v25
    v_sub_f32 v157, v157, v25
    v_sub_f32 v158, v158, v25
    v_sub_f32 v159, v159, v25
    v_exp_f32 v144, v144
    s_waitcnt lgkmcnt(1)
    v_mfma_f32_32x32x16_bf16 v[112:127], a[192:195], v[160:163], v[32:47]
    v_exp_f32 v145, v145
    v_exp_f32 v146, v146
    v_exp_f32 v147, v147
    v_add_f32 v22, v22, v144
    v_add_f32 v22, v22, v145
    v_cvt_pk_bf16_f32 v144, v144, v145
    s_cmp_eq_u32 s7, 1
    s_cselect_b64 s[70:71], -1, 0
    v_add_u32 v80, 0, v1
    v_mul_u32_u24 v28, 58255, v80
    v_mfma_f32_32x32x16_bf16 v[112:127], a[196:199], v[164:167], v[112:127]
    v_exp_f32 v148, v148
    s_add_u32 m0, s37, 16384
    s_add_u32 s51, s34, s35
    s_cmp_le_u32 s50, 0
    s_cbranch_scc1 L_cap9
    s_waitcnt vmcnt(5)
    s_cmp_le_u32 s50, 2
    s_cbranch_scc1 L_cap9
    s_waitcnt vmcnt(4)
L_cap9:
    buffer_load_dwordx4 v6, s[12:15], s51 offen offset:0 nt lds
    v_lshrrev_b32 v28, 20, v28
    v_mul_u32_u24 v83, 18, v28
    v_mfma_f32_32x32x16_bf16 v[112:127], a[200:203], v[168:171], v[112:127]
    v_exp_f32 v149, v149
    v_add_f32 v22, v22, v146
    v_add_f32 v22, v22, v147
    v_cvt_pk_bf16_f32 v145, v146, v147
    v_exp_f32 v150, v150
    v_exp_f32 v151, v151
    v_sub_u32 v83, v80, v83
    v_xor_b32 v29, 1, v83
    v_sub_u32 v29, 17, v29
    v_mfma_f32_32x32x16_bf16 v[112:127], a[204:207], v[172:175], v[112:127]
    v_add_f32 v22, v22, v148
    v_add_f32 v22, v22, v149
    v_cvt_pk_bf16_f32 v146, v148, v149
    v_exp_f32 v152, v152
    v_exp_f32 v153, v153
    v_add_f32 v22, v22, v150
    v_add_f32 v22, v22, v151
    v_cndmask_b32 v29, v83, v29, s[70:71]
    v_mul_u32_u24 v28, 1152, v28
    v_lshl_add_u32 v93, v29, 4, v28
    v_mfma_f32_32x32x16_bf16 v[112:127], a[208:211], v[176:179], v[112:127]
    v_cvt_pk_bf16_f32 v147, v150, v151
    v_exp_f32 v154, v154
    s_add_u32 s35, s35, 16384
    s_and_b32 s35, s35, 0x3ffff
    s_cmp_le_u32 s50, 0
    s_cbranch_scc1 L_cap10
    s_waitcnt vmcnt(5)
    s_cmp_le_u32 s50, 2
    s_cbranch_scc1 L_cap10
    s_waitcnt vmcnt(4)
L_cap10:
    buffer_load_dwordx4 v6, s[12:15], s51 offen offset:1024 nt lds
    v_add_u32 v80, 64, v1
    v_mul_u32_u24 v28, 58255, v80
    v_mfma_f32_32x32x16_bf16 v[112:127], a[212:215], v[180:183], v[112:127]
    v_exp_f32 v155, v155
    v_add_f32 v22, v22, v152
    v_add_f32 v22, v22, v153
    v_cvt_pk_bf16_f32 v152, v152, v153
    v_exp_f32 v156, v156
    v_exp_f32 v157, v157
    v_lshrrev_b32 v28, 20, v28
    v_mul_u32_u24 v83, 18, v28
    v_sub_u32 v83, v80, v83
    v_mfma_f32_32x32x16_bf16 v[112:127], a[216:219], v[184:187], v[112:127]
    v_add_f32 v22, v22, v154
    v_add_f32 v22, v22, v155
    v_cvt_pk_bf16_f32 v153, v154, v155
    v_exp_f32 v158, v158
    v_exp_f32 v159, v159
    v_add_f32 v22, v22, v156
    v_add_f32 v22, v22, v157
    v_xor_b32 v29, 1, v83
    v_sub_u32 v29, 17, v29
    v_mfma_f32_32x32x16_bf16 v[112:127], a[220:223], v[188:191], v[112:127]
    v_cvt_pk_bf16_f32 v154, v156, v157
    v_add_f32 v22, v22, v158
    v_add_f32 v22, v22, v159
    s_cmp_le_u32 s50, 0
    s_cbranch_scc1 L_cap11
    s_waitcnt vmcnt(6)
    s_cmp_le_u32 s50, 2
    s_cbranch_scc1 L_cap11
    s_waitcnt vmcnt(4)
L_cap11:
    buffer_load_dwordx4 v6, s[12:15], s51 offen offset:2048 nt lds
    v_cndmask_b32 v29, v83, v29, s[70:71]
    v_mul_u32_u24 v28, 1152, v28
    v_lshl_add_u32 v94, v29, 4, v28
    v_mfma_f32_32x32x16_bf16 a[32:47], a[224:227], v[144:147], 0
    v_cvt_pk_bf16_f32 v155, v158, v159
    v_add_u32 v80, 128, v1
    v_mul_u32_u24 v28, 58255, v80
    v_lshrrev_b32 v28, 20, v28
    v_mfma_f32_32x32x16_bf16 a[80:95], a[232:235], v[144:147], 0
    v_mul_u32_u24 v83, 18, v28
    v_sub_u32 v83, v80, v83
    v_mfma_f32_32x32x16_bf16 a[128:143], a[240:243], v[144:147], 0
    s_cmp_le_u32 s50, 0
    s_cbranch_scc1 L_cap12
    s_waitcnt vmcnt(5)
    s_cmp_le_u32 s50, 2
    s_cbranch_scc1 L_cap12
    s_waitcnt vmcnt(4)
L_cap12:
    buffer_load_dwordx4 v6, s[12:15], s51 offen offset:3072 nt lds
    v_xor_b32 v29, 1, v83
    v_sub_u32 v29, 17, v29
    v_cndmask_b32 v29, v83, v29, s[70:71]
    v_max3_f32 v23, v112, v113, v114
    v_max3_f32 v23, v23, v115, v116
    v_mfma_f32_32x32x16_bf16 a[176:191], a[248:251], v[144:147], 0
    v_mul_u32_u24 v28, 1152, v28
    v_lshl_add_u32 v95, v29, 4, v28
    v_add_u32 v80, 192, v1
    v_max3_f32 v23, v23, v117, v118
    v_max3_f32 v23, v23, v119, v120
    v_max3_f32 v23, v23, v121, v122
    v_max3_f32 v23, v23, v123, v124
    v_max3_f32 v23, v23, v125, v126
    v_max_f32 v23, v23, v127
    v_cmp_lt_f32 vcc, s43, v23
    s_cbranch_vccz L_sk1_0
    s_call_b64 s[40:41], L_rare0
L_sk1_0:
    v_mfma_f32_32x32x16_bf16 a[32:47], a[228:231], v[152:155], a[32:47]
    v_mul_u32_u24 v28, 58255, v80
    v_lshrrev_b32 v28, 20, v28
    v_exp_f32 v112, v112
    v_exp_f32 v113, v113
    v_exp_f32 v114, v114
    v_exp_f32 v115, v115
    v_add_f32 v20, v20, v112
    v_mfma_f32_32x32x16_bf16 a[80:95], a[236:239], v[152:155], a[80:95]
    s_add_u32 m0, s37, 20480
    s_add_u32 s51, s51, 4096
    s_cmp_le_u32 s50, 0
    s_cbranch_scc1 L_cap13
    s_waitcnt vmcnt(5)
    s_cmp_le_u32 s50, 2
    s_cbranch_scc1 L_cap13
    s_waitcnt vmcnt(4)
L_cap13:
    buffer_load_dwordx4 v6, s[12:15], s51 offen offset:0 nt lds
    v_mul_u32_u24 v83, 18, v28
    v_sub_u32 v83, v80, v83
    v_xor_b32 v29, 1, v83
    v_mfma_f32_32x32x16_bf16 a[128:143], a[244:247], v[152:155], a[128:143]
    v_sub_u32 v29, 17, v29
    v_cndmask_b32 v29, v83, v29, s[70:71]
    v_mul_u32_u24 v28, 1152, v28
    v_add_f32 v20, v20, v113
    v_cvt_pk_bf16_f32 v112, v112, v113
    v_exp_f32 v116, v116
    v_exp_f32 v117, v117
    v_add_f32 v20, v20, v114
    v_add_f32 v20, v20, v115
    v_mfma_f32_32x32x16_bf16 a[176:191], a[252:255], v[152:155], a[176:191]
    v_lshl_add_u32 v96, v29, 4, v28
    v_add_u32 v80, 256, v1
    v_cvt_pk_bf16_f32 v113, v114, v115
    v_exp_f32 v118, v118
    v_exp_f32 v119, v119
    v_add_f32 v20, v20, v116
    v_add_f32 v20, v20, v117
    v_cvt_pk_bf16_f32 v114, v116, v117
    v_mfma_f32_32x32x16_bf16 v[128:143], a[192:195], v[192:195], v[48:63]
    s_cmp_le_u32 s50, 0
    s_cbranch_scc1 L_cap14
    s_waitcnt vmcnt(6)
    s_cmp_le_u32 s50, 2
    s_cbranch_scc1 L_cap14
    s_waitcnt vmcnt(4)
L_cap14:
    buffer_load_dwordx4 v6, s[12:15], s51 offen offset:1024 nt lds
    s_waitcnt vmcnt(14)
    ds_read_b64_tr_b16 a[224:225], v16 offset:0
    ds_read_b64_tr_b16 a[226:227], v16 offset:2048
    v_mul_u32_u24 v28, 58255, v80
    v_lshrrev_b32 v28, 20, v28
    v_mul_u32_u24 v83, 18, v28
    v_mfma_f32_32x32x16_bf16 v[128:143], a[196:199], v[196:199], v[128:143]
    ds_read_b64_tr_b16 a[232:233], v17 offset:0
    ds_read_b64_tr_b16 a[234:235], v17 offset:2048
    ds_read_b64_tr_b16 a[240:241], v18 offset:0
    v_sub_u32 v83, v80, v83
    v_xor_b32 v29, 1, v83
    v_exp_f32 v120, v120
    v_exp_f32 v121, v121
    v_add_f32 v20, v20, v118
    v_add_f32 v20, v20, v119
    v_mfma_f32_32x32x16_bf16 v[128:143], a[200:203], v[200:203], v[128:143]
    ds_read_b64_tr_b16 a[242:243], v18 offset:2048
    ds_read_b64_tr_b16 a[248:249], v19 offset:0
    v_sub_u32 v29, 17, v29
    v_cndmask_b32 v29, v83, v29, s[70:71]
    v_mul_u32_u24 v28, 1152, v28
    v_cvt_pk_bf16_f32 v115, v118, v119
    v_exp_f32 v122, v122
    v_exp_f32 v123, v123
    v_add_f32 v20, v20, v120
    v_mfma_f32_32x32x16_bf16 v[128:143], a[204:207], v[204:207], v[128:143]
    s_cmp_le_u32 s50, 0
    s_cbranch_scc1 L_cap15
    s_waitcnt vmcnt(5)
    s_cmp_le_u32 s50, 2
    s_cbranch_scc1 L_cap15
    s_waitcnt vmcnt(4)
L_cap15:
    buffer_load_dwordx4 v6, s[12:15], s51 offen offset:2048 nt lds
    ds_read_b64_tr_b16 a[250:251], v19 offset:2048
    ds_read_b64_tr_b16 a[228:229], v16 offset:4096
    ds_read_b64_tr_b16 a[230:231], v16 offset:6144
    v_lshl_add_u32 v97, v29, 4, v28
    v_add_u32 v80, 320, v1
    v_mul_u32_u24 v28, 58255, v80
    v_mfma_f32_32x32x16_bf16 v[128:143], a[208:211], v[208:211], v[128:143]
    ds_read_b64_tr_b16 a[236:237], v17 offset:4096
    ds_read_b64_tr_b16 a[238:239], v17 offset:6144
    ds_read_b64_tr_b16 a[244:245], v18 offset:4096
    v_lshrrev_b32 v28, 20, v28
    v_mul_u32_u24 v83, 18, v28
    v_add_f32 v20, v20, v121
    v_cvt_pk_bf16_f32 v120, v120, v121
    v_exp_f32 v124, v124
    v_exp_f32 v125, v125
    v_mfma_f32_32x32x16_bf16 v[128:143], a[212:215], v[212:215], v[128:143]
    ds_read_b64_tr_b16 a[246:247], v18 offset:6144
    ds_read_b64_tr_b16 a[252:253], v19 offset:4096
    ds_read_b64_tr_b16 a[254:255], v19 offset:6144
    v_sub_u32 v83, v80, v83
    v_xor_b32 v29, 1, v83
    v_sub_u32 v29, 17, v29
    v_add_f32 v20, v20, v122
    v_add_f32 v20, v20, v123
    v_cvt_pk_bf16_f32 v121, v122, v123
    v_exp_f32 v126, v126
    v_mfma_f32_32x32x16_bf16 v[128:143], a[216:219], v[216:219], v[128:143]
    s_cmp_le_u32 s50, 0
    s_cbranch_scc1 L_cap16
    s_waitcnt vmcnt(5)
    s_cmp_le_u32 s50, 2
    s_cbranch_scc1 L_cap16
    s_waitcnt vmcnt(4)
L_cap16:
    buffer_load_dwordx4 v6, s[12:15], s51 offen offset:3072 nt lds
    v_cndmask_b32 v29, v83, v29, s[70:71]
    v_mul_u32_u24 v28, 1152, v28
    v_lshl_add_u32 v98, v29, 4, v28
    v_exp_f32 v127, v127
    v_mfma_f32_32x32x16_bf16 v[128:143], a[220:223], v[220:223], v[128:143]
    v_add_u32 v80, 384, v1
    v_mul_u32_u24 v28, 58255, v80
    v_add_f32 v20, v20, v124
    v_add_f32 v20, v20, v125
    v_cvt_pk_bf16_f32 v122, v124, v125
    v_add_f32 v20, v20, v126
    v_add_f32 v20, v20, v127
    v_cvt_pk_bf16_f32 v123, v126, v127
    s_waitcnt lgkmcnt(0)
    v_mfma_f32_32x32x16_bf16 a[0:15], a[224:227], v[112:115], a[0:15]
    v_lshrrev_b32 v28, 20, v28
    v_mul_u32_u24 v83, 18, v28
    v_sub_u32 v83, v80, v83
    v_mfma_f32_32x32x16_bf16 a[48:63], a[232:235], v[112:115], a[48:63]
    s_add_u32 m0, s37, 0
    s_add_u32 s51, s34, s36
    s_cmp_le_u32 s50, 0
    s_cbranch_scc1 L_cap17
    s_waitcnt vmcnt(5)
    s_cmp_le_u32 s50, 2
    s_cbranch_scc1 L_cap17
    s_waitcnt vmcnt(4)
L_cap17:
    buffer_load_dwordx4 v2, s[8:11], s51 offen offset:0 nt lds
    v_xor_b32 v29, 1, v83
    v_sub_u32 v29, 17, v29
    v_mfma_f32_32x32x16_bf16 a[96:111], a[240:243], v[112:115], a[96:111]
    v_cndmask_b32 v29, v83, v29, s[70:71]
    v_mul_u32_u24 v28, 1152, v28
    v_lshl_add_u32 v99, v29, 4, v28
    v_max3_f32 v24, v128, v129, v130
    v_max3_f32 v24, v24, v131, v132
    v_max3_f32 v24, v24, v133, v134
    v_max3_f32 v24, v24, v135, v136
    v_max3_f32 v24, v24, v137, v138
    v_max3_f32 v24, v24, v139, v140
    v_max3_f32 v24, v24, v141, v142
    v_mfma_f32_32x32x16_bf16 a[144:159], a[248:251], v[112:115], a[144:159]
    v_add_u32 v80, 448, v1
    v_mul_u32_u24 v28, 58255, v80
    v_lshrrev_b32 v28, 20, v28
    v_max_f32 v24, v24, v143
    v_cmp_lt_f32 vcc, s43, v24
    s_cbranch_vccz L_sk1_1
    s_call_b64 s[40:41], L_rare1
L_sk1_1:
    v_exp_f32 v128, v128
    v_exp_f32 v129, v129
    v_mfma_f32_32x32x16_bf16 a[0:15], a[228:231], v[120:123], a[0:15]
    s_add_u32 s36, s36, 16384
    s_and_b32 s36, s36, 0x3ffff
    s_cmp_le_u32 s50, 0
    s_cbranch_scc1 L_cap18
    s_waitcnt vmcnt(5)
    s_cmp_le_u32 s50, 2
    s_cbranch_scc1 L_cap18
    s_waitcnt vmcnt(4)
L_cap18:
    buffer_load_dwordx4 v3, s[8:11], s51 offen offset:1024 nt lds
    v_mul_u32_u24 v83, 18, v28
    v_sub_u32 v83, v80, v83
    v_mfma_f32_32x32x16_bf16 a[48:63], a[236:239], v[120:123], a[48:63]
    v_xor_b32 v29, 1, v83
    v_sub_u32 v29, 17, v29
    v_cndmask_b32 v29, v83, v29, s[70:71]
    v_exp_f32 v130, v130
    v_exp_f32 v131, v131
    v_add_f32 v21, v21, v128
    v_add_f32 v21, v21, v129
    v_cvt_pk_bf16_f32 v128, v128, v129
    v_mfma_f32_32x32x16_bf16 a[96:111], a[244:247], v[120:123], a[96:111]
    v_mul_u32_u24 v28, 1152, v28
    v_lshl_add_u32 v100, v29, 4, v28
    v_add_u32 v80, 512, v1
    v_exp_f32 v132, v132
    v_exp_f32 v133, v133
    v_add_f32 v21, v21, v130
    v_add_f32 v21, v21, v131
    v_cvt_pk_bf16_f32 v129, v130, v131
    v_mfma_f32_32x32x16_bf16 a[144:159], a[252:255], v[120:123], a[144:159]
    s_cmp_le_u32 s50, 0
    s_cbranch_scc1 L_cap19
    s_waitcnt vmcnt(6)
    s_cmp_le_u32 s50, 2
    s_cbranch_scc1 L_cap19
    s_waitcnt vmcnt(4)
L_cap19:
    buffer_load_dwordx4 v4, s[8:11], s51 offen offset:2048 nt lds
    v_mul_u32_u24 v28, 58255, v80
    v_lshrrev_b32 v28, 20, v28
    v_exp_f32 v134, v134
    v_mfma_f32_32x32x16_bf16 v[144:159], a[192:195], v[224:227], v[64:79]
    v_mul_u32_u24 v83, 18, v28
    v_sub_u32 v83, v80, v83
    v_xor_b32 v29, 1, v83
    v_exp_f32 v135, v135
    v_add_f32 v21, v21, v132
    v_add_f32 v21, v21, v133
    v_cvt_pk_bf16_f32 v130, v132, v133
    v_exp_f32 v136, v136
    v_mfma_f32_32x32x16_bf16 v[144:159], a[196:199], v[228:231], v[144:159]
    v_sub_u32 v29, 17, v29
    v_cndmask_b32 v29, v83, v29, s[70:71]
    v_mul_u32_u24 v28, 1152, v28
    v_exp_f32 v137, v137
    v_add_f32 v21, v21, v134
    v_add_f32 v21, v21, v135
    v_cvt_pk_bf16_f32 v131, v134, v135
    v_exp_f32 v138, v138
    v_mfma_f32_32x32x16_bf16 v[144:159], a[200:203], v[232:235], v[144:159]
    s_cmp_le_u32 s50, 0
    s_cbranch_scc1 L_cap20
    s_waitcnt vmcnt(5)
    s_cmp_le_u32 s50, 2
    s_cbranch_scc1 L_cap20
    s_waitcnt vmcnt(4)
L_cap20:
    buffer_load_dwordx4 v5, s[8:11], s51 offen offset:3072 nt lds
    v_lshl_add_u32 v101, v29, 4, v28
    v_lshlrev_b32 v102, 4, v1
    v_exp_f32 v139, v139
    v_mfma_f32_32x32x16_bf16 v[144:159], a[204:207], v[236:239], v[144:159]
    v_lshlrev_b32 v80, 4, v90
    v_lshl_add_u32 v80, v92, 2, v80
    v_add_u32 v80, v80, v81
    v_add_f32 v21, v21, v136
    v_add_f32 v21, v21, v137
    v_cvt_pk_bf16_f32 v136, v136, v137
    v_exp_f32 v140, v140
    v_exp_f32 v141, v141
    v_mfma_f32_32x32x16_bf16 v[144:159], a[208:211], v[240:243], v[144:159]
    v_mul_u32_u24 v80, 288, v80
    v_lshl_add_u32 v80, v82, 3, v80
    s_mul_i32 s3, s7, 18432
    v_add_f32 v21, v21, v138
    v_add_f32 v21, v21, v139
    v_cvt_pk_bf16_f32 v137, v138, v139
    v_exp_f32 v142, v142
    v_exp_f32 v143, v143
    v_mfma_f32_32x32x16_bf16 v[144:159], a[212:215], v[244:247], v[144:159]
    s_add_u32 m0, s37, 4096
    s_add_u32 s51, s51, 4096
    s_cmp_le_u32 s50, 0
    s_cbranch_scc1 L_cap21
    s_waitcnt vmcnt(5)
    s_cmp_le_u32 s50, 2
    s_cbranch_scc1 L_cap21
    s_waitcnt vmcnt(4)
L_cap21:
    buffer_load_dwordx4 v2, s[8:11], s51 offen offset:0 nt lds
    v_add_u32 v104, s3, v80
    v_add_u32 v103, 122880, v104
    v_lshlrev_b32 v107, 10, v92
    v_mfma_f32_32x32x16_bf16 v[144:159], a[216:219], v[248:251], v[144:159]
    v_lshl_add_u32 v107, v90, 8, v107
    v_lshl_add_u32 v107, v89, 4, v107
    v_add_f32 v21, v21, v140
    v_add_f32 v21, v21, v141
    v_cvt_pk_bf16_f32 v138, v140, v141
    v_add_f32 v21, v21, v142
    v_add_f32 v21, v21, v143
    v_cvt_pk_bf16_f32 v139, v142, v143
    v_mfma_f32_32x32x16_bf16 v[144:159], a[220:223], v[252:255], v[144:159]
    v_mov_b32 v108, 0
    s_mul_i32 s67, s30, 1179648
    s_mul_i32 s3, s32, 288
    s_add_u32 s64, s67, s3
    s_lshl_b32 s39, s29, 3
    v_mfma_f32_32x32x16_bf16 a[16:31], a[224:227], v[128:131], a[16:31]
    s_cmp_le_u32 s50, 0
    s_cbranch_scc1 L_cap22
    s_waitcnt vmcnt(6)
    s_cmp_le_u32 s50, 2
    s_cbranch_scc1 L_cap22
    s_waitcnt vmcnt(4)
L_cap22:
    buffer_load_dwordx4 v3, s[8:11], s51 offen offset:1024 nt lds
    s_waitcnt vmcnt(14)
    ds_read_b128 a[192:195], v8 offset:32768
    s_add_u32 s39, s39, s31
    s_lshl_b32 s66, s32, 1
    s_mul_i32 s65, s28, 9216
    s_mul_i32 s68, s28, 36864
    s_add_u32 s68, s68, s64
    v_mfma_f32_32x32x16_bf16 a[64:79], a[232:235], v[128:131], a[64:79]
    ds_read_b128 a[196:199], v9 offset:32768
    ds_read_b128 a[200:203], v10 offset:32768
    v_mfma_f32_32x32x16_bf16 a[112:127], a[240:243], v[128:131], a[112:127]
    ds_read_b128 a[204:207], v11 offset:32768
    ds_read_b128 a[208:211], v12 offset:32768
    ds_read_b128 a[212:215], v13 offset:32768
    v_max3_f32 v25, v144, v145, v146
    v_max3_f32 v25, v25, v147, v148
    v_max3_f32 v25, v25, v149, v150
    v_max3_f32 v25, v25, v151, v152
    v_mfma_f32_32x32x16_bf16 a[160:175], a[248:251], v[128:131], a[160:175]
    s_cmp_le_u32 s50, 0
    s_cbranch_scc1 L_cap23
    s_waitcnt vmcnt(5)
    s_cmp_le_u32 s50, 2
    s_cbranch_scc1 L_cap23
    s_waitcnt vmcnt(4)
L_cap23:
    buffer_load_dwordx4 v4, s[8:11], s51 offen offset:2048 nt lds
    ds_read_b128 a[216:219], v14 offset:32768
    ds_read_b128 a[220:223], v15 offset:32768
    v_mfma_f32_32x32x16_bf16 a[16:31], a[228:231], v[136:139], a[16:31]
    v_max3_f32 v25, v25, v153, v154
    v_max3_f32 v25, v25, v155, v156
    v_max3_f32 v25, v25, v157, v158
    v_max_f32 v25, v25, v159
    v_cmp_lt_f32 vcc, s43, v25
    s_cbranch_vccz L_sk1_2
    s_call_b64 s[40:41], L_rare2
L_sk1_2:
    v_mfma_f32_32x32x16_bf16 a[64:79], a[236:239], v[136:139], a[64:79]
    v_exp_f32 v144, v144
    v_exp_f32 v145, v145
    v_exp_f32 v146, v146
    v_mfma_f32_32x32x16_bf16 a[112:127], a[244:247], v[136:139], a[112:127]
    s_cmp_le_u32 s50, 0
    s_cbranch_scc1 L_cap24
    s_waitcnt vmcnt(5)
    s_cmp_le_u32 s50, 2
    s_cbranch_scc1 L_cap24
    s_waitcnt vmcnt(4)
L_cap24:
    buffer_load_dwordx4 v5, s[8:11], s51 offen offset:3072 nt lds
    v_mfma_f32_32x32x16_bf16 a[160:175], a[252:255], v[136:139], a[160:175]
    v_exp_f32 v147, v147
    v_add_f32 v22, v22, v144
    v_add_f32 v22, v22, v145
    v_cvt_pk_bf16_f32 v144, v144, v145
    v_exp_f32 v148, v148
    s_mov_b32 s46, 4
.p2align 6
L_tile:
    s_cmp_eq_u32 s7, 0
    s_cselect_b32 s3, 0, 0
    s_cmp_gt_u32 s46, 1
    s_cselect_b32 s50, s50, s3
    s_waitcnt lgkmcnt(0)
    v_mfma_f32_32x32x16_bf16 v[112:127], a[192:195], v[160:163], v[32:47]
    v_exp_f32 v149, v149
    v_add_f32 v22, v22, v146
    v_add_f32 v22, v22, v147
    v_cvt_pk_bf16_f32 v145, v146, v147
    v_exp_f32 v150, v150
    v_mfma_f32_32x32x16_bf16 v[112:127], a[196:199], v[164:167], v[112:127]
    s_add_u32 m0, s37, 32768
    s_add_u32 s51, s34, s35
    s_cmp_le_u32 s50, 0
    s_cbranch_scc1 L_cap25
    s_waitcnt vmcnt(5)
    s_cmp_le_u32 s50, 2
    s_cbranch_scc1 L_cap25
    s_waitcnt vmcnt(4)
L_cap25:
    buffer_load_dwordx4 v6, s[12:15], s51 offen offset:0 nt lds
    v_mfma_f32_32x32x16_bf16 v[112:127], a[200:203], v[168:171], v[112:127]
    v_exp_f32 v151, v151
    v_add_f32 v22, v22, v148
    v_add_f32 v22, v22, v149
    v_cvt_pk_bf16_f32 v146, v148, v149
    v_exp_f32 v152, v152
    v_mfma_f32_32x32x16_bf16 v[112:127], a[204:207], v[172:175], v[112:127]
    v_exp_f32 v153, v153
    v_add_f32 v22, v22, v150
    v_add_f32 v22, v22, v151
    v_cvt_pk_bf16_f32 v147, v150, v151
    v_exp_f32 v154, v154
    v_mfma_f32_32x32x16_bf16 v[112:127], a[208:211], v[176:179], v[112:127]
    s_add_u32 s35, s35, 16384
    s_and_b32 s35, s35, 0x3ffff
    s_cmp_le_u32 s50, 0
    s_cbranch_scc1 L_cap26
    s_waitcnt vmcnt(5)
    s_cmp_le_u32 s50, 2
    s_cbranch_scc1 L_cap26
    s_waitcnt vmcnt(4)
L_cap26:
    buffer_load_dwordx4 v6, s[12:15], s51 offen offset:1024 nt lds
    v_mfma_f32_32x32x16_bf16 v[112:127], a[212:215], v[180:183], v[112:127]
    v_exp_f32 v155, v155
    v_add_f32 v22, v22, v152
    v_add_f32 v22, v22, v153
    v_cvt_pk_bf16_f32 v152, v152, v153
    v_exp_f32 v156, v156
    v_mfma_f32_32x32x16_bf16 v[112:127], a[216:219], v[184:187], v[112:127]
    v_exp_f32 v157, v157
    v_add_f32 v22, v22, v154
    v_add_f32 v22, v22, v155
    v_cvt_pk_bf16_f32 v153, v154, v155
    v_exp_f32 v158, v158
    v_mfma_f32_32x32x16_bf16 v[112:127], a[220:223], v[188:191], v[112:127]
    s_cmp_le_u32 s50, 0
    s_cbranch_scc1 L_cap27
    s_waitcnt vmcnt(6)
    s_cmp_le_u32 s50, 2
    s_cbranch_scc1 L_cap27
    s_waitcnt vmcnt(4)
L_cap27:
    buffer_load_dwordx4 v6, s[12:15], s51 offen offset:2048 nt lds
    v_mfma_f32_32x32x16_bf16 a[32:47], a[224:227], v[144:147], a[32:47]
    v_exp_f32 v159, v159
    v_add_f32 v22, v22, v156
    v_add_f32 v22, v22, v157
    v_cvt_pk_bf16_f32 v154, v156, v157
    v_add_f32 v22, v22, v158
    v_add_f32 v22, v22, v159
    v_mfma_f32_32x32x16_bf16 a[80:95], a[232:235], v[144:147], a[80:95]
    v_cvt_pk_bf16_f32 v155, v158, v159
    v_mfma_f32_32x32x16_bf16 a[128:143], a[240:243], v[144:147], a[128:143]
    s_cmp_le_u32 s50, 0
    s_cbranch_scc1 L_cap28
    s_waitcnt vmcnt(5)
    s_cmp_le_u32 s50, 2
    s_cbranch_scc1 L_cap28
    s_waitcnt vmcnt(4)
L_cap28:
    buffer_load_dwordx4 v6, s[12:15], s51 offen offset:3072 nt lds
    v_max3_f32 v23, v112, v113, v114
    v_max3_f32 v23, v23, v115, v116
    v_mfma_f32_32x32x16_bf16 a[176:191], a[248:251], v[144:147], a[176:191]
    v_max3_f32 v23, v23, v117, v118
    v_max3_f32 v23, v23, v119, v120
    v_max3_f32 v23, v23, v121, v122
    v_max3_f32 v23, v23, v123, v124
    v_max3_f32 v23, v23, v125, v126
    v_max_f32 v23, v23, v127
    v_cmp_lt_f32 vcc, s43, v23
    s_cbranch_vccz L_sk2_0
    s_call_b64 s[40:41], L_rare0
L_sk2_0:
    v_mfma_f32_32x32x16_bf16 a[32:47], a[228:231], v[152:155], a[32:47]
    v_exp_f32 v112, v112
    v_exp_f32 v113, v113
    v_exp_f32 v114, v114
    v_exp_f32 v115, v115
    v_mfma_f32_32x32x16_bf16 a[80:95], a[236:239], v[152:155], a[80:95]
    s_add_u32 m0, s37, 36864
    s_add_u32 s51, s51, 4096
    s_cmp_le_u32 s50, 0
    s_cbranch_scc1 L_cap29
    s_waitcnt vmcnt(5)
    s_cmp_le_u32 s50, 2
    s_cbranch_scc1 L_cap29
    s_waitcnt vmcnt(4)
L_cap29:
    buffer_load_dwordx4 v6, s[12:15], s51 offen offset:0 nt lds
    v_mfma_f32_32x32x16_bf16 a[128:143], a[244:247], v[152:155], a[128:143]
    v_add_f32 v20, v20, v112
    v_add_f32 v20, v20, v113
    v_cvt_pk_bf16_f32 v112, v112, v113
    v_exp_f32 v116, v116
    v_exp_f32 v117, v117
    v_add_f32 v20, v20, v114
    v_mfma_f32_32x32x16_bf16 a[176:191], a[252:255], v[152:155], a[176:191]
    v_add_f32 v20, v20, v115
    v_cvt_pk_bf16_f32 v113, v114, v115
    v_exp_f32 v118, v118
    v_exp_f32 v119, v119
    v_add_f32 v20, v20, v116
    v_add_f32 v20, v20, v117
    v_mfma_f32_32x32x16_bf16 v[128:143], a[192:195], v[192:195], v[48:63]
    s_cmp_le_u32 s50, 0
    s_cbranch_scc1 L_cap30
    s_waitcnt vmcnt(6)
    s_cmp_le_u32 s50, 2
    s_cbranch_scc1 L_cap30
    s_waitcnt vmcnt(4)
L_cap30:
    buffer_load_dwordx4 v6, s[12:15], s51 offen offset:1024 nt lds
    s_waitcnt vmcnt(14)
    ds_read_b64_tr_b16 a[224:225], v16 offset:16384
    ds_read_b64_tr_b16 a[226:227], v16 offset:18432
    v_mfma_f32_32x32x16_bf16 v[128:143], a[196:199], v[196:199], v[128:143]
    ds_read_b64_tr_b16 a[232:233], v17 offset:16384
    ds_read_b64_tr_b16 a[234:235], v17 offset:18432
    ds_read_b64_tr_b16 a[240:241], v18 offset:16384
    v_cvt_pk_bf16_f32 v114, v116, v117
    v_exp_f32 v120, v120
    v_exp_f32 v121, v121
    v_mfma_f32_32x32x16_bf16 v[128:143], a[200:203], v[200:203], v[128:143]
    ds_read_b64_tr_b16 a[242:243], v18 offset:18432
    ds_read_b64_tr_b16 a[248:249], v19 offset:16384
    v_add_f32 v20, v20, v118
    v_add_f32 v20, v20, v119
    v_cvt_pk_bf16_f32 v115, v118, v119
    v_exp_f32 v122, v122
    v_mfma_f32_32x32x16_bf16 v[128:143], a[204:207], v[204:207], v[128:143]
    s_cmp_le_u32 s50, 0
    s_cbranch_scc1 L_cap31
    s_waitcnt vmcnt(5)
    s_cmp_le_u32 s50, 2
    s_cbranch_scc1 L_cap31
    s_waitcnt vmcnt(4)
L_cap31:
    buffer_load_dwordx4 v6, s[12:15], s51 offen offset:2048 nt lds
    ds_read_b64_tr_b16 a[250:251], v19 offset:18432
    ds_read_b64_tr_b16 a[228:229], v16 offset:20480
    ds_read_b64_tr_b16 a[230:231], v16 offset:22528
    v_mfma_f32_32x32x16_bf16 v[128:143], a[208:211], v[208:211], v[128:143]
    ds_read_b64_tr_b16 a[236:237], v17 offset:20480
    ds_read_b64_tr_b16 a[238:239], v17 offset:22528
    ds_read_b64_tr_b16 a[244:245], v18 offset:20480
    v_exp_f32 v123, v123
    v_add_f32 v20, v20, v120
    v_add_f32 v20, v20, v121
    v_cvt_pk_bf16_f32 v120, v120, v121
    v_mfma_f32_32x32x16_bf16 v[128:143], a[212:215], v[212:215], v[128:143]
    ds_read_b64_tr_b16 a[246:247], v18 offset:22528
    ds_read_b64_tr_b16 a[252:253], v19 offset:20480
    ds_read_b64_tr_b16 a[254:255], v19 offset:22528
    v_exp_f32 v124, v124
    v_exp_f32 v125, v125
    v_add_f32 v20, v20, v122
    v_mfma_f32_32x32x16_bf16 v[128:143], a[216:219], v[216:219], v[128:143]
    s_cmp_le_u32 s50, 0
    s_cbranch_scc1 L_cap32
    s_waitcnt vmcnt(5)
    s_cmp_le_u32 s50, 2
    s_cbranch_scc1 L_cap32
    s_waitcnt vmcnt(4)
L_cap32:
    buffer_load_dwordx4 v6, s[12:15], s51 offen offset:3072 nt lds
    v_add_f32 v20, v20, v123
    v_cvt_pk_bf16_f32 v121, v122, v123
    v_mfma_f32_32x32x16_bf16 v[128:143], a[220:223], v[220:223], v[128:143]
    v_exp_f32 v126, v126
    v_exp_f32 v127, v127
    v_add_f32 v20, v20, v124
    v_add_f32 v20, v20, v125
    v_cvt_pk_bf16_f32 v122, v124, v125
    v_add_f32 v20, v20, v126
    s_waitcnt lgkmcnt(0)
    v_mfma_f32_32x32x16_bf16 a[0:15], a[224:227], v[112:115], a[0:15]
    v_add_f32 v20, v20, v127
    v_cvt_pk_bf16_f32 v123, v126, v127
    v_mfma_f32_32x32x16_bf16 a[48:63], a[232:235], v[112:115], a[48:63]
    s_add_u32 m0, s37, 16384
    s_add_u32 s51, s34, s36
    s_cmp_le_u32 s50, 0
    s_cbranch_scc1 L_cap33
    s_waitcnt vmcnt(5)
    s_cmp_le_u32 s50, 2
    s_cbranch_scc1 L_cap33
    s_waitcnt vmcnt(4)
L_cap33:
    buffer_load_dwordx4 v2, s[8:11], s51 offen offset:0 nt lds
    v_mfma_f32_32x32x16_bf16 a[96:111], a[240:243], v[112:115], a[96:111]
    v_max3_f32 v24, v128, v129, v130
    v_max3_f32 v24, v24, v131, v132
    v_max3_f32 v24, v24, v133, v134
    v_max3_f32 v24, v24, v135, v136
    v_max3_f32 v24, v24, v137, v138
    v_max3_f32 v24, v24, v139, v140
    v_max3_f32 v24, v24, v141, v142
    v_mfma_f32_32x32x16_bf16 a[144:159], a[248:251], v[112:115], a[144:159]
    v_max_f32 v24, v24, v143
    v_cmp_lt_f32 vcc, s43, v24
    s_cbranch_vccz L_sk2_1
    s_call_b64 s[40:41], L_rare1
L_sk2_1:
    v_exp_f32 v128, v128
    v_exp_f32 v129, v129
    v_mfma_f32_32x32x16_bf16 a[0:15], a[228:231], v[120:123], a[0:15]
    s_add_u32 s36, s36, 16384
    s_and_b32 s36, s36, 0x3ffff
    s_cmp_le_u32 s50, 0
    s_cbranch_scc1 L_cap34
    s_waitcnt vmcnt(5)
    s_cmp_le_u32 s50, 2
    s_cbranch_scc1 L_cap34
    s_waitcnt vmcnt(4)
L_cap34:
    buffer_load_dwordx4 v3, s[8:11], s51 offen offset:1024 nt lds
    v_mfma_f32_32x32x16_bf16 a[48:63], a[236:239], v[120:123], a[48:63]
    v_exp_f32 v130, v130
    v_exp_f32 v131, v131
    v_add_f32 v21, v21, v128
    v_add_f32 v21, v21, v129
    v_cvt_pk_bf16_f32 v128, v128, v129
    v_mfma_f32_32x32x16_bf16 a[96:111], a[244:247], v[120:123], a[96:111]
    v_exp_f32 v132, v132
    v_exp_f32 v133, v133
    v_add_f32 v21, v21, v130
    v_add_f32 v21, v21, v131
    v_cvt_pk_bf16_f32 v129, v130, v131
    v_mfma_f32_32x32x16_bf16 a[144:159], a[252:255], v[120:123], a[144:159]
    s_cmp_le_u32 s50, 0
    s_cbranch_scc1 L_cap35
    s_waitcnt vmcnt(6)
    s_cmp_le_u32 s50, 2
    s_cbranch_scc1 L_cap35
    s_waitcnt vmcnt(4)
L_cap35:
    buffer_load_dwordx4 v4, s[8:11], s51 offen offset:2048 nt lds
    v_mfma_f32_32x32x16_bf16 v[144:159], a[192:195], v[224:227], v[64:79]
    v_exp_f32 v134, v134
    v_exp_f32 v135, v135
    v_add_f32 v21, v21, v132
    v_add_f32 v21, v21, v133
    v_cvt_pk_bf16_f32 v130, v132, v133
    v_mfma_f32_32x32x16_bf16 v[144:159], a[196:199], v[228:231], v[144:159]
    v_exp_f32 v136, v136
    v_exp_f32 v137, v137
    v_add_f32 v21, v21, v134
    v_add_f32 v21, v21, v135
    v_cvt_pk_bf16_f32 v131, v134, v135
    v_mfma_f32_32x32x16_bf16 v[144:159], a[200:203], v[232:235], v[144:159]
    s_cmp_le_u32 s50, 0
    s_cbranch_scc1 L_cap36
    s_waitcnt vmcnt(5)
    s_cmp_le_u32 s50, 2
    s_cbranch_scc1 L_cap36
    s_waitcnt vmcnt(4)
L_cap36:
    buffer_load_dwordx4 v5, s[8:11], s51 offen offset:3072 nt lds
    v_mfma_f32_32x32x16_bf16 v[144:159], a[204:207], v[236:239], v[144:159]
    v_exp_f32 v138, v138
    v_exp_f32 v139, v139
    v_add_f32 v21, v21, v136
    v_add_f32 v21, v21, v137
    v_cvt_pk_bf16_f32 v136, v136, v137
    v_mfma_f32_32x32x16_bf16 v[144:159], a[208:211], v[240:243], v[144:159]
    v_exp_f32 v140, v140
    v_exp_f32 v141, v141
    v_add_f32 v21, v21, v138
    v_add_f32 v21, v21, v139
    v_cvt_pk_bf16_f32 v137, v138, v139
    v_mfma_f32_32x32x16_bf16 v[144:159], a[212:215], v[244:247], v[144:159]
    s_add_u32 m0, s37, 20480
    s_add_u32 s51, s51, 4096
    s_cmp_le_u32 s50, 0
    s_cbranch_scc1 L_cap37
    s_waitcnt vmcnt(5)
    s_cmp_le_u32 s50, 2
    s_cbranch_scc1 L_cap37
    s_waitcnt vmcnt(4)
L_cap37:
    buffer_load_dwordx4 v2, s[8:11], s51 offen offset:0 nt lds
    v_mfma_f32_32x32x16_bf16 v[144:159], a[216:219], v[248:251], v[144:159]
    v_exp_f32 v142, v142
    v_exp_f32 v143, v143
    v_add_f32 v21, v21, v140
    v_add_f32 v21, v21, v141
    v_cvt_pk_bf16_f32 v138, v140, v141
    v_mfma_f32_32x32x16_bf16 v[144:159], a[220:223], v[252:255], v[144:159]
    v_add_f32 v21, v21, v142
    v_add_f32 v21, v21, v143
    v_cvt_pk_bf16_f32 v139, v142, v143
    v_mfma_f32_32x32x16_bf16 a[16:31], a[224:227], v[128:131], a[16:31]
    s_cmp_le_u32 s50, 0
    s_cbranch_scc1 L_cap38
    s_waitcnt vmcnt(6)
    s_cmp_le_u32 s50, 2
    s_cbranch_scc1 L_cap38
    s_waitcnt vmcnt(4)
L_cap38:
    buffer_load_dwordx4 v3, s[8:11], s51 offen offset:1024 nt lds
    s_waitcnt vmcnt(14)
    ds_read_b128 a[192:195], v8 offset:0
    v_mfma_f32_32x32x16_bf16 a[64:79], a[232:235], v[128:131], a[64:79]
    ds_read_b128 a[196:199], v9 offset:0
    ds_read_b128 a[200:203], v10 offset:0
    v_mfma_f32_32x32x16_bf16 a[112:127], a[240:243], v[128:131], a[112:127]
    ds_read_b128 a[204:207], v11 offset:0
    ds_read_b128 a[208:211], v12 offset:0
    ds_read_b128 a[212:215], v13 offset:0
    v_max3_f32 v25, v144, v145, v146
    v_max3_f32 v25, v25, v147, v148
    v_max3_f32 v25, v25, v149, v150
    v_max3_f32 v25, v25, v151, v152
    v_mfma_f32_32x32x16_bf16 a[160:175], a[248:251], v[128:131], a[160:175]
    s_cmp_le_u32 s50, 0
    s_cbranch_scc1 L_cap39
    s_waitcnt vmcnt(5)
    s_cmp_le_u32 s50, 2
    s_cbranch_scc1 L_cap39
    s_waitcnt vmcnt(4)
L_cap39:
    buffer_load_dwordx4 v4, s[8:11], s51 offen offset:2048 nt lds
    ds_read_b128 a[216:219], v14 offset:0
    ds_read_b128 a[220:223], v15 offset:0
    v_mfma_f32_32x32x16_bf16 a[16:31], a[228:231], v[136:139], a[16:31]
    v_max3_f32 v25, v25, v153, v154
    v_max3_f32 v25, v25, v155, v156
    v_max3_f32 v25, v25, v157, v158
    v_max_f32 v25, v25, v159
    v_cmp_lt_f32 vcc, s43, v25
    s_cbranch_vccz L_sk2_2
    s_call_b64 s[40:41], L_rare2
L_sk2_2:
    v_mfma_f32_32x32x16_bf16 a[64:79], a[236:239], v[136:139], a[64:79]
    v_exp_f32 v144, v144
    v_exp_f32 v145, v145
    v_exp_f32 v146, v146
    v_mfma_f32_32x32x16_bf16 a[112:127], a[244:247], v[136:139], a[112:127]
    s_cmp_le_u32 s50, 0
    s_cbranch_scc1 L_cap40
    s_waitcnt vmcnt(5)
    s_cmp_le_u32 s50, 2
    s_cbranch_scc1 L_cap40
    s_waitcnt vmcnt(4)
L_cap40:
    buffer_load_dwordx4 v5, s[8:11], s51 offen offset:3072 nt lds
    v_mfma_f32_32x32x16_bf16 a[160:175], a[252:255], v[136:139], a[160:175]
    v_exp_f32 v147, v147
    v_add_f32 v22, v22, v144
    v_add_f32 v22, v22, v145
    v_cvt_pk_bf16_f32 v144, v144, v145
    v_exp_f32 v148, v148
    s_waitcnt lgkmcnt(0)
    v_mfma_f32_32x32x16_bf16 v[112:127], a[192:195], v[160:163], v[32:47]
    v_exp_f32 v149, v149
    v_add_f32 v22, v22, v146
    v_add_f32 v22, v22, v147
    v_cvt_pk_bf16_f32 v145, v146, v147
    v_exp_f32 v150, v150
    v_mfma_f32_32x32x16_bf16 v[112:127], a[196:199], v[164:167], v[112:127]
    s_add_u32 m0, s37, 0
    s_add_u32 s51, s34, s35
    s_cmp_le_u32 s50, 0
    s_cbranch_scc1 L_cap41
    s_waitcnt vmcnt(5)
    s_cmp_le_u32 s50, 2
    s_cbranch_scc1 L_cap41
    s_waitcnt vmcnt(4)
L_cap41:
    buffer_load_dwordx4 v6, s[12:15], s51 offen offset:0 nt lds
    v_mfma_f32_32x32x16_bf16 v[112:127], a[200:203], v[168:171], v[112:127]
    v_exp_f32 v151, v151
    v_add_f32 v22, v22, v148
    v_add_f32 v22, v22, v149
    v_cvt_pk_bf16_f32 v146, v148, v149
    v_exp_f32 v152, v152
    v_mfma_f32_32x32x16_bf16 v[112:127], a[204:207], v[172:175], v[112:127]
    v_exp_f32 v153, v153
    v_add_f32 v22, v22, v150
    v_add_f32 v22, v22, v151
    v_cvt_pk_bf16_f32 v147, v150, v151
    v_exp_f32 v154, v154
    v_mfma_f32_32x32x16_bf16 v[112:127], a[208:211], v[176:179], v[112:127]
    s_add_u32 s35, s35, 16384
    s_and_b32 s35, s35, 0x3ffff
    s_cmp_le_u32 s50, 0
    s_cbranch_scc1 L_cap42
    s_waitcnt vmcnt(5)
    s_cmp_le_u32 s50, 2
    s_cbranch_scc1 L_cap42
    s_waitcnt vmcnt(4)
L_cap42:
    buffer_load_dwordx4 v6, s[12:15], s51 offen offset:1024 nt lds
    v_mfma_f32_32x32x16_bf16 v[112:127], a[212:215], v[180:183], v[112:127]
    v_exp_f32 v155, v155
    v_add_f32 v22, v22, v152
    v_add_f32 v22, v22, v153
    v_cvt_pk_bf16_f32 v152, v152, v153
    v_exp_f32 v156, v156
    v_mfma_f32_32x32x16_bf16 v[112:127], a[216:219], v[184:187], v[112:127]
    v_exp_f32 v157, v157
    v_add_f32 v22, v22, v154
    v_add_f32 v22, v22, v155
    v_cvt_pk_bf16_f32 v153, v154, v155
    v_exp_f32 v158, v158
    v_mfma_f32_32x32x16_bf16 v[112:127], a[220:223], v[188:191], v[112:127]
    s_cmp_le_u32 s50, 0
    s_cbranch_scc1 L_cap43
    s_waitcnt vmcnt(6)
    s_cmp_le_u32 s50, 2
    s_cbranch_scc1 L_cap43
    s_waitcnt vmcnt(4)
L_cap43:
    buffer_load_dwordx4 v6, s[12:15], s51 offen offset:2048 nt lds
    v_mfma_f32_32x32x16_bf16 a[32:47], a[224:227], v[144:147], a[32:47]
    v_exp_f32 v159, v159
    v_add_f32 v22, v22, v156
    v_add_f32 v22, v22, v157
    v_cvt_pk_bf16_f32 v154, v156, v157
    v_add_f32 v22, v22, v158
    v_add_f32 v22, v22, v159
    v_mfma_f32_32x32x16_bf16 a[80:95], a[232:235], v[144:147], a[80:95]
    v_cvt_pk_bf16_f32 v155, v158, v159
    v_mfma_f32_32x32x16_bf16 a[128:143], a[240:243], v[144:147], a[128:143]
    s_cmp_le_u32 s50, 0
    s_cbranch_scc1 L_cap44
    s_waitcnt vmcnt(5)
    s_cmp_le_u32 s50, 2
    s_cbranch_scc1 L_cap44
    s_waitcnt vmcnt(4)
L_cap44:
    buffer_load_dwordx4 v6, s[12:15], s51 offen offset:3072 nt lds
    v_max3_f32 v23, v112, v113, v114
    v_max3_f32 v23, v23, v115, v116
    v_mfma_f32_32x32x16_bf16 a[176:191], a[248:251], v[144:147], a[176:191]
    v_max3_f32 v23, v23, v117, v118
    v_max3_f32 v23, v23, v119, v120
    v_max3_f32 v23, v23, v121, v122
    v_max3_f32 v23, v23, v123, v124
    v_max3_f32 v23, v23, v125, v126
    v_max_f32 v23, v23, v127
    v_cmp_lt_f32 vcc, s43, v23
    s_cbranch_vccz L_sk3_0
    s_call_b64 s[40:41], L_rare0
L_sk3_0:
    v_mfma_f32_32x32x16_bf16 a[32:47], a[228:231], v[152:155], a[32:47]
    v_exp_f32 v112, v112
    v_exp_f32 v113, v113
    v_exp_f32 v114, v114
    v_exp_f32 v115, v115
    v_mfma_f32_32x32x16_bf16 a[80:95], a[236:239], v[152:155], a[80:95]
    s_add_u32 m0, s37, 4096
    s_add_u32 s51, s51, 4096
    s_cmp_le_u32 s50, 0
    s_cbranch_scc1 L_cap45
    s_waitcnt vmcnt(5)
    s_cmp_le_u32 s50, 2
    s_cbranch_scc1 L_cap45
    s_waitcnt vmcnt(4)
L_cap45:
    buffer_load_dwordx4 v6, s[12:15], s51 offen offset:0 nt lds
    v_mfma_f32_32x32x16_bf16 a[128:143], a[244:247], v[152:155], a[128:143]
    v_add_f32 v20, v20, v112
    v_add_f32 v20, v20, v113
    v_cvt_pk_bf16_f32 v112, v112, v113
    v_exp_f32 v116, v116
    v_exp_f32 v117, v117
    v_add_f32 v20, v20, v114
    v_mfma_f32_32x32x16_bf16 a[176:191], a[252:255], v[152:155], a[176:191]
    v_add_f32 v20, v20, v115
    v_cvt_pk_bf16_f32 v113, v114, v115
    v_exp_f32 v118, v118
    v_exp_f32 v119, v119
    v_add_f32 v20, v20, v116
    v_add_f32 v20, v20, v117
    v_mfma_f32_32x32x16_bf16 v[128:143], a[192:195], v[192:195], v[48:63]
    s_cmp_le_u32 s50, 0
    s_cbranch_scc1 L_cap46
    s_waitcnt vmcnt(6)
    s_cmp_le_u32 s50, 2
    s_cbranch_scc1 L_cap46
    s_waitcnt vmcnt(4)
L_cap46:
    buffer_load_dwordx4 v6, s[12:15], s51 offen offset:1024 nt lds
    s_waitcnt vmcnt(14)
    ds_read_b64_tr_b16 a[224:225], v16 offset:32768
    ds_read_b64_tr_b16 a[226:227], v16 offset:34816
    v_mfma_f32_32x32x16_bf16 v[128:143], a[196:199], v[196:199], v[128:143]
    ds_read_b64_tr_b16 a[232:233], v17 offset:32768
    ds_read_b64_tr_b16 a[234:235], v17 offset:34816
    ds_read_b64_tr_b16 a[240:241], v18 offset:32768
    v_cvt_pk_bf16_f32 v114, v116, v117
    v_exp_f32 v120, v120
    v_exp_f32 v121, v121
    v_mfma_f32_32x32x16_bf16 v[128:143], a[200:203], v[200:203], v[128:143]
    ds_read_b64_tr_b16 a[242:243], v18 offset:34816
    ds_read_b64_tr_b16 a[248:249], v19 offset:32768
    v_add_f32 v20, v20, v118
    v_add_f32 v20, v20, v119
    v_cvt_pk_bf16_f32 v115, v118, v119
    v_exp_f32 v122, v122
    v_mfma_f32_32x32x16_bf16 v[128:143], a[204:207], v[204:207], v[128:143]
    s_cmp_le_u32 s50, 0
    s_cbranch_scc1 L_cap47
    s_waitcnt vmcnt(5)
    s_cmp_le_u32 s50, 2
    s_cbranch_scc1 L_cap47
    s_waitcnt vmcnt(4)
L_cap47:
    buffer_load_dwordx4 v6, s[12:15], s51 offen offset:2048 nt lds
    ds_read_b64_tr_b16 a[250:251], v19 offset:34816
    ds_read_b64_tr_b16 a[228:229], v16 offset:36864
    ds_read_b64_tr_b16 a[230:231], v16 offset:38912
    v_mfma_f32_32x32x16_bf16 v[128:143], a[208:211], v[208:211], v[128:143]
    ds_read_b64_tr_b16 a[236:237], v17 offset:36864
    ds_read_b64_tr_b16 a[238:239], v17 offset:38912
    ds_read_b64_tr_b16 a[244:245], v18 offset:36864
    v_exp_f32 v123, v123
    v_add_f32 v20, v20, v120
    v_add_f32 v20, v20, v121
    v_cvt_pk_bf16_f32 v120, v120, v121
    v_mfma_f32_32x32x16_bf16 v[128:143], a[212:215], v[212:215], v[128:143]
    ds_read_b64_tr_b16 a[246:247], v18 offset:38912
    ds_read_b64_tr_b16 a[252:253], v19 offset:36864
    ds_read_b64_tr_b16 a[254:255], v19 offset:38912
    v_exp_f32 v124, v124
    v_exp_f32 v125, v125
    v_add_f32 v20, v20, v122
    v_mfma_f32_32x32x16_bf16 v[128:143], a[216:219], v[216:219], v[128:143]
    s_cmp_le_u32 s50, 0
    s_cbranch_scc1 L_cap48
    s_waitcnt vmcnt(5)
    s_cmp_le_u32 s50, 2
    s_cbranch_scc1 L_cap48
    s_waitcnt vmcnt(4)
L_cap48:
    buffer_load_dwordx4 v6, s[12:15], s51 offen offset:3072 nt lds
    v_add_f32 v20, v20, v123
    v_cvt_pk_bf16_f32 v121, v122, v123
    v_mfma_f32_32x32x16_bf16 v[128:143], a[220:223], v[220:223], v[128:143]
    v_exp_f32 v126, v126
    v_exp_f32 v127, v127
    v_add_f32 v20, v20, v124
    v_add_f32 v20, v20, v125
    v_cvt_pk_bf16_f32 v122, v124, v125
    v_add_f32 v20, v20, v126
    s_waitcnt lgkmcnt(0)
    v_mfma_f32_32x32x16_bf16 a[0:15], a[224:227], v[112:115], a[0:15]
    v_add_f32 v20, v20, v127
    v_cvt_pk_bf16_f32 v123, v126, v127
    v_mfma_f32_32x32x16_bf16 a[48:63], a[232:235], v[112:115], a[48:63]
    s_add_u32 m0, s37, 32768
    s_add_u32 s51, s34, s36
    s_cmp_le_u32 s50, 0
    s_cbranch_scc1 L_cap49
    s_waitcnt vmcnt(5)
    s_cmp_le_u32 s50, 2
    s_cbranch_scc1 L_cap49
    s_waitcnt vmcnt(4)
L_cap49:
    buffer_load_dwordx4 v2, s[8:11], s51 offen offset:0 nt lds
    v_mfma_f32_32x32x16_bf16 a[96:111], a[240:243], v[112:115], a[96:111]
    v_max3_f32 v24, v128, v129, v130
    v_max3_f32 v24, v24, v131, v132
    v_max3_f32 v24, v24, v133, v134
    v_max3_f32 v24, v24, v135, v136
    v_max3_f32 v24, v24, v137, v138
    v_max3_f32 v24, v24, v139, v140
    v_max3_f32 v24, v24, v141, v142
    v_mfma_f32_32x32x16_bf16 a[144:159], a[248:251], v[112:115], a[144:159]
    v_max_f32 v24, v24, v143
    v_cmp_lt_f32 vcc, s43, v24
    s_cbranch_vccz L_sk3_1
    s_call_b64 s[40:41], L_rare1
L_sk3_1:
    v_exp_f32 v128, v128
    v_exp_f32 v129, v129
    v_mfma_f32_32x32x16_bf16 a[0:15], a[228:231], v[120:123], a[0:15]
    s_add_u32 s36, s36, 16384
    s_and_b32 s36, s36, 0x3ffff
    s_cmp_le_u32 s50, 0
    s_cbranch_scc1 L_cap50
    s_waitcnt vmcnt(5)
    s_cmp_le_u32 s50, 2
    s_cbranch_scc1 L_cap50
    s_waitcnt vmcnt(4)
L_cap50:
    buffer_load_dwordx4 v3, s[8:11], s51 offen offset:1024 nt lds
    v_mfma_f32_32x32x16_bf16 a[48:63], a[236:239], v[120:123], a[48:63]
    v_exp_f32 v130, v130
    v_exp_f32 v131, v131
    v_add_f32 v21, v21, v128
    v_add_f32 v21, v21, v129
    v_cvt_pk_bf16_f32 v128, v128, v129
    v_mfma_f32_32x32x16_bf16 a[96:111], a[244:247], v[120:123], a[96:111]
    v_exp_f32 v132, v132
    v_exp_f32 v133, v133
    v_add_f32 v21, v21, v130
    v_add_f32 v21, v21, v131
    v_cvt_pk_bf16_f32 v129, v130, v131
    v_mfma_f32_32x32x16_bf16 a[144:159], a[252:255], v[120:123], a[144:159]
    s_cmp_le_u32 s50, 0
    s_cbranch_scc1 L_cap51
    s_waitcnt vmcnt(6)
    s_cmp_le_u32 s50, 2
    s_cbranch_scc1 L_cap51
    s_waitcnt vmcnt(4)
L_cap51:
    buffer_load_dwordx4 v4, s[8:11], s51 offen offset:2048 nt lds
    v_mfma_f32_32x32x16_bf16 v[144:159], a[192:195], v[224:227], v[64:79]
    v_exp_f32 v134, v134
    v_exp_f32 v135, v135
    v_add_f32 v21, v21, v132
    v_add_f32 v21, v21, v133
    v_cvt_pk_bf16_f32 v130, v132, v133
    v_mfma_f32_32x32x16_bf16 v[144:159], a[196:199], v[228:231], v[144:159]
    v_exp_f32 v136, v136
    v_exp_f32 v137, v137
    v_add_f32 v21, v21, v134
    v_add_f32 v21, v21, v135
    v_cvt_pk_bf16_f32 v131, v134, v135
    v_mfma_f32_32x32x16_bf16 v[144:159], a[200:203], v[232:235], v[144:159]
    s_cmp_le_u32 s50, 0
    s_cbranch_scc1 L_cap52
    s_waitcnt vmcnt(5)
    s_cmp_le_u32 s50, 2
    s_cbranch_scc1 L_cap52
    s_waitcnt vmcnt(4)
L_cap52:
    buffer_load_dwordx4 v5, s[8:11], s51 offen offset:3072 nt lds
    v_mfma_f32_32x32x16_bf16 v[144:159], a[204:207], v[236:239], v[144:159]
    v_exp_f32 v138, v138
    v_exp_f32 v139, v139
    v_add_f32 v21, v21, v136
    v_add_f32 v21, v21, v137
    v_cvt_pk_bf16_f32 v136, v136, v137
    v_mfma_f32_32x32x16_bf16 v[144:159], a[208:211], v[240:243], v[144:159]
    v_exp_f32 v140, v140
    v_exp_f32 v141, v141
    v_add_f32 v21, v21, v138
    v_add_f32 v21, v21, v139
    v_cvt_pk_bf16_f32 v137, v138, v139
    v_mfma_f32_32x32x16_bf16 v[144:159], a[212:215], v[244:247], v[144:159]
    s_add_u32 m0, s37, 36864
    s_add_u32 s51, s51, 4096
    s_cmp_le_u32 s50, 0
    s_cbranch_scc1 L_cap53
    s_waitcnt vmcnt(5)
    s_cmp_le_u32 s50, 2
    s_cbranch_scc1 L_cap53
    s_waitcnt vmcnt(4)
L_cap53:
    buffer_load_dwordx4 v2, s[8:11], s51 offen offset:0 nt lds
    v_mfma_f32_32x32x16_bf16 v[144:159], a[216:219], v[248:251], v[144:159]
    v_exp_f32 v142, v142
    v_exp_f32 v143, v143
    v_add_f32 v21, v21, v140
    v_add_f32 v21, v21, v141
    v_cvt_pk_bf16_f32 v138, v140, v141
    v_mfma_f32_32x32x16_bf16 v[144:159], a[220:223], v[252:255], v[144:159]
    v_add_f32 v21, v21, v142
    v_add_f32 v21, v21, v143
    v_cvt_pk_bf16_f32 v139, v142, v143
    v_mfma_f32_32x32x16_bf16 a[16:31], a[224:227], v[128:131], a[16:31]
    s_cmp_le_u32 s50, 0
    s_cbranch_scc1 L_cap54
    s_waitcnt vmcnt(6)
    s_cmp_le_u32 s50, 2
    s_cbranch_scc1 L_cap54
    s_waitcnt vmcnt(4)
L_cap54:
    buffer_load_dwordx4 v3, s[8:11], s51 offen offset:1024 nt lds
    s_waitcnt vmcnt(14)
    ds_read_b128 a[192:195], v8 offset:16384
    v_mfma_f32_32x32x16_bf16 a[64:79], a[232:235], v[128:131], a[64:79]
    ds_read_b128 a[196:199], v9 offset:16384
    ds_read_b128 a[200:203], v10 offset:16384
    v_mfma_f32_32x32x16_bf16 a[112:127], a[240:243], v[128:131], a[112:127]
    ds_read_b128 a[204:207], v11 offset:16384
    ds_read_b128 a[208:211], v12 offset:16384
    ds_read_b128 a[212:215], v13 offset:16384
    v_max3_f32 v25, v144, v145, v146
    v_max3_f32 v25, v25, v147, v148
    v_max3_f32 v25, v25, v149, v150
    v_max3_f32 v25, v25, v151, v152
    v_mfma_f32_32x32x16_bf16 a[160:175], a[248:251], v[128:131], a[160:175]
    s_cmp_le_u32 s50, 0
    s_cbranch_scc1 L_cap55
    s_waitcnt vmcnt(5)
    s_cmp_le_u32 s50, 2
    s_cbranch_scc1 L_cap55
    s_waitcnt vmcnt(4)
L_cap55:
    buffer_load_dwordx4 v4, s[8:11], s51 offen offset:2048 nt lds
    ds_read_b128 a[216:219], v14 offset:16384
    ds_read_b128 a[220:223], v15 offset:16384
    v_mfma_f32_32x32x16_bf16 a[16:31], a[228:231], v[136:139], a[16:31]
    v_max3_f32 v25, v25, v153, v154
    v_max3_f32 v25, v25, v155, v156
    v_max3_f32 v25, v25, v157, v158
    v_max_f32 v25, v25, v159
    v_cmp_lt_f32 vcc, s43, v25
    s_cbranch_vccz L_sk3_2
    s_call_b64 s[40:41], L_rare2
L_sk3_2:
    v_mfma_f32_32x32x16_bf16 a[64:79], a[236:239], v[136:139], a[64:79]
    v_exp_f32 v144, v144
    v_exp_f32 v145, v145
    v_exp_f32 v146, v146
    v_mfma_f32_32x32x16_bf16 a[112:127], a[244:247], v[136:139], a[112:127]
    s_cmp_le_u32 s50, 0
    s_cbranch_scc1 L_cap56
    s_waitcnt vmcnt(5)
    s_cmp_le_u32 s50, 2
    s_cbranch_scc1 L_cap56
    s_waitcnt vmcnt(4)
L_cap56:
    buffer_load_dwordx4 v5, s[8:11], s51 offen offset:3072 nt lds
    v_mfma_f32_32x32x16_bf16 a[160:175], a[252:255], v[136:139], a[160:175]
    v_exp_f32 v147, v147
    v_add_f32 v22, v22, v144
    v_add_f32 v22, v22, v145
    v_cvt_pk_bf16_f32 v144, v144, v145
    v_exp_f32 v148, v148
    s_waitcnt lgkmcnt(0)
    v_mfma_f32_32x32x16_bf16 v[112:127], a[192:195], v[160:163], v[32:47]
    v_exp_f32 v149, v149
    v_add_f32 v22, v22, v146
    v_add_f32 v22, v22, v147
    v_cvt_pk_bf16_f32 v145, v146, v147
    v_exp_f32 v150, v150
    v_mfma_f32_32x32x16_bf16 v[112:127], a[196:199], v[164:167], v[112:127]
    s_add_u32 m0, s37, 16384
    s_add_u32 s51, s34, s35
    s_cmp_le_u32 s50, 0
    s_cbranch_scc1 L_cap57
    s_waitcnt vmcnt(5)
    s_cmp_le_u32 s50, 2
    s_cbranch_scc1 L_cap57
    s_waitcnt vmcnt(4)
L_cap57:
    buffer_load_dwordx4 v6, s[12:15], s51 offen offset:0 nt lds
    v_mfma_f32_32x32x16_bf16 v[112:127], a[200:203], v[168:171], v[112:127]
    v_exp_f32 v151, v151
    v_add_f32 v22, v22, v148
    v_add_f32 v22, v22, v149
    v_cvt_pk_bf16_f32 v146, v148, v149
    v_exp_f32 v152, v152
    v_mfma_f32_32x32x16_bf16 v[112:127], a[204:207], v[172:175], v[112:127]
    v_exp_f32 v153, v153
    v_add_f32 v22, v22, v150
    v_add_f32 v22, v22, v151
    v_cvt_pk_bf16_f32 v147, v150, v151
    v_exp_f32 v154, v154
    v_mfma_f32_32x32x16_bf16 v[112:127], a[208:211], v[176:179], v[112:127]
    s_add_u32 s35, s35, 16384
    s_and_b32 s35, s35, 0x3ffff
    s_cmp_le_u32 s50, 0
    s_cbranch_scc1 L_cap58
    s_waitcnt vmcnt(5)
    s_cmp_le_u32 s50, 2
    s_cbranch_scc1 L_cap58
    s_waitcnt vmcnt(4)
L_cap58:
    buffer_load_dwordx4 v6, s[12:15], s51 offen offset:1024 nt lds
    v_mfma_f32_32x32x16_bf16 v[112:127], a[212:215], v[180:183], v[112:127]
    v_exp_f32 v155, v155
    v_add_f32 v22, v22, v152
    v_add_f32 v22, v22, v153
    v_cvt_pk_bf16_f32 v152, v152, v153
    v_exp_f32 v156, v156
    v_mfma_f32_32x32x16_bf16 v[112:127], a[216:219], v[184:187], v[112:127]
    v_exp_f32 v157, v157
    v_add_f32 v22, v22, v154
    v_add_f32 v22, v22, v155
    v_cvt_pk_bf16_f32 v153, v154, v155
    v_exp_f32 v158, v158
    v_mfma_f32_32x32x16_bf16 v[112:127], a[220:223], v[188:191], v[112:127]
    s_cmp_le_u32 s50, 0
    s_cbranch_scc1 L_cap59
    s_waitcnt vmcnt(6)
    s_cmp_le_u32 s50, 2
    s_cbranch_scc1 L_cap59
    s_waitcnt vmcnt(4)
L_cap59:
    buffer_load_dwordx4 v6, s[12:15], s51 offen offset:2048 nt lds
    v_mfma_f32_32x32x16_bf16 a[32:47], a[224:227], v[144:147], a[32:47]
    v_exp_f32 v159, v159
    v_add_f32 v22, v22, v156
    v_add_f32 v22, v22, v157
    v_cvt_pk_bf16_f32 v154, v156, v157
    v_add_f32 v22, v22, v158
    v_add_f32 v22, v22, v159
    v_mfma_f32_32x32x16_bf16 a[80:95], a[232:235], v[144:147], a[80:95]
    v_cvt_pk_bf16_f32 v155, v158, v159
    v_mfma_f32_32x32x16_bf16 a[128:143], a[240:243], v[144:147], a[128:143]
    s_cmp_le_u32 s50, 0
    s_cbranch_scc1 L_cap60
    s_waitcnt vmcnt(5)
    s_cmp_le_u32 s50, 2
    s_cbranch_scc1 L_cap60
    s_waitcnt vmcnt(4)
L_cap60:
    buffer_load_dwordx4 v6, s[12:15], s51 offen offset:3072 nt lds
    v_max3_f32 v23, v112, v113, v114
    v_max3_f32 v23, v23, v115, v116
    v_mfma_f32_32x32x16_bf16 a[176:191], a[248:251], v[144:147], a[176:191]
    v_max3_f32 v23, v23, v117, v118
    v_max3_f32 v23, v23, v119, v120
    v_max3_f32 v23, v23, v121, v122
    v_max3_f32 v23, v23, v123, v124
    v_max3_f32 v23, v23, v125, v126
    v_max_f32 v23, v23, v127
    v_cmp_lt_f32 vcc, s43, v23
    s_cbranch_vccz L_sk4_0
    s_call_b64 s[40:41], L_rare0
L_sk4_0:
    v_mfma_f32_32x32x16_bf16 a[32:47], a[228:231], v[152:155], a[32:47]
    v_exp_f32 v112, v112
    v_exp_f32 v113, v113
    v_exp_f32 v114, v114
    v_exp_f32 v115, v115
    v_mfma_f32_32x32x16_bf16 a[80:95], a[236:239], v[152:155], a[80:95]
    s_add_u32 m0, s37, 20480
    s_add_u32 s51, s51, 4096
    s_cmp_le_u32 s50, 0
    s_cbranch_scc1 L_cap61
    s_waitcnt vmcnt(5)
    s_cmp_le_u32 s50, 2
    s_cbranch_scc1 L_cap61
    s_waitcnt vmcnt(4)
L_cap61:
    buffer_load_dwordx4 v6, s[12:15], s51 offen offset:0 nt lds
    v_mfma_f32_32x32x16_bf16 a[128:143], a[244:247], v[152:155], a[128:143]
    v_add_f32 v20, v20, v112
    v_add_f32 v20, v20, v113
    v_cvt_pk_bf16_f32 v112, v112, v113
    v_exp_f32 v116, v116
    v_exp_f32 v117, v117
    v_add_f32 v20, v20, v114
    v_mfma_f32_32x32x16_bf16 a[176:191], a[252:255], v[152:155], a[176:191]
    v_add_f32 v20, v20, v115
    v_cvt_pk_bf16_f32 v113, v114, v115
    v_exp_f32 v118, v118
    v_exp_f32 v119, v119
    v_add_f32 v20, v20, v116
    v_add_f32 v20, v20, v117
    v_mfma_f32_32x32x16_bf16 v[128:143], a[192:195], v[192:195], v[48:63]
    s_cmp_le_u32 s50, 0
    s_cbranch_scc1 L_cap62
    s_waitcnt vmcnt(6)
    s_cmp_le_u32 s50, 2
    s_cbranch_scc1 L_cap62
    s_waitcnt vmcnt(4)
L_cap62:
    buffer_load_dwordx4 v6, s[12:15], s51 offen offset:1024 nt lds
    s_waitcnt vmcnt(14)
    ds_read_b64_tr_b16 a[224:225], v16 offset:0
    ds_read_b64_tr_b16 a[226:227], v16 offset:2048
    v_mfma_f32_32x32x16_bf16 v[128:143], a[196:199], v[196:199], v[128:143]
    ds_read_b64_tr_b16 a[232:233], v17 offset:0
    ds_read_b64_tr_b16 a[234:235], v17 offset:2048
    ds_read_b64_tr_b16 a[240:241], v18 offset:0
    v_cvt_pk_bf16_f32 v114, v116, v117
    v_exp_f32 v120, v120
    v_exp_f32 v121, v121
    v_mfma_f32_32x32x16_bf16 v[128:143], a[200:203], v[200:203], v[128:143]
    ds_read_b64_tr_b16 a[242:243], v18 offset:2048
    ds_read_b64_tr_b16 a[248:249], v19 offset:0
    v_add_f32 v20, v20, v118
    v_add_f32 v20, v20, v119
    v_cvt_pk_bf16_f32 v115, v118, v119
    v_exp_f32 v122, v122
    v_mfma_f32_32x32x16_bf16 v[128:143], a[204:207], v[204:207], v[128:143]
    s_cmp_le_u32 s50, 0
    s_cbranch_scc1 L_cap63
    s_waitcnt vmcnt(5)
    s_cmp_le_u32 s50, 2
    s_cbranch_scc1 L_cap63
    s_waitcnt vmcnt(4)
L_cap63:
    buffer_load_dwordx4 v6, s[12:15], s51 offen offset:2048 nt lds
    ds_read_b64_tr_b16 a[250:251], v19 offset:2048
    ds_read_b64_tr_b16 a[228:229], v16 offset:4096
    ds_read_b64_tr_b16 a[230:231], v16 offset:6144
    v_mfma_f32_32x32x16_bf16 v[128:143], a[208:211], v[208:211], v[128:143]
    ds_read_b64_tr_b16 a[236:237], v17 offset:4096
    ds_read_b64_tr_b16 a[238:239], v17 offset:6144
    ds_read_b64_tr_b16 a[244:245], v18 offset:4096
    v_exp_f32 v123, v123
    v_add_f32 v20, v20, v120
    v_add_f32 v20, v20, v121
    v_cvt_pk_bf16_f32 v120, v120, v121
    v_mfma_f32_32x32x16_bf16 v[128:143], a[212:215], v[212:215], v[128:143]
    ds_read_b64_tr_b16 a[246:247], v18 offset:6144
    ds_read_b64_tr_b16 a[252:253], v19 offset:4096
    ds_read_b64_tr_b16 a[254:255], v19 offset:6144
    v_exp_f32 v124, v124
    v_exp_f32 v125, v125
    v_add_f32 v20, v20, v122
    v_mfma_f32_32x32x16_bf16 v[128:143], a[216:219], v[216:219], v[128:143]
    s_cmp_le_u32 s50, 0
    s_cbranch_scc1 L_cap64
    s_waitcnt vmcnt(5)
    s_cmp_le_u32 s50, 2
    s_cbranch_scc1 L_cap64
    s_waitcnt vmcnt(4)
L_cap64:
    buffer_load_dwordx4 v6, s[12:15], s51 offen offset:3072 nt lds
    v_add_f32 v20, v20, v123
    v_cvt_pk_bf16_f32 v121, v122, v123
    v_mfma_f32_32x32x16_bf16 v[128:143], a[220:223], v[220:223], v[128:143]
    v_exp_f32 v126, v126
    v_exp_f32 v127, v127
    v_add_f32 v20, v20, v124
    v_add_f32 v20, v20, v125
    v_cvt_pk_bf16_f32 v122, v124, v125
    v_add_f32 v20, v20, v126
    s_waitcnt lgkmcnt(0)
    v_mfma_f32_32x32x16_bf16 a[0:15], a[224:227], v[112:115], a[0:15]
    v_add_f32 v20, v20, v127
    v_cvt_pk_bf16_f32 v123, v126, v127
    v_mfma_f32_32x32x16_bf16 a[48:63], a[232:235], v[112:115], a[48:63]
    s_add_u32 m0, s37, 0
    s_add_u32 s51, s34, s36
    s_cmp_le_u32 s50, 0
    s_cbranch_scc1 L_cap65
    s_waitcnt vmcnt(5)
    s_cmp_le_u32 s50, 2
    s_cbranch_scc1 L_cap65
    s_waitcnt vmcnt(4)
L_cap65:
    buffer_load_dwordx4 v2, s[8:11], s51 offen offset:0 nt lds
    v_mfma_f32_32x32x16_bf16 a[96:111], a[240:243], v[112:115], a[96:111]
    v_max3_f32 v24, v128, v129, v130
    v_max3_f32 v24, v24, v131, v132
    v_max3_f32 v24, v24, v133, v134
    v_max3_f32 v24, v24, v135, v136
    v_max3_f32 v24, v24, v137, v138
    v_max3_f32 v24, v24, v139, v140
    v_max3_f32 v24, v24, v141, v142
    v_mfma_f32_32x32x16_bf16 a[144:159], a[248:251], v[112:115], a[144:159]
    v_max_f32 v24, v24, v143
    v_cmp_lt_f32 vcc, s43, v24
    s_cbranch_vccz L_sk4_1
    s_call_b64 s[40:41], L_rare1
L_sk4_1:
    v_exp_f32 v128, v128
    v_exp_f32 v129, v129
    v_mfma_f32_32x32x16_bf16 a[0:15], a[228:231], v[120:123], a[0:15]
    s_add_u32 s36, s36, 16384
    s_and_b32 s36, s36, 0x3ffff
    s_cmp_le_u32 s50, 0
    s_cbranch_scc1 L_cap66
    s_waitcnt vmcnt(5)
    s_cmp_le_u32 s50, 2
    s_cbranch_scc1 L_cap66
    s_waitcnt vmcnt(4)
L_cap66:
    buffer_load_dwordx4 v3, s[8:11], s51 offen offset:1024 nt lds
    v_mfma_f32_32x32x16_bf16 a[48:63], a[236:239], v[120:123], a[48:63]
    v_exp_f32 v130, v130
    v_exp_f32 v131, v131
    v_add_f32 v21, v21, v128
    v_add_f32 v21, v21, v129
    v_cvt_pk_bf16_f32 v128, v128, v129
    v_mfma_f32_32x32x16_bf16 a[96:111], a[244:247], v[120:123], a[96:111]
    v_exp_f32 v132, v132
    v_exp_f32 v133, v133
    v_add_f32 v21, v21, v130
    v_add_f32 v21, v21, v131
    v_cvt_pk_bf16_f32 v129, v130, v131
    v_mfma_f32_32x32x16_bf16 a[144:159], a[252:255], v[120:123], a[144:159]
    s_cmp_le_u32 s50, 0
    s_cbranch_scc1 L_cap67
    s_waitcnt vmcnt(6)
    s_cmp_le_u32 s50, 2
    s_cbranch_scc1 L_cap67
    s_waitcnt vmcnt(4)
L_cap67:
    buffer_load_dwordx4 v4, s[8:11], s51 offen offset:2048 nt lds
    v_mfma_f32_32x32x16_bf16 v[144:159], a[192:195], v[224:227], v[64:79]
    v_exp_f32 v134, v134
    v_exp_f32 v135, v135
    v_add_f32 v21, v21, v132
    v_add_f32 v21, v21, v133
    v_cvt_pk_bf16_f32 v130, v132, v133
    v_mfma_f32_32x32x16_bf16 v[144:159], a[196:199], v[228:231], v[144:159]
    v_exp_f32 v136, v136
    v_exp_f32 v137, v137
    v_add_f32 v21, v21, v134
    v_add_f32 v21, v21, v135
    v_cvt_pk_bf16_f32 v131, v134, v135
    v_mfma_f32_32x32x16_bf16 v[144:159], a[200:203], v[232:235], v[144:159]
    s_cmp_le_u32 s50, 0
    s_cbranch_scc1 L_cap68
    s_waitcnt vmcnt(5)
    s_cmp_le_u32 s50, 2
    s_cbranch_scc1 L_cap68
    s_waitcnt vmcnt(4)
L_cap68:
    buffer_load_dwordx4 v5, s[8:11], s51 offen offset:3072 nt lds
    v_mfma_f32_32x32x16_bf16 v[144:159], a[204:207], v[236:239], v[144:159]
    v_exp_f32 v138, v138
    v_exp_f32 v139, v139
    v_add_f32 v21, v21, v136
    v_add_f32 v21, v21, v137
    v_cvt_pk_bf16_f32 v136, v136, v137
    v_mfma_f32_32x32x16_bf16 v[144:159], a[208:211], v[240:243], v[144:159]
    v_exp_f32 v140, v140
    v_exp_f32 v141, v141
    v_add_f32 v21, v21, v138
    v_add_f32 v21, v21, v139
    v_cvt_pk_bf16_f32 v137, v138, v139
    v_mfma_f32_32x32x16_bf16 v[144:159], a[212:215], v[244:247], v[144:159]
    s_add_u32 m0, s37, 4096
    s_add_u32 s51, s51, 4096
    s_cmp_le_u32 s50, 0
    s_cbranch_scc1 L_cap69
    s_waitcnt vmcnt(5)
    s_cmp_le_u32 s50, 2
    s_cbranch_scc1 L_cap69
    s_waitcnt vmcnt(4)
L_cap69:
    buffer_load_dwordx4 v2, s[8:11], s51 offen offset:0 nt lds
    v_mfma_f32_32x32x16_bf16 v[144:159], a[216:219], v[248:251], v[144:159]
    v_exp_f32 v142, v142
    v_exp_f32 v143, v143
    v_add_f32 v21, v21, v140
    v_add_f32 v21, v21, v141
    v_cvt_pk_bf16_f32 v138, v140, v141
    v_mfma_f32_32x32x16_bf16 v[144:159], a[220:223], v[252:255], v[144:159]
    v_add_f32 v21, v21, v142
    v_add_f32 v21, v21, v143
    v_cvt_pk_bf16_f32 v139, v142, v143
    v_mfma_f32_32x32x16_bf16 a[16:31], a[224:227], v[128:131], a[16:31]
    s_cmp_le_u32 s50, 0
    s_cbranch_scc1 L_cap70
    s_waitcnt vmcnt(6)
    s_cmp_le_u32 s50, 2
    s_cbranch_scc1 L_cap70
    s_waitcnt vmcnt(4)
L_cap70:
    buffer_load_dwordx4 v3, s[8:11], s51 offen offset:1024 nt lds
    s_waitcnt vmcnt(14)
    ds_read_b128 a[192:195], v8 offset:32768
    v_mfma_f32_32x32x16_bf16 a[64:79], a[232:235], v[128:131], a[64:79]
    ds_read_b128 a[196:199], v9 offset:32768
    ds_read_b128 a[200:203], v10 offset:32768
    v_mfma_f32_32x32x16_bf16 a[112:127], a[240:243], v[128:131], a[112:127]
    ds_read_b128 a[204:207], v11 offset:32768
    ds_read_b128 a[208:211], v12 offset:32768
    ds_read_b128 a[212:215], v13 offset:32768
    v_max3_f32 v25, v144, v145, v146
    v_max3_f32 v25, v25, v147, v148
    v_max3_f32 v25, v25, v149, v150
    v_max3_f32 v25, v25, v151, v152
    v_mfma_f32_32x32x16_bf16 a[160:175], a[248:251], v[128:131], a[160:175]
    s_cmp_le_u32 s50, 0
    s_cbranch_scc1 L_cap71
    s_waitcnt vmcnt(5)
    s_cmp_le_u32 s50, 2
    s_cbranch_scc1 L_cap71
    s_waitcnt vmcnt(4)
L_cap71:
    buffer_load_dwordx4 v4, s[8:11], s51 offen offset:2048 nt lds
    ds_read_b128 a[216:219], v14 offset:32768
    ds_read_b128 a[220:223], v15 offset:32768
    v_mfma_f32_32x32x16_bf16 a[16:31], a[228:231], v[136:139], a[16:31]
    v_max3_f32 v25, v25, v153, v154
    v_max3_f32 v25, v25, v155, v156
    v_max3_f32 v25, v25, v157, v158
    v_max_f32 v25, v25, v159
    v_cmp_lt_f32 vcc, s43, v25
    s_cbranch_vccz L_sk4_2
    s_call_b64 s[40:41], L_rare2
L_sk4_2:
    v_mfma_f32_32x32x16_bf16 a[64:79], a[236:239], v[136:139], a[64:79]
    v_exp_f32 v144, v144
    v_exp_f32 v145, v145
    v_exp_f32 v146, v146
    v_mfma_f32_32x32x16_bf16 a[112:127], a[244:247], v[136:139], a[112:127]
    s_cmp_le_u32 s50, 0
    s_cbranch_scc1 L_cap72
    s_waitcnt vmcnt(5)
    s_cmp_le_u32 s50, 2
    s_cbranch_scc1 L_cap72
    s_waitcnt vmcnt(4)
L_cap72:
    buffer_load_dwordx4 v5, s[8:11], s51 offen offset:3072 nt lds
    v_mfma_f32_32x32x16_bf16 a[160:175], a[252:255], v[136:139], a[160:175]
    v_exp_f32 v147, v147
    v_add_f32 v22, v22, v144
    v_add_f32 v22, v22, v145
    v_cvt_pk_bf16_f32 v144, v144, v145
    v_exp_f32 v148, v148
    s_sub_u32 s46, s46, 1
    s_cmp_lg_u32 s46, 0
    s_cbranch_scc1 L_tile
    s_waitcnt lgkmcnt(0)
    v_mfma_f32_32x32x16_bf16 v[112:127], a[192:195], v[160:163], v[32:47]
    v_exp_f32 v149, v149
    v_add_f32 v22, v22, v146
    v_add_f32 v22, v22, v147
    v_cvt_pk_bf16_f32 v145, v146, v147
    v_exp_f32 v150, v150
    v_mfma_f32_32x32x16_bf16 v[112:127], a[196:199], v[164:167], v[112:127]
    s_add_u32 m0, s37, 32768
    s_add_u32 s51, s34, s35
    buffer_load_dwordx4 v6, s[12:15], s51 offen offset:0 nt lds
    v_mfma_f32_32x32x16_bf16 v[112:127], a[200:203], v[168:171], v[112:127]
    v_exp_f32 v151, v151
    v_add_f32 v22, v22, v148
    v_add_f32 v22, v22, v149
    v_cvt_pk_bf16_f32 v146, v148, v149
    v_exp_f32 v152, v152
    v_mfma_f32_32x32x16_bf16 v[112:127], a[204:207], v[172:175], v[112:127]
    v_exp_f32 v153, v153
    v_add_f32 v22, v22, v150
    v_add_f32 v22, v22, v151
    v_cvt_pk_bf16_f32 v147, v150, v151
    v_exp_f32 v154, v154
    v_mfma_f32_32x32x16_bf16 v[112:127], a[208:211], v[176:179], v[112:127]
    s_add_u32 s35, s35, 16384
    s_and_b32 s35, s35, 0x3ffff
    buffer_load_dwordx4 v6, s[12:15], s51 offen offset:1024 nt lds
    v_mfma_f32_32x32x16_bf16 v[112:127], a[212:215], v[180:183], v[112:127]
    v_exp_f32 v155, v155
    v_add_f32 v22, v22, v152
    v_add_f32 v22, v22, v153
    v_cvt_pk_bf16_f32 v152, v152, v153
    v_exp_f32 v156, v156
    v_mfma_f32_32x32x16_bf16 v[112:127], a[216:219], v[184:187], v[112:127]
    v_exp_f32 v157, v157
    v_add_f32 v22, v22, v154
    v_add_f32 v22, v22, v155
    v_cvt_pk_bf16_f32 v153, v154, v155
    v_exp_f32 v158, v158
    v_mfma_f32_32x32x16_bf16 v[112:127], a[220:223], v[188:191], v[112:127]
    buffer_load_dwordx4 v6, s[12:15], s51 offen offset:2048 nt lds
    v_mfma_f32_32x32x16_bf16 a[32:47], a[224:227], v[144:147], a[32:47]
    v_exp_f32 v159, v159
    v_add_f32 v22, v22, v156
    v_add_f32 v22, v22, v157
    v_cvt_pk_bf16_f32 v154, v156, v157
    v_add_f32 v22, v22, v158
    v_add_f32 v22, v22, v159
    v_mfma_f32_32x32x16_bf16 a[80:95], a[232:235], v[144:147], a[80:95]
    v_cvt_pk_bf16_f32 v155, v158, v159
    v_mfma_f32_32x32x16_bf16 a[128:143], a[240:243], v[144:147], a[128:143]
    buffer_load_dwordx4 v6, s[12:15], s51 offen offset:3072 nt lds
    v_max3_f32 v23, v112, v113, v114
    v_max3_f32 v23, v23, v115, v116
    v_max3_f32 v23, v23, v117, v118
    v_mfma_f32_32x32x16_bf16 a[176:191], a[248:251], v[144:147], a[176:191]
    v_max3_f32 v23, v23, v119, v120
    v_max3_f32 v23, v23, v121, v122
    v_max3_f32 v23, v23, v123, v124
    v_max3_f32 v23, v23, v125, v126
    v_max_f32 v23, v23, v127
    v_cmp_lt_f32 vcc, s43, v23
    s_cbranch_vccz L_sk14_0
    s_call_b64 s[40:41], L_rare0
L_sk14_0:
    v_mfma_f32_32x32x16_bf16 a[32:47], a[228:231], v[152:155], a[32:47]
    v_exp_f32 v112, v112
    v_exp_f32 v113, v113
    v_exp_f32 v114, v114
    v_mfma_f32_32x32x16_bf16 a[80:95], a[236:239], v[152:155], a[80:95]
    s_add_u32 m0, s37, 36864
    s_add_u32 s51, s51, 4096
    buffer_load_dwordx4 v6, s[12:15], s51 offen offset:0 nt lds
    v_mfma_f32_32x32x16_bf16 a[128:143], a[244:247], v[152:155], a[128:143]
    v_exp_f32 v115, v115
    v_add_f32 v20, v20, v112
    v_add_f32 v20, v20, v113
    v_cvt_pk_bf16_f32 v112, v112, v113
    v_exp_f32 v116, v116
    v_mfma_f32_32x32x16_bf16 a[176:191], a[252:255], v[152:155], a[176:191]
    v_exp_f32 v117, v117
    v_add_f32 v20, v20, v114
    v_add_f32 v20, v20, v115
    v_cvt_pk_bf16_f32 v113, v114, v115
    v_exp_f32 v118, v118
    v_mfma_f32_32x32x16_bf16 v[128:143], a[192:195], v[192:195], v[48:63]
    buffer_load_dwordx4 v6, s[12:15], s51 offen offset:1024 nt lds
    s_waitcnt vmcnt(14)
    ds_read_b64_tr_b16 a[224:225], v16 offset:16384
    ds_read_b64_tr_b16 a[226:227], v16 offset:18432
    v_mfma_f32_32x32x16_bf16 v[128:143], a[196:199], v[196:199], v[128:143]
    ds_read_b64_tr_b16 a[232:233], v17 offset:16384
    ds_read_b64_tr_b16 a[234:235], v17 offset:18432
    ds_read_b64_tr_b16 a[240:241], v18 offset:16384
    v_exp_f32 v119, v119
    v_add_f32 v20, v20, v116
    v_add_f32 v20, v20, v117
    v_mfma_f32_32x32x16_bf16 v[128:143], a[200:203], v[200:203], v[128:143]
    ds_read_b64_tr_b16 a[242:243], v18 offset:18432
    ds_read_b64_tr_b16 a[248:249], v19 offset:16384
    v_cvt_pk_bf16_f32 v114, v116, v117
    v_exp_f32 v120, v120
    v_exp_f32 v121, v121
    v_mfma_f32_32x32x16_bf16 v[128:143], a[204:207], v[204:207], v[128:143]
    buffer_load_dwordx4 v6, s[12:15], s51 offen offset:2048 nt lds
    ds_read_b64_tr_b16 a[250:251], v19 offset:18432
    ds_read_b64_tr_b16 a[228:229], v16 offset:20480
    ds_read_b64_tr_b16 a[230:231], v16 offset:22528
    v_mfma_f32_32x32x16_bf16 v[128:143], a[208:211], v[208:211], v[128:143]
    ds_read_b64_tr_b16 a[236:237], v17 offset:20480
    ds_read_b64_tr_b16 a[238:239], v17 offset:22528
    ds_read_b64_tr_b16 a[244:245], v18 offset:20480
    v_add_f32 v20, v20, v118
    v_add_f32 v20, v20, v119
    v_cvt_pk_bf16_f32 v115, v118, v119
    v_mfma_f32_32x32x16_bf16 v[128:143], a[212:215], v[212:215], v[128:143]
    ds_read_b64_tr_b16 a[246:247], v18 offset:22528
    ds_read_b64_tr_b16 a[252:253], v19 offset:20480
    ds_read_b64_tr_b16 a[254:255], v19 offset:22528
    v_exp_f32 v122, v122
    v_exp_f32 v123, v123
    v_mfma_f32_32x32x16_bf16 v[128:143], a[216:219], v[216:219], v[128:143]
    buffer_load_dwordx4 v6, s[12:15], s51 offen offset:3072 nt lds
    v_add_f32 v20, v20, v120
    v_add_f32 v20, v20, v121
    v_cvt_pk_bf16_f32 v120, v120, v121
    v_mfma_f32_32x32x16_bf16 v[128:143], a[220:223], v[220:223], v[128:143]
    v_exp_f32 v124, v124
    v_exp_f32 v125, v125
    v_add_f32 v20, v20, v122
    v_add_f32 v20, v20, v123
    v_cvt_pk_bf16_f32 v121, v122, v123
    s_waitcnt lgkmcnt(0)
    v_mfma_f32_32x32x16_bf16 a[0:15], a[224:227], v[112:115], a[0:15]
    v_exp_f32 v126, v126
    v_exp_f32 v127, v127
    v_add_f32 v20, v20, v124
    v_add_f32 v20, v20, v125
    v_cvt_pk_bf16_f32 v122, v124, v125
    v_mfma_f32_32x32x16_bf16 a[48:63], a[232:235], v[112:115], a[48:63]
    v_add_f32 v20, v20, v126
    v_add_f32 v20, v20, v127
    v_cvt_pk_bf16_f32 v123, v126, v127
    v_mfma_f32_32x32x16_bf16 a[96:111], a[240:243], v[112:115], a[96:111]
    v_max3_f32 v24, v128, v129, v130
    v_max3_f32 v24, v24, v131, v132
    v_max3_f32 v24, v24, v133, v134
    v_max3_f32 v24, v24, v135, v136
    v_max3_f32 v24, v24, v137, v138
    v_mfma_f32_32x32x16_bf16 a[144:159], a[248:251], v[112:115], a[144:159]
    v_max3_f32 v24, v24, v139, v140
    v_max3_f32 v24, v24, v141, v142
    v_max_f32 v24, v24, v143
    v_cmp_lt_f32 vcc, s43, v24
    s_cbranch_vccz L_sk14_1
    s_call_b64 s[40:41], L_rare1
L_sk14_1:
    v_mfma_f32_32x32x16_bf16 a[0:15], a[228:231], v[120:123], a[0:15]
    v_exp_f32 v128, v128
    v_exp_f32 v129, v129
    v_mfma_f32_32x32x16_bf16 a[48:63], a[236:239], v[120:123], a[48:63]
    v_exp_f32 v130, v130
    v_exp_f32 v131, v131
    v_add_f32 v21, v21, v128
    v_mfma_f32_32x32x16_bf16 a[96:111], a[244:247], v[120:123], a[96:111]
    v_add_f32 v21, v21, v129
    v_cvt_pk_bf16_f32 v128, v128, v129
    v_exp_f32 v132, v132
    v_mfma_f32_32x32x16_bf16 a[144:159], a[252:255], v[120:123], a[144:159]
    v_exp_f32 v133, v133
    v_add_f32 v21, v21, v130
    v_add_f32 v21, v21, v131
    v_cvt_pk_bf16_f32 v129, v130, v131
    v_mfma_f32_32x32x16_bf16 v[144:159], a[192:195], v[224:227], v[64:79]
    v_exp_f32 v134, v134
    v_exp_f32 v135, v135
    v_add_f32 v21, v21, v132
    v_mfma_f32_32x32x16_bf16 v[144:159], a[196:199], v[228:231], v[144:159]
    v_add_f32 v21, v21, v133
    v_cvt_pk_bf16_f32 v130, v132, v133
    v_exp_f32 v136, v136
    v_mfma_f32_32x32x16_bf16 v[144:159], a[200:203], v[232:235], v[144:159]
    v_exp_f32 v137, v137
    v_add_f32 v21, v21, v134
    v_add_f32 v21, v21, v135
    v_cvt_pk_bf16_f32 v131, v134, v135
    v_mfma_f32_32x32x16_bf16 v[144:159], a[204:207], v[236:239], v[144:159]
    v_exp_f32 v138, v138
    v_exp_f32 v139, v139
    v_add_f32 v21, v21, v136
    v_mfma_f32_32x32x16_bf16 v[144:159], a[208:211], v[240:243], v[144:159]
    v_add_f32 v21, v21, v137
    v_cvt_pk_bf16_f32 v136, v136, v137
    v_exp_f32 v140, v140
    v_mfma_f32_32x32x16_bf16 v[144:159], a[212:215], v[244:247], v[144:159]
    v_exp_f32 v141, v141
    v_add_f32 v21, v21, v138
    v_add_f32 v21, v21, v139
    v_cvt_pk_bf16_f32 v137, v138, v139
    v_mfma_f32_32x32x16_bf16 v[144:159], a[216:219], v[248:251], v[144:159]
    v_exp_f32 v142, v142
    v_exp_f32 v143, v143
    v_add_f32 v21, v21, v140
    v_mfma_f32_32x32x16_bf16 v[144:159], a[220:223], v[252:255], v[144:159]
    v_add_f32 v21, v21, v141
    v_cvt_pk_bf16_f32 v138, v140, v141
    v_add_f32 v21, v21, v142
    v_add_f32 v21, v21, v143
    v_cvt_pk_bf16_f32 v139, v142, v143
    v_mfma_f32_32x32x16_bf16 a[16:31], a[224:227], v[128:131], a[16:31]
    s_waitcnt vmcnt(8)
    ds_read_b128 a[192:195], v8 offset:0
    v_mfma_f32_32x32x16_bf16 a[64:79], a[232:235], v[128:131], a[64:79]
    ds_read_b128 a[196:199], v9 offset:0
    ds_read_b128 a[200:203], v10 offset:0
    v_mfma_f32_32x32x16_bf16 a[112:127], a[240:243], v[128:131], a[112:127]
    ds_read_b128 a[204:207], v11 offset:0
    ds_read_b128 a[208:211], v12 offset:0
    ds_read_b128 a[212:215], v13 offset:0
    v_max3_f32 v25, v144, v145, v146
    v_max3_f32 v25, v25, v147, v148
    v_max3_f32 v25, v25, v149, v150
    v_mfma_f32_32x32x16_bf16 a[160:175], a[248:251], v[128:131], a[160:175]
    ds_read_b128 a[216:219], v14 offset:0
    ds_read_b128 a[220:223], v15 offset:0
    v_max3_f32 v25, v25, v151, v152
    v_max3_f32 v25, v25, v153, v154
    v_max3_f32 v25, v25, v155, v156
    v_max3_f32 v25, v25, v157, v158
    v_mfma_f32_32x32x16_bf16 a[16:31], a[228:231], v[136:139], a[16:31]
    s_cmp_eq_u32 s7, 1
    s_cbranch_scc1 L_now0
    v_mov_b32 v83, 162832
    s_mov_b32 s47, 0x400000
L_yq:
    ds_read_b128 v[84:87], v83
    s_sub_u32 s47, s47, 1
    s_waitcnt lgkmcnt(0)
    v_min3_u32 v84, v84, v85, v86
    v_min_u32 v84, v84, v87
    s_nop 1
    v_readfirstlane_b32 s3, v84
    s_nop 1
    s_cmp_eq_u32 s47, 0
    s_cselect_b32 s3, 1, s3
    s_cmp_lt_u32 s3, 1
    s_cbranch_scc1 L_yq
    s_add_u32 s4, s66, 0
    s_and_b32 s4, s4, 7
    s_mul_i32 s4, s4, 147456
    s_add_u32 s4, s4, s68
    s_add_u32 s4, s4, 0
    s_add_u32 m0, s65, 122880
    s_nop 0
    buffer_load_dwordx4 v93, s[60:63], s4 offen lds
    s_add_u32 m0, s65, 123904
    s_nop 0
    buffer_load_dwordx4 v94, s[60:63], s4 offen lds
    s_add_u32 m0, s65, 124928
    s_nop 0
    buffer_load_dwordx4 v95, s[60:63], s4 offen lds
    s_add_u32 m0, s65, 125952
    s_nop 0
    buffer_load_dwordx4 v96, s[60:63], s4 offen lds
    s_add_u32 m0, s65, 126976
    s_nop 0
    buffer_load_dwordx4 v97, s[60:63], s4 offen lds
    s_add_u32 m0, s65, 128000
    s_nop 0
    buffer_load_dwordx4 v98, s[60:63], s4 offen lds
    s_add_u32 m0, s65, 129024
    s_nop 0
    buffer_load_dwordx4 v99, s[60:63], s4 offen lds
    s_add_u32 m0, s65, 130048
    s_nop 0
    buffer_load_dwordx4 v100, s[60:63], s4 offen lds
    s_add_u32 m0, s65, 131072
    s_nop 0
    buffer_load_dwordx4 v101, s[60:63], s4 offen lds
    s_add_u32 s4, s66, 0
    s_and_b32 s4, s4, 7
    s_mul_i32 s4, s4, 147456
    s_add_u32 s4, s4, s68
    s_add_u32 s4, s4, 73728
    s_add_u32 m0, s65, 141312
    s_nop 0
    buffer_load_dwordx4 v93, s[60:63], s4 offen lds
    s_add_u32 m0, s65, 142336
    s_nop 0
    buffer_load_dwordx4 v94, s[60:63], s4 offen lds
    s_add_u32 m0, s65, 143360
    s_nop 0
    buffer_load_dwordx4 v95, s[60:63], s4 offen lds
    s_add_u32 m0, s65, 144384
    s_nop 0
    buffer_load_dwordx4 v96, s[60:63], s4 offen lds
    s_add_u32 m0, s65, 145408
    s_nop 0
    buffer_load_dwordx4 v97, s[60:63], s4 offen lds
    s_add_u32 m0, s65, 146432
    s_nop 0
    buffer_load_dwordx4 v98, s[60:63], s4 offen lds
    s_add_u32 m0, s65, 147456
    s_nop 0
    buffer_load_dwordx4 v99, s[60:63], s4 offen lds
    s_add_u32 m0, s65, 148480
    s_nop 0
    buffer_load_dwordx4 v100, s[60:63], s4 offen lds
    s_add_u32 m0, s65, 149504
    s_nop 0
    buffer_load_dwordx4 v101, s[60:63], s4 offen lds
L_now0:
    v_max_f32 v25, v25, v159
    v_cmp_lt_f32 vcc, s43, v25
    s_cbranch_vccz L_sk14_2
    s_call_b64 s[40:41], L_rare2
L_sk14_2:
    v_mfma_f32_32x32x16_bf16 a[64:79], a[236:239], v[136:139], a[64:79]
    v_exp_f32 v144, v144
    v_exp_f32 v145, v145
    v_exp_f32 v146, v146
    v_mfma_f32_32x32x16_bf16 a[112:127], a[244:247], v[136:139], a[112:127]
    v_exp_f32 v147, v147
    v_add_f32 v22, v22, v144
    v_add_f32 v22, v22, v145
    v_cvt_pk_bf16_f32 v144, v144, v145
    v_mfma_f32_32x32x16_bf16 a[160:175], a[252:255], v[136:139], a[160:175]
    v_exp_f32 v148, v148
    v_exp_f32 v149, v149
    v_add_f32 v22, v22, v146
    v_add_f32 v22, v22, v147
    s_waitcnt lgkmcnt(0)
    v_mfma_f32_32x32x16_bf16 v[112:127], a[192:195], v[160:163], v[32:47]
    v_cvt_pk_bf16_f32 v145, v146, v147
    v_exp_f32 v150, v150
    v_exp_f32 v151, v151
    v_add_f32 v22, v22, v148
    v_mfma_f32_32x32x16_bf16 v[112:127], a[196:199], v[164:167], v[112:127]
    v_mfma_f32_32x32x16_bf16 v[112:127], a[200:203], v[168:171], v[112:127]
    v_add_f32 v22, v22, v149
    v_cvt_pk_bf16_f32 v146, v148, v149
    v_exp_f32 v152, v152
    v_exp_f32 v153, v153
    v_mfma_f32_32x32x16_bf16 v[112:127], a[204:207], v[172:175], v[112:127]
    v_add_f32 v22, v22, v150
    v_add_f32 v22, v22, v151
    v_cvt_pk_bf16_f32 v147, v150, v151
    v_exp_f32 v154, v154
    v_mfma_f32_32x32x16_bf16 v[112:127], a[208:211], v[176:179], v[112:127]
    v_mfma_f32_32x32x16_bf16 v[112:127], a[212:215], v[180:183], v[112:127]
    v_exp_f32 v155, v155
    v_add_f32 v22, v22, v152
    v_add_f32 v22, v22, v153
    v_cvt_pk_bf16_f32 v152, v152, v153
    v_mfma_f32_32x32x16_bf16 v[112:127], a[216:219], v[184:187], v[112:127]
    v_exp_f32 v156, v156
    v_exp_f32 v157, v157
    v_add_f32 v22, v22, v154
    v_add_f32 v22, v22, v155
    v_mfma_f32_32x32x16_bf16 v[112:127], a[220:223], v[188:191], v[112:127]
    v_mfma_f32_32x32x16_bf16 a[32:47], a[224:227], v[144:147], a[32:47]
    v_cvt_pk_bf16_f32 v153, v154, v155
    v_exp_f32 v158, v158
    v_exp_f32 v159, v159
    v_add_f32 v22, v22, v156
    buffer_load_dword v106, v108, s[56:59], 0 offen sc1
    v_mfma_f32_32x32x16_bf16 a[80:95], a[232:235], v[144:147], a[80:95]
    v_add_f32 v22, v22, v157
    v_cvt_pk_bf16_f32 v154, v156, v157
    v_add_f32 v22, v22, v158
    v_add_f32 v22, v22, v159
    v_cvt_pk_bf16_f32 v155, v158, v159
    v_mfma_f32_32x32x16_bf16 a[128:143], a[240:243], v[144:147], a[128:143]
    v_add_u32 v28, s37, v102
    s_lshl_b32 s3, s6, 14
    s_sub_u32 s3, 8192, s3
    v_max3_f32 v23, v112, v113, v114
    v_max3_f32 v23, v23, v115, v116
    v_max3_f32 v23, v23, v117, v118
    v_max3_f32 v23, v23, v119, v120
    v_mfma_f32_32x32x16_bf16 a[176:191], a[248:251], v[144:147], a[176:191]
    v_add_u32 v29, s3, v28
    v_max3_f32 v23, v23, v121, v122
    v_max3_f32 v23, v23, v123, v124
    v_max3_f32 v23, v23, v125, v126
    v_max_f32 v23, v23, v127
    v_cmp_lt_f32 vcc, s43, v23
    s_cbranch_vccz L_sk15_0
    s_call_b64 s[40:41], L_rare0
L_sk15_0:
    v_mfma_f32_32x32x16_bf16 a[32:47], a[228:231], v[152:155], a[32:47]
    s_mul_i32 s3, s28, 768
    s_add_u32 s3, s3, 159744
    v_lshlrev_b32 v30, 3, v91
    v_exp_f32 v112, v112
    v_exp_f32 v113, v113
    v_mfma_f32_32x32x16_bf16 a[80:95], a[236:239], v[152:155], a[80:95]
    v_add_u32 v30, s3, v30
    v_exp_f32 v114, v114
    v_exp_f32 v115, v115
    v_add_f32 v20, v20, v112
    v_add_f32 v20, v20, v113
    v_mfma_f32_32x32x16_bf16 a[128:143], a[244:247], v[152:155], a[128:143]
    s_xor_b32 s3, s28, 1
    s_mul_i32 s3, s3, 768
    s_add_u32 s3, s3, 159744
    v_cvt_pk_bf16_f32 v112, v112, v113
    v_exp_f32 v116, v116
    v_mfma_f32_32x32x16_bf16 a[176:191], a[252:255], v[152:155], a[176:191]
    v_lshlrev_b32 v31, 3, v91
    v_add_u32 v31, s3, v31
    v_exp_f32 v117, v117
    v_add_f32 v20, v20, v114
    v_add_f32 v20, v20, v115
    v_cvt_pk_bf16_f32 v113, v114, v115
    v_mfma_f32_32x32x16_bf16 v[128:143], a[192:195], v[192:195], v[48:63]
    s_waitcnt vmcnt(0)
    ds_read_b64_tr_b16 a[224:225], v16 offset:32768
    ds_read_b64_tr_b16 a[226:227], v16 offset:34816
    v_exp_f32 v118, v118
    v_exp_f32 v119, v119
    v_mfma_f32_32x32x16_bf16 v[128:143], a[196:199], v[196:199], v[128:143]
    ds_read_b64_tr_b16 a[232:233], v17 offset:32768
    ds_read_b64_tr_b16 a[234:235], v17 offset:34816
    ds_read_b64_tr_b16 a[240:241], v18 offset:32768
    v_add_f32 v20, v20, v116
    v_add_f32 v20, v20, v117
    v_cvt_pk_bf16_f32 v114, v116, v117
    v_mfma_f32_32x32x16_bf16 v[128:143], a[200:203], v[200:203], v[128:143]
    ds_read_b64_tr_b16 a[242:243], v18 offset:34816
    ds_read_b64_tr_b16 a[248:249], v19 offset:32768
    v_exp_f32 v120, v120
    v_exp_f32 v121, v121
    v_add_f32 v20, v20, v118
    v_mfma_f32_32x32x16_bf16 v[128:143], a[204:207], v[204:207], v[128:143]
    ds_read_b64_tr_b16 a[250:251], v19 offset:34816
    ds_read_b64_tr_b16 a[228:229], v16 offset:36864
    ds_read_b64_tr_b16 a[230:231], v16 offset:38912
    v_add_f32 v20, v20, v119
    v_cvt_pk_bf16_f32 v115, v118, v119
    v_exp_f32 v122, v122
    v_mfma_f32_32x32x16_bf16 v[128:143], a[208:211], v[208:211], v[128:143]
    ds_read_b64_tr_b16 a[236:237], v17 offset:36864
    ds_read_b64_tr_b16 a[238:239], v17 offset:38912
    ds_read_b64_tr_b16 a[244:245], v18 offset:36864
    v_exp_f32 v123, v123
    v_add_f32 v20, v20, v120
    v_add_f32 v20, v20, v121
    v_mfma_f32_32x32x16_bf16 v[128:143], a[212:215], v[212:215], v[128:143]
    ds_read_b64_tr_b16 a[246:247], v18 offset:38912
    ds_read_b64_tr_b16 a[252:253], v19 offset:36864
    ds_read_b64_tr_b16 a[254:255], v19 offset:38912
    v_cvt_pk_bf16_f32 v120, v120, v121
    v_exp_f32 v124, v124
    v_mfma_f32_32x32x16_bf16 v[128:143], a[216:219], v[216:219], v[128:143]
    v_exp_f32 v125, v125
    v_add_f32 v20, v20, v122
    v_add_f32 v20, v20, v123
    v_cvt_pk_bf16_f32 v121, v122, v123
    v_exp_f32 v126, v126
    v_mfma_f32_32x32x16_bf16 v[128:143], a[220:223], v[220:223], v[128:143]
    v_exp_f32 v127, v127
    v_add_f32 v20, v20, v124
    v_add_f32 v20, v20, v125
    v_cvt_pk_bf16_f32 v122, v124, v125
    v_add_f32 v20, v20, v126
    v_add_f32 v20, v20, v127
    s_waitcnt lgkmcnt(0)
    v_mfma_f32_32x32x16_bf16 a[0:15], a[224:227], v[112:115], a[0:15]
    v_cvt_pk_bf16_f32 v123, v126, v127
    v_mfma_f32_32x32x16_bf16 a[48:63], a[232:235], v[112:115], a[48:63]
    v_mfma_f32_32x32x16_bf16 a[96:111], a[240:243], v[112:115], a[96:111]
    s_nop 0
    v_max3_f32 v24, v128, v129, v130
    v_max3_f32 v24, v24, v131, v132
    v_max3_f32 v24, v24, v133, v134
    v_max3_f32 v24, v24, v135, v136
    v_max3_f32 v24, v24, v137, v138
    v_max3_f32 v24, v24, v139, v140
    v_max3_f32 v24, v24, v141, v142
    v_mfma_f32_32x32x16_bf16 a[144:159], a[248:251], v[112:115], a[144:159]
    v_max_f32 v24, v24, v143
    v_cmp_lt_f32 vcc, s43, v24
    s_cbranch_vccz L_sk15_1
    s_call_b64 s[40:41], L_rare1
L_sk15_1:
    v_exp_f32 v128, v128
    v_exp_f32 v129, v129
    v_mfma_f32_32x32x16_bf16 a[0:15], a[228:231], v[120:123], a[0:15]
    s_andn2_b32 s71, s2, 24
    s_lshl_b32 s71, s71, 7
    s_add_u32 s69, s71, 50331648
    v_exp_f32 v130, v130
    v_exp_f32 v131, v131
    v_mfma_f32_32x32x16_bf16 a[48:63], a[236:239], v[120:123], a[48:63]
    v_and_b32 v13, 3, v1
    v_add_f32 v21, v21, v128
    v_add_f32 v21, v21, v129
    v_cvt_pk_bf16_f32 v128, v128, v129
    v_exp_f32 v132, v132
    v_mfma_f32_32x32x16_bf16 a[96:111], a[244:247], v[120:123], a[96:111]
    v_lshlrev_b32 v13, 10, v13
    v_and_b32 v14, 4, v1
    v_exp_f32 v133, v133
    v_add_f32 v21, v21, v130
    v_add_f32 v21, v21, v131
    v_cvt_pk_bf16_f32 v129, v130, v131
    v_mfma_f32_32x32x16_bf16 a[144:159], a[252:255], v[120:123], a[144:159]
    v_add_u32 v13, v13, v14
    v_exp_f32 v134, v134
    v_exp_f32 v135, v135
    v_add_f32 v21, v21, v132
    v_add_f32 v21, v21, v133
    v_mfma_f32_32x32x16_bf16 v[144:159], a[192:195], v[224:227], v[64:79]
    buffer_load_dword v12, v13, s[24:27], s69 offen sc1
    v_cvt_pk_bf16_f32 v130, v132, v133
    v_exp_f32 v136, v136
    v_mfma_f32_32x32x16_bf16 v[144:159], a[196:199], v[228:231], v[144:159]
    v_accvgpr_read_b32 v160, a0
    v_accvgpr_read_b32 v161, a1
    v_accvgpr_read_b32 v162, a2
    v_exp_f32 v137, v137
    v_add_f32 v21, v21, v134
    v_add_f32 v21, v21, v135
    v_mfma_f32_32x32x16_bf16 v[144:159], a[200:203], v[232:235], v[144:159]
    ds_write_b128 v28, a[96:99] offset:0
    v_accvgpr_read_b32 v163, a3
    v_accvgpr_read_b32 v164, a4
    v_accvgpr_read_b32 v165, a5
    v_cvt_pk_bf16_f32 v131, v134, v135
    v_exp_f32 v138, v138
    v_mfma_f32_32x32x16_bf16 v[144:159], a[204:207], v[236:239], v[144:159]
    v_accvgpr_read_b32 v166, a6
    v_accvgpr_read_b32 v167, a7
    v_accvgpr_read_b32 v168, a8
    v_exp_f32 v139, v139
    v_add_f32 v21, v21, v136
    v_add_f32 v21, v21, v137
    v_mfma_f32_32x32x16_bf16 v[144:159], a[208:211], v[240:243], v[144:159]
    ds_write_b128 v28, a[100:103] offset:1024
    v_accvgpr_read_b32 v169, a9
    v_accvgpr_read_b32 v170, a10
    v_accvgpr_read_b32 v171, a11
    v_cvt_pk_bf16_f32 v136, v136, v137
    v_exp_f32 v140, v140
    v_mfma_f32_32x32x16_bf16 v[144:159], a[212:215], v[244:247], v[144:159]
    v_accvgpr_read_b32 v172, a12
    v_accvgpr_read_b32 v173, a13
    v_accvgpr_read_b32 v174, a14
    v_exp_f32 v141, v141
    v_add_f32 v21, v21, v138
    v_add_f32 v21, v21, v139
    v_mfma_f32_32x32x16_bf16 v[144:159], a[216:219], v[248:251], v[144:159]
    ds_write_b128 v28, a[104:107] offset:2048
    v_accvgpr_read_b32 v175, a15
    v_accvgpr_read_b32 v208, a48
    v_cvt_pk_bf16_f32 v137, v138, v139
    v_exp_f32 v142, v142
    v_mfma_f32_32x32x16_bf16 v[144:159], a[220:223], v[252:255], v[144:159]
    v_accvgpr_read_b32 v209, a49
    v_accvgpr_read_b32 v210, a50
    v_accvgpr_read_b32 v211, a51
    v_exp_f32 v143, v143
    v_add_f32 v21, v21, v140
    v_add_f32 v21, v21, v141
    v_mfma_f32_32x32x16_bf16 a[16:31], a[224:227], v[128:131], a[16:31]
    ds_write_b128 v28, a[108:111] offset:3072
    v_accvgpr_read_b32 v212, a52
    v_accvgpr_read_b32 v213, a53
    v_accvgpr_read_b32 v214, a54
    v_cvt_pk_bf16_f32 v138, v140, v141
    v_add_f32 v21, v21, v142
    v_add_f32 v21, v21, v143
    v_mfma_f32_32x32x16_bf16 a[64:79], a[232:235], v[128:131], a[64:79]
    ds_write_b128 v28, a[144:147] offset:20480
    v_accvgpr_read_b32 v215, a55
    v_accvgpr_read_b32 v216, a56
    v_accvgpr_read_b32 v217, a57
    v_cvt_pk_bf16_f32 v139, v142, v143
    v_mfma_f32_32x32x16_bf16 a[112:127], a[240:243], v[128:131], a[112:127]
    v_accvgpr_read_b32 v218, a58
    v_accvgpr_read_b32 v219, a59
    v_accvgpr_read_b32 v220, a60
    v_max3_f32 v25, v144, v145, v146
    v_max3_f32 v25, v25, v147, v148
    v_max3_f32 v25, v25, v149, v150
    v_max3_f32 v25, v25, v151, v152
    v_mfma_f32_32x32x16_bf16 a[160:175], a[248:251], v[128:131], a[160:175]
    ds_write_b128 v28, a[148:151] offset:21504
    v_accvgpr_read_b32 v221, a61
    v_accvgpr_read_b32 v222, a62
    v_accvgpr_read_b32 v223, a63
    v_max3_f32 v25, v25, v153, v154
    v_max3_f32 v25, v25, v155, v156
    v_max3_f32 v25, v25, v157, v158
    v_mfma_f32_32x32x16_bf16 a[16:31], a[228:231], v[136:139], a[16:31]
    v_max_f32 v25, v25, v159
    v_cmp_lt_f32 vcc, s43, v25
    s_cbranch_vccz L_sk15_2
    s_call_b64 s[40:41], L_rare2
L_sk15_2:
    v_exp_f32 v144, v144
    v_exp_f32 v145, v145
    v_mfma_f32_32x32x16_bf16 a[64:79], a[236:239], v[136:139], a[64:79]
    ds_write_b128 v28, a[152:155] offset:22528
    v_exp_f32 v146, v146
    v_exp_f32 v147, v147
    v_add_f32 v22, v22, v144
    v_add_f32 v22, v22, v145
    v_mfma_f32_32x32x16_bf16 a[112:127], a[244:247], v[136:139], a[112:127]
    v_cvt_pk_bf16_f32 v144, v144, v145
    v_exp_f32 v148, v148
    v_exp_f32 v149, v149
    v_add_f32 v22, v22, v146
    v_add_f32 v22, v22, v147
    v_mfma_f32_32x32x16_bf16 a[160:175], a[252:255], v[136:139], a[160:175]
    ds_write_b128 v28, a[156:159] offset:23552
    v_cvt_pk_bf16_f32 v145, v146, v147
    v_exp_f32 v150, v150
    v_exp_f32 v151, v151
    v_add_f32 v22, v22, v148
    v_add_f32 v22, v22, v149
    v_cvt_pk_bf16_f32 v146, v148, v149
    v_exp_f32 v152, v152
    v_exp_f32 v153, v153
    v_add_f32 v22, v22, v150
    v_add_f32 v22, v22, v151
    v_cvt_pk_bf16_f32 v147, v150, v151
    v_exp_f32 v154, v154
    v_exp_f32 v155, v155
    v_mfma_f32_32x32x16_bf16 a[32:47], a[224:227], v[144:147], a[32:47]
    v_add_f32 v22, v22, v152
    v_add_f32 v22, v22, v153
    v_cvt_pk_bf16_f32 v152, v152, v153
    v_exp_f32 v156, v156
    v_exp_f32 v157, v157
    v_mfma_f32_32x32x16_bf16 a[80:95], a[232:235], v[144:147], a[80:95]
    v_add_f32 v22, v22, v154
    v_add_f32 v22, v22, v155
    v_cvt_pk_bf16_f32 v153, v154, v155
    v_exp_f32 v158, v158
    v_exp_f32 v159, v159
    v_mfma_f32_32x32x16_bf16 a[128:143], a[240:243], v[144:147], a[128:143]
    v_add_f32 v22, v22, v156
    v_add_f32 v22, v22, v157
    v_cvt_pk_bf16_f32 v154, v156, v157
    v_add_f32 v22, v22, v158
    v_add_f32 v22, v22, v159
    v_cvt_pk_bf16_f32 v155, v158, v159
    v_mfma_f32_32x32x16_bf16 a[176:191], a[248:251], v[144:147], a[176:191]
    v_mov_b32 v3, v20
    v_mov_b32 v2, v32
    v_mov_b32 v5, v21
    v_mov_b32 v4, v48
    v_mov_b32 v7, v22
    v_mfma_f32_32x32x16_bf16 a[32:47], a[228:231], v[152:155], a[32:47]
    v_mov_b32 v6, v64
    v_permlane32_swap_b32 v20, v3
    v_permlane32_swap_b32 v21, v5
    v_permlane32_swap_b32 v22, v7
    v_mfma_f32_32x32x16_bf16 a[80:95], a[236:239], v[152:155], a[80:95]
    v_add_f32 v3, v20, v3
    ds_write_b64 v30, v[2:3] offset:0
    v_add_f32 v5, v21, v5
    ds_write_b64 v30, v[4:5] offset:256
    v_add_f32 v7, v22, v7
    v_mfma_f32_32x32x16_bf16 a[128:143], a[244:247], v[152:155], a[128:143]
    ds_write_b64 v30, v[6:7] offset:512
    ds_write_b128 v28, a[112:115] offset:4096
    ds_write_b128 v28, a[116:119] offset:5120
    ds_write_b128 v28, a[120:123] offset:6144
    v_mfma_f32_32x32x16_bf16 a[176:191], a[252:255], v[152:155], a[176:191]
    ds_write_b128 v28, a[124:127] offset:7168
    ds_write_b128 v28, a[160:163] offset:32768
    ds_write_b128 v28, a[164:167] offset:33792
    ds_write_b128 v28, a[168:171] offset:34816
    ds_write_b128 v28, a[172:175] offset:35840
    v_accvgpr_read_b32 v176, a16
    v_accvgpr_read_b32 v177, a17
    v_accvgpr_read_b32 v178, a18
    v_accvgpr_read_b32 v179, a19
    v_accvgpr_read_b32 v180, a20
    v_accvgpr_read_b32 v181, a21
    v_accvgpr_read_b32 v182, a22
    v_accvgpr_read_b32 v183, a23
    v_accvgpr_read_b32 v184, a24
    v_accvgpr_read_b32 v185, a25
    v_accvgpr_read_b32 v186, a26
    v_accvgpr_read_b32 v187, a27
    ds_write_b128 v28, a[128:131] offset:16384
    ds_write_b128 v28, a[132:135] offset:17408
    ds_write_b128 v28, a[136:139] offset:18432
    ds_write_b128 v28, a[140:143] offset:19456
    ds_write_b128 v28, a[176:179] offset:36864
    ds_write_b128 v28, a[180:183] offset:37888
    ds_write_b128 v28, a[184:187] offset:38912
    ds_write_b128 v28, a[188:191] offset:39936
    v_accvgpr_read_b32 v188, a28
    v_accvgpr_read_b32 v189, a29
    v_accvgpr_read_b32 v190, a30
    v_accvgpr_read_b32 v191, a31
    v_accvgpr_read_b32 v224, a64
    v_accvgpr_read_b32 v225, a65
    v_accvgpr_read_b32 v226, a66
    v_accvgpr_read_b32 v227, a67
    v_accvgpr_read_b32 v228, a68
    v_accvgpr_read_b32 v229, a69
    v_accvgpr_read_b32 v230, a70
    v_accvgpr_read_b32 v231, a71
    v_accvgpr_read_b32 v232, a72
    v_accvgpr_read_b32 v233, a73
    v_accvgpr_read_b32 v234, a74
    v_accvgpr_read_b32 v235, a75
    v_accvgpr_read_b32 v236, a76
    v_accvgpr_read_b32 v237, a77
    v_accvgpr_read_b32 v238, a78
    v_accvgpr_read_b32 v239, a79
    v_accvgpr_read_b32 v192, a32
    v_accvgpr_read_b32 v193, a33
    v_accvgpr_read_b32 v194, a34
    v_accvgpr_read_b32 v195, a35
    v_accvgpr_read_b32 v196, a36
    v_accvgpr_read_b32 v197, a37
    v_accvgpr_read_b32 v198, a38
    v_accvgpr_read_b32 v199, a39
    v_accvgpr_read_b32 v200, a40
    v_accvgpr_read_b32 v201, a41
    v_accvgpr_read_b32 v202, a42
    v_accvgpr_read_b32 v203, a43
    v_accvgpr_read_b32 v204, a44
    v_accvgpr_read_b32 v205, a45
    v_accvgpr_read_b32 v206, a46
    v_accvgpr_read_b32 v207, a47
    v_accvgpr_read_b32 v240, a80
    v_accvgpr_read_b32 v241, a81
    v_accvgpr_read_b32 v242, a82
    v_accvgpr_read_b32 v243, a83
    v_accvgpr_read_b32 v244, a84
    v_accvgpr_read_b32 v245, a85
    v_accvgpr_read_b32 v246, a86
    v_accvgpr_read_b32 v247, a87
    v_accvgpr_read_b32 v248, a88
    v_accvgpr_read_b32 v249, a89
    v_accvgpr_read_b32 v250, a90
    v_accvgpr_read_b32 v251, a91
    v_accvgpr_read_b32 v252, a92
    v_accvgpr_read_b32 v253, a93
    v_accvgpr_read_b32 v254, a94
    v_accvgpr_read_b32 v255, a95
    s_mov_b32 s4, 0x100000
L_tag:
    s_waitcnt vmcnt(0)
    v_readfirstlane_b32 s75, v106
    s_nop 0
    s_cmp_lg_u32 s75, 0
    s_cbranch_scc1 L_tag_ok
    buffer_load_dword v106, v108, s[56:59], 0 offen sc1
    s_sub_u32 s4, s4, 1
    s_cmp_lg_u32 s4, 0
    s_cbranch_scc1 L_tag
L_tag_ok:
    s_lshl_b32 s3, s39, 5
    s_add_u32 s3, s3, s33
    s_mul_i32 s52, s3, 24576
    s_mul_i32 s3, s6, 12288
    s_add_u32 s52, s52, s3
    s_waitcnt lgkmcnt(0)
    s_lshl_b32 s3, s2, 7
    s_lshl_b32 s4, s28, 2
    s_add_u32 s70, s3, s4
    s_add_u32 s70, s70, 50331648
    s_lshl_b32 s3, s39, 2
    s_add_u32 s3, s3, s30
    s_mul_i32 s37, s3, 196608
    s_mul_i32 s4, s6, 3072
    s_add_u32 s37, s37, s4
    s_mul_i32 s4, s7, 12288
    s_add_u32 s37, s37, s4
    s_mov_b32 s45, 0
    s_cmp_eq_u32 s7, 0
    s_cbranch_scc1 L_noearly
    v_cmp_ne_u32 vcc, s75, v12
    s_cbranch_vccnz L_noearly
    s_mov_b32 s45, 1
    s_add_u32 s47, s66, 2
    s_and_b32 s47, s47, 7
    s_mul_i32 s47, s47, 24576
    s_add_u32 s47, s47, s37
    buffer_load_dwordx4 a[24:27], v102, s[24:27], s47 offen offset:0 sc1
    buffer_load_dwordx4 a[28:31], v102, s[24:27], s47 offen offset:1024 sc1
    buffer_load_dwordx4 a[32:35], v102, s[24:27], s47 offen offset:2048 sc1
    s_add_u32 s47, s47, 6144
    buffer_load_dwordx4 a[36:39], v102, s[24:27], s47 offen offset:0 sc1
    buffer_load_dwordx4 a[40:43], v102, s[24:27], s47 offen offset:1024 sc1
    buffer_load_dwordx4 a[44:47], v102, s[24:27], s47 offen offset:2048 sc1
    s_add_u32 s47, s66, 4
    s_and_b32 s47, s47, 7
    s_mul_i32 s47, s47, 24576
    s_add_u32 s47, s47, s37
    buffer_load_dwordx4 a[48:51], v102, s[24:27], s47 offen offset:0 sc1
    buffer_load_dwordx4 a[52:55], v102, s[24:27], s47 offen offset:1024 sc1
    buffer_load_dwordx4 a[56:59], v102, s[24:27], s47 offen offset:2048 sc1
    s_add_u32 s47, s47, 6144
    buffer_load_dwordx4 a[60:63], v102, s[24:27], s47 offen offset:0 sc1
    buffer_load_dwordx4 a[64:67], v102, s[24:27], s47 offen offset:1024 sc1
    buffer_load_dwordx4 a[68:71], v102, s[24:27], s47 offen offset:2048 sc1
    s_add_u32 s47, s66, 6
    s_and_b32 s47, s47, 7
    s_mul_i32 s47, s47, 24576
    s_add_u32 s47, s47, s37
    buffer_load_dwordx4 a[72:75], v102, s[24:27], s47 offen offset:0 sc1
    buffer_load_dwordx4 a[76:79], v102, s[24:27], s47 offen offset:1024 sc1
    buffer_load_dwordx4 a[80:83], v102, s[24:27], s47 offen offset:2048 sc1
    s_add_u32 s47, s47, 6144
    buffer_load_dwordx4 a[84:87], v102, s[24:27], s47 offen offset:0 sc1
    buffer_load_dwordx4 a[88:91], v102, s[24:27], s47 offen offset:1024 sc1
    buffer_load_dwordx4 a[92:95], v102, s[24:27], s47 offen offset:2048 sc1
L_noearly:
    v_sub_u32 v27, v29, v102
    v_add_u32 v27, v27, v107
    s_add_u32 s44, s44, 1
    v_mov_b32 v111, s44
    ds_write_b32 v109, v111
    s_mov_b32 s47, 0x400000
L_ps2:
    ds_read_b32 v111, v110
    s_sub_u32 s47, s47, 1
    s_waitcnt lgkmcnt(0)
    v_readfirstlane_b32 s3, v111
    s_cmp_eq_u32 s47, 0
    s_cselect_b32 s3, s44, s3
    s_cmp_lt_u32 s3, s44
    s_cbranch_scc1 L_ps2
    ds_read_b64 v[8:9], v31 offset:0
    ds_read_b64 v[10:11], v31 offset:256
    ds_read_b64 v[12:13], v31 offset:512
    ds_read_b128 v[32:35], v29 offset:0
    ds_read_b128 v[36:39], v29 offset:1024
    ds_read_b128 v[40:43], v29 offset:2048
    ds_read_b128 v[44:47], v29 offset:3072
    ds_read_b128 v[48:51], v29 offset:4096
    ds_read_b128 v[52:55], v29 offset:5120
    ds_read_b128 v[56:59], v29 offset:6144
    ds_read_b128 v[60:63], v29 offset:7168
    s_waitcnt lgkmcnt(10)
    v_min_f32 v22, v2, v8
    v_sub_f32 v23, v22, v2
    v_sub_f32 v24, v22, v8
    v_exp_f32 v23, v23
    v_exp_f32 v24, v24
    v_mul_f32 v3, v3, v23
    v_fmac_f32 v3, v9, v24
    v_rcp_f32 v3, v3
    s_nop 0
    v_mul_f32 v16, v23, v3
    v_mul_f32 v17, v24, v3
    s_waitcnt lgkmcnt(9)
    v_min_f32 v22, v4, v10
    v_sub_f32 v23, v22, v4
    v_sub_f32 v24, v22, v10
    v_exp_f32 v23, v23
    v_exp_f32 v24, v24
    v_mul_f32 v5, v5, v23
    v_fmac_f32 v5, v11, v24
    v_rcp_f32 v5, v5
    s_nop 0
    v_mul_f32 v18, v23, v5
    v_mul_f32 v19, v24, v5
    s_waitcnt lgkmcnt(8)
    v_min_f32 v22, v6, v12
    v_sub_f32 v23, v22, v6
    v_sub_f32 v24, v22, v12
    v_exp_f32 v23, v23
    v_exp_f32 v24, v24
    v_mul_f32 v7, v7, v23
    v_fmac_f32 v7, v13, v24
    v_rcp_f32 v7, v7
    s_nop 0
    v_mul_f32 v20, v23, v7
    v_mul_f32 v21, v24, v7
    ds_read_b128 v[64:67], v29 offset:16384
    ds_read_b128 v[68:71], v29 offset:17408
    ds_read_b128 v[72:75], v29 offset:18432
    ds_read_b128 v[76:79], v29 offset:19456
    ds_read_b128 v[112:115], v29 offset:20480
    ds_read_b128 v[116:119], v29 offset:21504
    ds_read_b128 v[120:123], v29 offset:22528
    ds_read_b128 v[124:127], v29 offset:23552
    ds_read_b128 v[128:131], v29 offset:32768
    ds_read_b128 v[132:135], v29 offset:33792
    ds_read_b128 v[136:139], v29 offset:34816
    ds_read_b128 v[140:143], v29 offset:35840
    ds_read_b128 v[144:147], v29 offset:36864
    ds_read_b128 v[148:151], v29 offset:37888
    ds_read_b128 v[152:155], v29 offset:38912
    ds_read_b128 v[156:159], v29 offset:39936
    s_waitcnt lgkmcnt(14)
    v_pk_mul_f32 v[32:33], v[32:33], v[16:17] op_sel:[0,1] op_sel_hi:[1,1]
    v_pk_mul_f32 v[34:35], v[34:35], v[16:17] op_sel:[0,1] op_sel_hi:[1,1]
    v_pk_mul_f32 v[36:37], v[36:37], v[16:17] op_sel:[0,1] op_sel_hi:[1,1]
    v_pk_mul_f32 v[38:39], v[38:39], v[16:17] op_sel:[0,1] op_sel_hi:[1,1]
    v_pk_mul_f32 v[40:41], v[40:41], v[16:17] op_sel:[0,1] op_sel_hi:[1,1]
    v_pk_mul_f32 v[42:43], v[42:43], v[16:17] op_sel:[0,1] op_sel_hi:[1,1]
    v_pk_mul_f32 v[44:45], v[44:45], v[16:17] op_sel:[0,1] op_sel_hi:[1,1]
    v_pk_mul_f32 v[46:47], v[46:47], v[16:17] op_sel:[0,1] op_sel_hi:[1,1]
    v_pk_fma_f32 v[160:161], v[160:161], v[16:17], v[32:33] op_sel_hi:[1,0,1]
    v_pk_fma_f32 v[162:163], v[162:163], v[16:17], v[34:35] op_sel_hi:[1,0,1]
    v_pk_fma_f32 v[164:165], v[164:165], v[16:17], v[36:37] op_sel_hi:[1,0,1]
    v_pk_fma_f32 v[166:167], v[166:167], v[16:17], v[38:39] op_sel_hi:[1,0,1]
    v_pk_fma_f32 v[168:169], v[168:169], v[16:17], v[40:41] op_sel_hi:[1,0,1]
    v_pk_fma_f32 v[170:171], v[170:171], v[16:17], v[42:43] op_sel_hi:[1,0,1]
    v_pk_fma_f32 v[172:173], v[172:173], v[16:17], v[44:45] op_sel_hi:[1,0,1]
    v_pk_fma_f32 v[174:175], v[174:175], v[16:17], v[46:47] op_sel_hi:[1,0,1]
    v_cvt_pk_bf16_f32 v160, v160, v161
    v_cvt_pk_bf16_f32 v161, v162, v163
    v_cvt_pk_bf16_f32 v162, v164, v165
    v_cvt_pk_bf16_f32 v163, v166, v167
    v_cvt_pk_bf16_f32 v168, v168, v169
    v_cvt_pk_bf16_f32 v169, v170, v171
    v_cvt_pk_bf16_f32 v170, v172, v173
    v_cvt_pk_bf16_f32 v171, v174, v175
    s_add_u32 s47, s52, 0
    buffer_store_dwordx4 v[160:163], v107, s[24:27], s47 offen offset:0 sc1
    ds_write_b128 v27, v[160:163] offset:0
    buffer_store_dwordx4 v[168:171], v107, s[24:27], s47 offen offset:512 sc1
    ds_write_b128 v27, v[168:171] offset:512
    v_pk_mul_f32 v[48:49], v[48:49], v[18:19] op_sel:[0,1] op_sel_hi:[1,1]
    v_pk_mul_f32 v[50:51], v[50:51], v[18:19] op_sel:[0,1] op_sel_hi:[1,1]
    v_pk_mul_f32 v[52:53], v[52:53], v[18:19] op_sel:[0,1] op_sel_hi:[1,1]
    v_pk_mul_f32 v[54:55], v[54:55], v[18:19] op_sel:[0,1] op_sel_hi:[1,1]
    v_pk_mul_f32 v[56:57], v[56:57], v[18:19] op_sel:[0,1] op_sel_hi:[1,1]
    v_pk_mul_f32 v[58:59], v[58:59], v[18:19] op_sel:[0,1] op_sel_hi:[1,1]
    v_pk_mul_f32 v[60:61], v[60:61], v[18:19] op_sel:[0,1] op_sel_hi:[1,1]
    v_pk_mul_f32 v[62:63], v[62:63], v[18:19] op_sel:[0,1] op_sel_hi:[1,1]
    v_pk_fma_f32 v[176:177], v[176:177], v[18:19], v[48:49] op_sel_hi:[1,0,1]
    v_pk_fma_f32 v[178:179], v[178:179], v[18:19], v[50:51] op_sel_hi:[1,0,1]
    v_pk_fma_f32 v[180:181], v[180:181], v[18:19], v[52:53] op_sel_hi:[1,0,1]
    v_pk_fma_f32 v[182:183], v[182:183], v[18:19], v[54:55] op_sel_hi:[1,0,1]
    v_pk_fma_f32 v[184:185], v[184:185], v[18:19], v[56:57] op_sel_hi:[1,0,1]
    v_pk_fma_f32 v[186:187], v[186:187], v[18:19], v[58:59] op_sel_hi:[1,0,1]
    v_pk_fma_f32 v[188:189], v[188:189], v[18:19], v[60:61] op_sel_hi:[1,0,1]
    v_pk_fma_f32 v[190:191], v[190:191], v[18:19], v[62:63] op_sel_hi:[1,0,1]
    v_cvt_pk_bf16_f32 v176, v176, v177
    v_cvt_pk_bf16_f32 v177, v178, v179
    v_cvt_pk_bf16_f32 v178, v180, v181
    v_cvt_pk_bf16_f32 v179, v182, v183
    v_cvt_pk_bf16_f32 v184, v184, v185
    v_cvt_pk_bf16_f32 v185, v186, v187
    v_cvt_pk_bf16_f32 v186, v188, v189
    v_cvt_pk_bf16_f32 v187, v190, v191
    s_add_u32 s47, s52, 2048
    buffer_store_dwordx4 v[176:179], v107, s[24:27], s47 offen offset:0 sc1
    ds_write_b128 v27, v[176:179] offset:2048
    buffer_store_dwordx4 v[184:187], v107, s[24:27], s47 offen offset:512 sc1
    ds_write_b128 v27, v[184:187] offset:2560
    s_waitcnt lgkmcnt(14)
    v_pk_mul_f32 v[64:65], v[64:65], v[20:21] op_sel:[0,1] op_sel_hi:[1,1]
    v_pk_mul_f32 v[66:67], v[66:67], v[20:21] op_sel:[0,1] op_sel_hi:[1,1]
    v_pk_mul_f32 v[68:69], v[68:69], v[20:21] op_sel:[0,1] op_sel_hi:[1,1]
    v_pk_mul_f32 v[70:71], v[70:71], v[20:21] op_sel:[0,1] op_sel_hi:[1,1]
    v_pk_mul_f32 v[72:73], v[72:73], v[20:21] op_sel:[0,1] op_sel_hi:[1,1]
    v_pk_mul_f32 v[74:75], v[74:75], v[20:21] op_sel:[0,1] op_sel_hi:[1,1]
    v_pk_mul_f32 v[76:77], v[76:77], v[20:21] op_sel:[0,1] op_sel_hi:[1,1]
    v_pk_mul_f32 v[78:79], v[78:79], v[20:21] op_sel:[0,1] op_sel_hi:[1,1]
    v_pk_fma_f32 v[192:193], v[192:193], v[20:21], v[64:65] op_sel_hi:[1,0,1]
    v_pk_fma_f32 v[194:195], v[194:195], v[20:21], v[66:67] op_sel_hi:[1,0,1]
    v_pk_fma_f32 v[196:197], v[196:197], v[20:21], v[68:69] op_sel_hi:[1,0,1]
    v_pk_fma_f32 v[198:199], v[198:199], v[20:21], v[70:71] op_sel_hi:[1,0,1]
    v_pk_fma_f32 v[200:201], v[200:201], v[20:21], v[72:73] op_sel_hi:[1,0,1]
    v_pk_fma_f32 v[202:203], v[202:203], v[20:21], v[74:75] op_sel_hi:[1,0,1]
    v_pk_fma_f32 v[204:205], v[204:205], v[20:21], v[76:77] op_sel_hi:[1,0,1]
    v_pk_fma_f32 v[206:207], v[206:207], v[20:21], v[78:79] op_sel_hi:[1,0,1]
    v_cvt_pk_bf16_f32 v192, v192, v193
    v_cvt_pk_bf16_f32 v193, v194, v195
    v_cvt_pk_bf16_f32 v194, v196, v197
    v_cvt_pk_bf16_f32 v195, v198, v199
    v_cvt_pk_bf16_f32 v200, v200, v201
    v_cvt_pk_bf16_f32 v201, v202, v203
    v_cvt_pk_bf16_f32 v202, v204, v205
    v_cvt_pk_bf16_f32 v203, v206, v207
    s_add_u32 s47, s52, 4096
    buffer_store_dwordx4 v[192:195], v107, s[24:27], s47 offen offset:0 sc1
    ds_write_b128 v27, v[192:195] offset:4096
    buffer_store_dwordx4 v[200:203], v107, s[24:27], s47 offen offset:512 sc1
    ds_write_b128 v27, v[200:203] offset:4608
    s_waitcnt lgkmcnt(14)
    v_pk_mul_f32 v[112:113], v[112:113], v[16:17] op_sel:[0,1] op_sel_hi:[1,1]
    v_pk_mul_f32 v[114:115], v[114:115], v[16:17] op_sel:[0,1] op_sel_hi:[1,1]
    v_pk_mul_f32 v[116:117], v[116:117], v[16:17] op_sel:[0,1] op_sel_hi:[1,1]
    v_pk_mul_f32 v[118:119], v[118:119], v[16:17] op_sel:[0,1] op_sel_hi:[1,1]
    v_pk_mul_f32 v[120:121], v[120:121], v[16:17] op_sel:[0,1] op_sel_hi:[1,1]
    v_pk_mul_f32 v[122:123], v[122:123], v[16:17] op_sel:[0,1] op_sel_hi:[1,1]
    v_pk_mul_f32 v[124:125], v[124:125], v[16:17] op_sel:[0,1] op_sel_hi:[1,1]
    v_pk_mul_f32 v[126:127], v[126:127], v[16:17] op_sel:[0,1] op_sel_hi:[1,1]
    v_pk_fma_f32 v[208:209], v[208:209], v[16:17], v[112:113] op_sel_hi:[1,0,1]
    v_pk_fma_f32 v[210:211], v[210:211], v[16:17], v[114:115] op_sel_hi:[1,0,1]
    v_pk_fma_f32 v[212:213], v[212:213], v[16:17], v[116:117] op_sel_hi:[1,0,1]
    v_pk_fma_f32 v[214:215], v[214:215], v[16:17], v[118:119] op_sel_hi:[1,0,1]
    v_pk_fma_f32 v[216:217], v[216:217], v[16:17], v[120:121] op_sel_hi:[1,0,1]
    v_pk_fma_f32 v[218:219], v[218:219], v[16:17], v[122:123] op_sel_hi:[1,0,1]
    v_pk_fma_f32 v[220:221], v[220:221], v[16:17], v[124:125] op_sel_hi:[1,0,1]
    v_pk_fma_f32 v[222:223], v[222:223], v[16:17], v[126:127] op_sel_hi:[1,0,1]
    v_cvt_pk_bf16_f32 v208, v208, v209
    v_cvt_pk_bf16_f32 v209, v210, v211
    v_cvt_pk_bf16_f32 v210, v212, v213
    v_cvt_pk_bf16_f32 v211, v214, v215
    v_cvt_pk_bf16_f32 v216, v216, v217
    v_cvt_pk_bf16_f32 v217, v218, v219
    v_cvt_pk_bf16_f32 v218, v220, v221
    v_cvt_pk_bf16_f32 v219, v222, v223
    s_add_u32 s47, s52, 6144
    buffer_store_dwordx4 v[208:211], v107, s[24:27], s47 offen offset:0 sc1
    ds_write_b128 v27, v[208:211] offset:6144
    buffer_store_dwordx4 v[216:219], v107, s[24:27], s47 offen offset:512 sc1
    ds_write_b128 v27, v[216:219] offset:6656
    s_waitcnt lgkmcnt(12)
    v_pk_mul_f32 v[128:129], v[128:129], v[18:19] op_sel:[0,1] op_sel_hi:[1,1]
    v_pk_mul_f32 v[130:131], v[130:131], v[18:19] op_sel:[0,1] op_sel_hi:[1,1]
    v_pk_mul_f32 v[132:133], v[132:133], v[18:19] op_sel:[0,1] op_sel_hi:[1,1]
    v_pk_mul_f32 v[134:135], v[134:135], v[18:19] op_sel:[0,1] op_sel_hi:[1,1]
    v_pk_mul_f32 v[136:137], v[136:137], v[18:19] op_sel:[0,1] op_sel_hi:[1,1]
    v_pk_mul_f32 v[138:139], v[138:139], v[18:19] op_sel:[0,1] op_sel_hi:[1,1]
    v_pk_mul_f32 v[140:141], v[140:141], v[18:19] op_sel:[0,1] op_sel_hi:[1,1]
    v_pk_mul_f32 v[142:143], v[142:143], v[18:19] op_sel:[0,1] op_sel_hi:[1,1]
    v_pk_fma_f32 v[224:225], v[224:225], v[18:19], v[128:129] op_sel_hi:[1,0,1]
    v_pk_fma_f32 v[226:227], v[226:227], v[18:19], v[130:131] op_sel_hi:[1,0,1]
    v_pk_fma_f32 v[228:229], v[228:229], v[18:19], v[132:133] op_sel_hi:[1,0,1]
    v_pk_fma_f32 v[230:231], v[230:231], v[18:19], v[134:135] op_sel_hi:[1,0,1]
    v_pk_fma_f32 v[232:233], v[232:233], v[18:19], v[136:137] op_sel_hi:[1,0,1]
    v_pk_fma_f32 v[234:235], v[234:235], v[18:19], v[138:139] op_sel_hi:[1,0,1]
    v_pk_fma_f32 v[236:237], v[236:237], v[18:19], v[140:141] op_sel_hi:[1,0,1]
    v_pk_fma_f32 v[238:239], v[238:239], v[18:19], v[142:143] op_sel_hi:[1,0,1]
    v_cvt_pk_bf16_f32 v224, v224, v225
    v_cvt_pk_bf16_f32 v225, v226, v227
    v_cvt_pk_bf16_f32 v226, v228, v229
    v_cvt_pk_bf16_f32 v227, v230, v231
    v_cvt_pk_bf16_f32 v232, v232, v233
    v_cvt_pk_bf16_f32 v233, v234, v235
    v_cvt_pk_bf16_f32 v234, v236, v237
    v_cvt_pk_bf16_f32 v235, v238, v239
    s_add_u32 s47, s52, 8192
    buffer_store_dwordx4 v[224:227], v107, s[24:27], s47 offen offset:0 sc1
    ds_write_b128 v27, v[224:227] offset:16384
    buffer_store_dwordx4 v[232:235], v107, s[24:27], s47 offen offset:512 sc1
    ds_write_b128 v27, v[232:235] offset:16896
    s_waitcnt lgkmcnt(10)
    v_pk_mul_f32 v[144:145], v[144:145], v[20:21] op_sel:[0,1] op_sel_hi:[1,1]
    v_pk_mul_f32 v[146:147], v[146:147], v[20:21] op_sel:[0,1] op_sel_hi:[1,1]
    v_pk_mul_f32 v[148:149], v[148:149], v[20:21] op_sel:[0,1] op_sel_hi:[1,1]
    v_pk_mul_f32 v[150:151], v[150:151], v[20:21] op_sel:[0,1] op_sel_hi:[1,1]
    v_pk_mul_f32 v[152:153], v[152:153], v[20:21] op_sel:[0,1] op_sel_hi:[1,1]
    v_pk_mul_f32 v[154:155], v[154:155], v[20:21] op_sel:[0,1] op_sel_hi:[1,1]
    v_pk_mul_f32 v[156:157], v[156:157], v[20:21] op_sel:[0,1] op_sel_hi:[1,1]
    v_pk_mul_f32 v[158:159], v[158:159], v[20:21] op_sel:[0,1] op_sel_hi:[1,1]
    v_pk_fma_f32 v[240:241], v[240:241], v[20:21], v[144:145] op_sel_hi:[1,0,1]
    v_pk_fma_f32 v[242:243], v[242:243], v[20:21], v[146:147] op_sel_hi:[1,0,1]
    v_pk_fma_f32 v[244:245], v[244:245], v[20:21], v[148:149] op_sel_hi:[1,0,1]
    v_pk_fma_f32 v[246:247], v[246:247], v[20:21], v[150:151] op_sel_hi:[1,0,1]
    v_pk_fma_f32 v[248:249], v[248:249], v[20:21], v[152:153] op_sel_hi:[1,0,1]
    v_pk_fma_f32 v[250:251], v[250:251], v[20:21], v[154:155] op_sel_hi:[1,0,1]
    v_pk_fma_f32 v[252:253], v[252:253], v[20:21], v[156:157] op_sel_hi:[1,0,1]
    v_pk_fma_f32 v[254:255], v[254:255], v[20:21], v[158:159] op_sel_hi:[1,0,1]
    v_cvt_pk_bf16_f32 v240, v240, v241
    v_cvt_pk_bf16_f32 v241, v242, v243
    v_cvt_pk_bf16_f32 v242, v244, v245
    v_cvt_pk_bf16_f32 v243, v246, v247
    v_cvt_pk_bf16_f32 v248, v248, v249
    v_cvt_pk_bf16_f32 v249, v250, v251
    v_cvt_pk_bf16_f32 v250, v252, v253
    v_cvt_pk_bf16_f32 v251, v254, v255
    s_add_u32 s47, s52, 10240
    buffer_store_dwordx4 v[240:243], v107, s[24:27], s47 offen offset:0 sc1
    ds_write_b128 v27, v[240:243] offset:18432
    buffer_store_dwordx4 v[248:251], v107, s[24:27], s47 offen offset:512 sc1
    ds_write_b128 v27, v[248:251] offset:18944
    v_mov_b32 v14, s75
    s_cmp_eq_u32 s7, 1
    s_cbranch_scc1 L_tailY
    s_waitcnt vmcnt(0)
    buffer_store_dword v14, v108, s[24:27], s70 offen sc1
    v_add_u32 v3, 8192, v102
    s_waitcnt lgkmcnt(0)
    s_add_u32 s44, s44, 1
    v_mov_b32 v111, s44
    ds_write_b32 v109, v111
    s_mov_b32 s47, 0x400000
L_ps3:
    ds_read_b32 v111, v110
    s_sub_u32 s47, s47, 1
    s_waitcnt lgkmcnt(0)
    v_readfirstlane_b32 s3, v111
    s_cmp_eq_u32 s47, 0
    s_cselect_b32 s3, s44, s3
    s_cmp_lt_u32 s3, s44
    s_cbranch_scc1 L_ps3
    s_cmp_eq_u32 s6, 1
    s_cbranch_scc1 L_x1
    ds_read_b128 a[192:195], v3 offset:0
    ds_read_b128 a[196:199], v3 offset:1024
    ds_read_b128 a[200:203], v3 offset:2048
    ds_read_b128 a[204:207], v3 offset:6144
    ds_read_b128 a[208:211], v3 offset:7168
    ds_read_b128 a[212:215], v3 offset:16384
    ds_read_b128 a[216:219], v102 offset:0
    ds_read_b128 a[220:223], v102 offset:1024
    ds_read_b128 a[224:227], v102 offset:2048
    ds_read_b128 a[228:231], v102 offset:6144
    ds_read_b128 a[232:235], v102 offset:7168
    ds_read_b128 a[236:239], v102 offset:16384
    s_branch L_x2
L_x1:
    ds_read_b128 a[192:195], v3 offset:3072
    ds_read_b128 a[196:199], v3 offset:4096
    ds_read_b128 a[200:203], v3 offset:5120
    ds_read_b128 a[204:207], v3 offset:17408
    ds_read_b128 a[208:211], v3 offset:18432
    ds_read_b128 a[212:215], v3 offset:19456
    ds_read_b128 a[216:219], v102 offset:3072
    ds_read_b128 a[220:223], v102 offset:4096
    ds_read_b128 a[224:227], v102 offset:5120
    ds_read_b128 a[228:231], v102 offset:17408
    ds_read_b128 a[232:235], v102 offset:18432
    ds_read_b128 a[236:239], v102 offset:19456
L_x2:
    v_add_u32 v80, 0, v1
    v_mul_u32_u24 v28, 58255, v80
    v_lshrrev_b32 v28, 20, v28
    v_mul_u32_u24 v83, 18, v28
    v_sub_u32 v83, v80, v83
    v_xor_b32 v29, 1, v83
    v_sub_u32 v29, 17, v29
    v_mul_u32_u24 v28, 1152, v28
    v_lshl_add_u32 v224, v29, 4, v28
    v_add_u32 v80, 64, v1
    v_mul_u32_u24 v28, 58255, v80
    v_lshrrev_b32 v28, 20, v28
    v_mul_u32_u24 v83, 18, v28
    v_sub_u32 v83, v80, v83
    v_xor_b32 v29, 1, v83
    v_sub_u32 v29, 17, v29
    v_mul_u32_u24 v28, 1152, v28
    v_lshl_add_u32 v225, v29, 4, v28
    v_add_u32 v80, 128, v1
    v_mul_u32_u24 v28, 58255, v80
    v_lshrrev_b32 v28, 20, v28
    v_mul_u32_u24 v83, 18, v28
    v_sub_u32 v83, v80, v83
    v_xor_b32 v29, 1, v83
    v_sub_u32 v29, 17, v29
    v_mul_u32_u24 v28, 1152, v28
    v_lshl_add_u32 v226, v29, 4, v28
    v_add_u32 v80, 192, v1
    v_mul_u32_u24 v28, 58255, v80
    v_lshrrev_b32 v28, 20, v28
    v_mul_u32_u24 v83, 18, v28
    v_sub_u32 v83, v80, v83
    v_xor_b32 v29, 1, v83
    v_sub_u32 v29, 17, v29
    v_mul_u32_u24 v28, 1152, v28
    v_lshl_add_u32 v227, v29, 4, v28
    v_add_u32 v80, 256, v1
    v_mul_u32_u24 v28, 58255, v80
    v_lshrrev_b32 v28, 20, v28
    v_mul_u32_u24 v83, 18, v28
    v_sub_u32 v83, v80, v83
    v_xor_b32 v29, 1, v83
    v_sub_u32 v29, 17, v29
    v_mul_u32_u24 v28, 1152, v28
    v_lshl_add_u32 v228, v29, 4, v28
    v_add_u32 v80, 320, v1
    v_mul_u32_u24 v28, 58255, v80
    v_lshrrev_b32 v28, 20, v28
    v_mul_u32_u24 v83, 18, v28
    v_sub_u32 v83, v80, v83
    v_xor_b32 v29, 1, v83
    v_sub_u32 v29, 17, v29
    v_mul_u32_u24 v28, 1152, v28
    v_lshl_add_u32 v229, v29, 4, v28
    v_add_u32 v80, 384, v1
    v_mul_u32_u24 v28, 58255, v80
    v_lshrrev_b32 v28, 20, v28
    v_mul_u32_u24 v83, 18, v28
    v_sub_u32 v83, v80, v83
    v_xor_b32 v29, 1, v83
    v_sub_u32 v29, 17, v29
    v_mul_u32_u24 v28, 1152, v28
    v_lshl_add_u32 v230, v29, 4, v28
    v_add_u32 v80, 448, v1
    v_mul_u32_u24 v28, 58255, v80
    v_lshrrev_b32 v28, 20, v28
    v_mul_u32_u24 v83, 18, v28
    v_sub_u32 v83, v80, v83
    v_xor_b32 v29, 1, v83
    v_sub_u32 v29, 17, v29
    v_mul_u32_u24 v28, 1152, v28
    v_lshl_add_u32 v231, v29, 4, v28
    v_add_u32 v80, 512, v1
    v_mul_u32_u24 v28, 58255, v80
    v_lshrrev_b32 v28, 20, v28
    v_mul_u32_u24 v83, 18, v28
    v_sub_u32 v83, v80, v83
    v_xor_b32 v29, 1, v83
    v_sub_u32 v29, 17, v29
    v_mul_u32_u24 v28, 1152, v28
    v_lshl_add_u32 v232, v29, 4, v28
    s_waitcnt lgkmcnt(0)
    s_add_u32 s44, s44, 1
    v_mov_b32 v111, s44
    ds_write_b32 v109, v111
    s_mov_b32 s47, 0x400000
L_ps4:
    ds_read_b32 v111, v110
    s_sub_u32 s47, s47, 1
    s_waitcnt lgkmcnt(0)
    v_readfirstlane_b32 s3, v111
    s_cmp_eq_u32 s47, 0
    s_cselect_b32 s3, s44, s3
    s_cmp_lt_u32 s3, s44
    s_cbranch_scc1 L_ps4
    ds_read_b64_tr_b16 v[16:17], v103 offset:0
    ds_read_b64_tr_b16 v[18:19], v103 offset:2304
    ds_read_b64_tr_b16 v[20:21], v103 offset:32
    ds_read_b64_tr_b16 v[22:23], v103 offset:2336
    ds_read_b64_tr_b16 v[24:25], v103 offset:64
    ds_read_b64_tr_b16 v[26:27], v103 offset:2368
    ds_read_b64_tr_b16 v[28:29], v103 offset:96
    ds_read_b64_tr_b16 v[30:31], v103 offset:2400
    ds_read_b64_tr_b16 v[32:33], v103 offset:128
    ds_read_b64_tr_b16 v[34:35], v103 offset:2432
    ds_read_b64_tr_b16 v[36:37], v103 offset:160
    ds_read_b64_tr_b16 v[38:39], v103 offset:2464
    ds_read_b64_tr_b16 v[40:41], v103 offset:192
    ds_read_b64_tr_b16 v[42:43], v103 offset:2496
    ds_read_b64_tr_b16 v[44:45], v103 offset:224
    ds_read_b64_tr_b16 v[46:47], v103 offset:2528
    ds_read_b64_tr_b16 v[48:49], v103 offset:256
    ds_read_b64_tr_b16 v[50:51], v103 offset:2560
    s_add_u32 s69, s71, 50331648
    v_and_b32 v13, 3, v1
    v_lshlrev_b32 v13, 10, v13
    v_and_b32 v14, 4, v1
    v_add_u32 v13, v13, v14
    buffer_load_dword v12, v13, s[24:27], s69 offen sc1
    s_waitcnt lgkmcnt(0)
    v_mfma_f32_16x16x32_bf16 v[112:115], v[16:19], a[192:195], 0
    ds_read_b64_tr_b16 v[52:53], v103 offset:9216
    v_mfma_f32_16x16x32_bf16 v[116:119], v[16:19], a[196:199], 0
    ds_read_b64_tr_b16 v[54:55], v103 offset:11520
    v_mfma_f32_16x16x32_bf16 v[120:123], v[16:19], a[200:203], 0
    ds_read_b64_tr_b16 v[56:57], v103 offset:9248
    s_add_u32 s4, s66, 2
    s_and_b32 s4, s4, 7
    s_mul_i32 s4, s4, 147456
    s_add_u32 s4, s4, s68
    s_add_u32 s4, s4, 0
    s_add_u32 m0, s65, 0
    s_nop 0
    buffer_load_dwordx4 v93, s[60:63], s4 offen lds
    v_mfma_f32_16x16x32_bf16 v[124:127], v[20:23], a[192:195], 0
    ds_read_b64_tr_b16 v[58:59], v103 offset:11552
    v_mfma_f32_16x16x32_bf16 v[128:131], v[20:23], a[196:199], 0
    v_mfma_f32_16x16x32_bf16 v[132:135], v[20:23], a[200:203], 0
    ds_read_b64_tr_b16 v[60:61], v103 offset:9280
    v_mfma_f32_16x16x32_bf16 v[136:139], v[24:27], a[192:195], 0
    ds_read_b64_tr_b16 v[62:63], v103 offset:11584
    s_add_u32 m0, s65, 1024
    s_nop 0
    buffer_load_dwordx4 v94, s[60:63], s4 offen lds
    v_mfma_f32_16x16x32_bf16 v[140:143], v[24:27], a[196:199], 0
    ds_read_b64_tr_b16 v[64:65], v103 offset:9312
    v_mfma_f32_16x16x32_bf16 v[144:147], v[24:27], a[200:203], 0
    ds_read_b64_tr_b16 v[66:67], v103 offset:11616
    s_add_u32 m0, s65, 2048
    s_nop 0
    buffer_load_dwordx4 v95, s[60:63], s4 offen lds
    v_mfma_f32_16x16x32_bf16 v[148:151], v[28:31], a[192:195], 0
    ds_read_b64_tr_b16 v[68:69], v103 offset:9344
    v_mfma_f32_16x16x32_bf16 v[152:155], v[28:31], a[196:199], 0
    ds_read_b64_tr_b16 v[70:71], v103 offset:11648
    v_mfma_f32_16x16x32_bf16 v[156:159], v[28:31], a[200:203], 0
    ds_read_b64_tr_b16 v[72:73], v103 offset:9376
    s_add_u32 m0, s65, 3072
    s_nop 0
    buffer_load_dwordx4 v96, s[60:63], s4 offen lds
    v_mfma_f32_16x16x32_bf16 v[160:163], v[32:35], a[192:195], 0
    ds_read_b64_tr_b16 v[74:75], v103 offset:11680
    v_mfma_f32_16x16x32_bf16 v[164:167], v[32:35], a[196:199], 0
    ds_read_b64_tr_b16 v[76:77], v103 offset:9408
    v_mfma_f32_16x16x32_bf16 v[168:171], v[32:35], a[200:203], 0
    s_add_u32 m0, s65, 4096
    s_nop 0
    buffer_load_dwordx4 v97, s[60:63], s4 offen lds
    v_mfma_f32_16x16x32_bf16 v[172:175], v[36:39], a[192:195], 0
    ds_read_b64_tr_b16 v[78:79], v103 offset:11712
    v_mfma_f32_16x16x32_bf16 v[176:179], v[36:39], a[196:199], 0
    ds_read_b64_tr_b16 v[80:81], v103 offset:9440
    v_mfma_f32_16x16x32_bf16 v[180:183], v[36:39], a[200:203], 0
    ds_read_b64_tr_b16 v[82:83], v103 offset:11744
    s_add_u32 m0, s65, 5120
    s_nop 0
    buffer_load_dwordx4 v98, s[60:63], s4 offen lds
    v_mfma_f32_16x16x32_bf16 v[184:187], v[40:43], a[192:195], 0
    ds_read_b64_tr_b16 v[84:85], v103 offset:9472
    v_mfma_f32_16x16x32_bf16 v[188:191], v[40:43], a[196:199], 0
    ds_read_b64_tr_b16 v[86:87], v103 offset:11776
    v_mfma_f32_16x16x32_bf16 v[192:195], v[40:43], a[200:203], 0
    s_add_u32 m0, s65, 6144
    s_nop 0
    buffer_load_dwordx4 v99, s[60:63], s4 offen lds
    v_mfma_f32_16x16x32_bf16 v[196:199], v[44:47], a[192:195], 0
    v_mfma_f32_16x16x32_bf16 v[200:203], v[44:47], a[196:199], 0
    s_add_u32 m0, s65, 7168
    s_nop 0
    buffer_load_dwordx4 v100, s[60:63], s4 offen lds
    v_mfma_f32_16x16x32_bf16 v[204:207], v[44:47], a[200:203], 0
    v_mfma_f32_16x16x32_bf16 v[208:211], v[48:51], a[192:195], 0
    v_mfma_f32_16x16x32_bf16 v[212:215], v[48:51], a[196:199], 0
    s_add_u32 m0, s65, 8192
    s_nop 0
    buffer_load_dwordx4 v101, s[60:63], s4 offen lds
    v_mfma_f32_16x16x32_bf16 v[216:219], v[48:51], a[200:203], 0
    s_waitcnt lgkmcnt(0)
    v_mfma_f32_16x16x32_bf16 v[112:115], v[52:55], a[204:207], v[112:115]
    ds_read_b64_tr_b16 v[16:17], v103 offset:18432
    v_mfma_f32_16x16x32_bf16 v[116:119], v[52:55], a[208:211], v[116:119]
    ds_read_b64_tr_b16 v[18:19], v103 offset:20736
    v_mfma_f32_16x16x32_bf16 v[120:123], v[52:55], a[212:215], v[120:123]
    ds_read_b64_tr_b16 v[20:21], v103 offset:18464
    s_add_u32 s4, s66, 2
    s_and_b32 s4, s4, 7
    s_mul_i32 s4, s4, 147456
    s_add_u32 s4, s4, s68
    s_add_u32 s4, s4, 73728
    s_add_u32 m0, s65, 18432
    s_nop 0
    buffer_load_dwordx4 v224, s[60:63], s4 offen lds
    v_mfma_f32_16x16x32_bf16 v[124:127], v[56:59], a[204:207], v[124:127]
    ds_read_b64_tr_b16 v[22:23], v103 offset:20768
    v_mfma_f32_16x16x32_bf16 v[128:131], v[56:59], a[208:211], v[128:131]
    v_mfma_f32_16x16x32_bf16 v[132:135], v[56:59], a[212:215], v[132:135]
    ds_read_b64_tr_b16 v[24:25], v103 offset:18496
    v_mfma_f32_16x16x32_bf16 v[136:139], v[60:63], a[204:207], v[136:139]
    ds_read_b64_tr_b16 v[26:27], v103 offset:20800
    s_add_u32 m0, s65, 19456
    s_nop 0
    buffer_load_dwordx4 v225, s[60:63], s4 offen lds
    v_mfma_f32_16x16x32_bf16 v[140:143], v[60:63], a[208:211], v[140:143]
    ds_read_b64_tr_b16 v[28:29], v103 offset:18528
    v_mfma_f32_16x16x32_bf16 v[144:147], v[60:63], a[212:215], v[144:147]
    ds_read_b64_tr_b16 v[30:31], v103 offset:20832
    s_add_u32 m0, s65, 20480
    s_nop 0
    buffer_load_dwordx4 v226, s[60:63], s4 offen lds
    v_mfma_f32_16x16x32_bf16 v[148:151], v[64:67], a[204:207], v[148:151]
    ds_read_b64_tr_b16 v[32:33], v103 offset:18560
    v_mfma_f32_16x16x32_bf16 v[152:155], v[64:67], a[208:211], v[152:155]
    ds_read_b64_tr_b16 v[34:35], v103 offset:20864
    v_mfma_f32_16x16x32_bf16 v[156:159], v[64:67], a[212:215], v[156:159]
    ds_read_b64_tr_b16 v[36:37], v103 offset:18592
    s_add_u32 m0, s65, 21504
    s_nop 0
    buffer_load_dwordx4 v227, s[60:63], s4 offen lds
    v_mfma_f32_16x16x32_bf16 v[160:163], v[68:71], a[204:207], v[160:163]
    ds_read_b64_tr_b16 v[38:39], v103 offset:20896
    v_mfma_f32_16x16x32_bf16 v[164:167], v[68:71], a[208:211], v[164:167]
    ds_read_b64_tr_b16 v[40:41], v103 offset:18624
    v_mfma_f32_16x16x32_bf16 v[168:171], v[68:71], a[212:215], v[168:171]
    s_add_u32 m0, s65, 22528
    s_nop 0
    buffer_load_dwordx4 v228, s[60:63], s4 offen lds
    v_mfma_f32_16x16x32_bf16 v[172:175], v[72:75], a[204:207], v[172:175]
    ds_read_b64_tr_b16 v[42:43], v103 offset:20928
    v_mfma_f32_16x16x32_bf16 v[176:179], v[72:75], a[208:211], v[176:179]
    ds_read_b64_tr_b16 v[44:45], v103 offset:18656
    v_mfma_f32_16x16x32_bf16 v[180:183], v[72:75], a[212:215], v[180:183]
    ds_read_b64_tr_b16 v[46:47], v103 offset:20960
    s_add_u32 m0, s65, 23552
    s_nop 0
    buffer_load_dwordx4 v229, s[60:63], s4 offen lds
    v_mfma_f32_16x16x32_bf16 v[184:187], v[76:79], a[204:207], v[184:187]
    ds_read_b64_tr_b16 v[48:49], v103 offset:18688
    v_mfma_f32_16x16x32_bf16 v[188:191], v[76:79], a[208:211], v[188:191]
    ds_read_b64_tr_b16 v[50:51], v103 offset:20992
    v_mfma_f32_16x16x32_bf16 v[192:195], v[76:79], a[212:215], v[192:195]
    s_add_u32 m0, s65, 24576
    s_nop 0
    buffer_load_dwordx4 v230, s[60:63], s4 offen lds
    v_mfma_f32_16x16x32_bf16 v[196:199], v[80:83], a[204:207], v[196:199]
    v_mfma_f32_16x16x32_bf16 v[200:203], v[80:83], a[208:211], v[200:203]
    s_add_u32 m0, s65, 25600
    s_nop 0
    buffer_load_dwordx4 v231, s[60:63], s4 offen lds
    v_mfma_f32_16x16x32_bf16 v[204:207], v[80:83], a[212:215], v[204:207]
    v_mfma_f32_16x16x32_bf16 v[208:211], v[84:87], a[204:207], v[208:211]
    v_mfma_f32_16x16x32_bf16 v[212:215], v[84:87], a[208:211], v[212:215]
    s_add_u32 m0, s65, 26624
    s_nop 0
    buffer_load_dwordx4 v232, s[60:63], s4 offen lds
    v_mfma_f32_16x16x32_bf16 v[216:219], v[84:87], a[212:215], v[216:219]
    s_mov_b32 s4, 0x100000
L_pollA:
    s_waitcnt vmcnt(0)
    v_cmp_ne_u32 vcc, s75, v12
    s_cbranch_vccz L_gotA
    s_sleep 1
    buffer_load_dword v12, v13, s[24:27], s69 offen sc1
    s_sub_u32 s4, s4, 1
    s_cmp_lg_u32 s4, 0
    s_cbranch_scc1 L_pollA
L_gotA:
    s_waitcnt vmcnt(0)
    s_waitcnt lgkmcnt(0)
    v_mfma_f32_16x16x32_bf16 v[112:115], v[16:19], a[216:219], v[112:115]
    ds_read_b64_tr_b16 v[52:53], v103 offset:27648
    v_mfma_f32_16x16x32_bf16 v[116:119], v[16:19], a[220:223], v[116:119]
    ds_read_b64_tr_b16 v[54:55], v103 offset:29952
    v_mfma_f32_16x16x32_bf16 v[120:123], v[16:19], a[224:227], v[120:123]
    ds_read_b64_tr_b16 v[56:57], v103 offset:27680
    v_mfma_f32_16x16x32_bf16 v[124:127], v[20:23], a[216:219], v[124:127]
    ds_read_b64_tr_b16 v[58:59], v103 offset:29984
    v_mfma_f32_16x16x32_bf16 v[128:131], v[20:23], a[220:223], v[128:131]
    v_mfma_f32_16x16x32_bf16 v[132:135], v[20:23], a[224:227], v[132:135]
    ds_read_b64_tr_b16 v[60:61], v103 offset:27712
    v_mfma_f32_16x16x32_bf16 v[136:139], v[24:27], a[216:219], v[136:139]
    ds_read_b64_tr_b16 v[62:63], v103 offset:30016
    v_mfma_f32_16x16x32_bf16 v[140:143], v[24:27], a[220:223], v[140:143]
    ds_read_b64_tr_b16 v[64:65], v103 offset:27744
    v_mfma_f32_16x16x32_bf16 v[144:147], v[24:27], a[224:227], v[144:147]
    ds_read_b64_tr_b16 v[66:67], v103 offset:30048
    v_mfma_f32_16x16x32_bf16 v[148:151], v[28:31], a[216:219], v[148:151]
    ds_read_b64_tr_b16 v[68:69], v103 offset:27776
    v_mfma_f32_16x16x32_bf16 v[152:155], v[28:31], a[220:223], v[152:155]
    ds_read_b64_tr_b16 v[70:71], v103 offset:30080
    v_mfma_f32_16x16x32_bf16 v[156:159], v[28:31], a[224:227], v[156:159]
    ds_read_b64_tr_b16 v[72:73], v103 offset:27808
    v_mfma_f32_16x16x32_bf16 v[160:163], v[32:35], a[216:219], v[160:163]
    ds_read_b64_tr_b16 v[74:75], v103 offset:30112
    v_mfma_f32_16x16x32_bf16 v[164:167], v[32:35], a[220:223], v[164:167]
    ds_read_b64_tr_b16 v[76:77], v103 offset:27840
    v_mfma_f32_16x16x32_bf16 v[168:171], v[32:35], a[224:227], v[168:171]
    v_mfma_f32_16x16x32_bf16 v[172:175], v[36:39], a[216:219], v[172:175]
    ds_read_b64_tr_b16 v[78:79], v103 offset:30144
    v_mfma_f32_16x16x32_bf16 v[176:179], v[36:39], a[220:223], v[176:179]
    ds_read_b64_tr_b16 v[80:81], v103 offset:27872
    v_mfma_f32_16x16x32_bf16 v[180:183], v[36:39], a[224:227], v[180:183]
    ds_read_b64_tr_b16 v[82:83], v103 offset:30176
    v_mfma_f32_16x16x32_bf16 v[184:187], v[40:43], a[216:219], v[184:187]
    ds_read_b64_tr_b16 v[84:85], v103 offset:27904
    v_mfma_f32_16x16x32_bf16 v[188:191], v[40:43], a[220:223], v[188:191]
    ds_read_b64_tr_b16 v[86:87], v103 offset:30208
    v_mfma_f32_16x16x32_bf16 v[192:195], v[40:43], a[224:227], v[192:195]
    v_mfma_f32_16x16x32_bf16 v[196:199], v[44:47], a[216:219], v[196:199]
    v_mfma_f32_16x16x32_bf16 v[200:203], v[44:47], a[220:223], v[200:203]
    v_mfma_f32_16x16x32_bf16 v[204:207], v[44:47], a[224:227], v[204:207]
    v_mfma_f32_16x16x32_bf16 v[208:211], v[48:51], a[216:219], v[208:211]
    v_mfma_f32_16x16x32_bf16 v[212:215], v[48:51], a[220:223], v[212:215]
    v_mfma_f32_16x16x32_bf16 v[216:219], v[48:51], a[224:227], v[216:219]
    s_waitcnt lgkmcnt(0)
    s_add_u32 s44, s44, 1
    v_mov_b32 v111, s44
    ds_write_b32 v109, v111
    s_mov_b32 s47, 0x400000
L_ps5:
    ds_read_b32 v111, v110
    s_sub_u32 s47, s47, 1
    s_waitcnt lgkmcnt(0)
    v_readfirstlane_b32 s3, v111
    s_cmp_eq_u32 s47, 0
    s_cselect_b32 s3, s44, s3
    s_cmp_lt_u32 s3, s44
    s_cbranch_scc1 L_ps5
    s_waitcnt lgkmcnt(0)
    v_mfma_f32_16x16x32_bf16 v[112:115], v[52:55], a[228:231], v[112:115]
    v_mfma_f32_16x16x32_bf16 v[116:119], v[52:55], a[232:235], v[116:119]
    s_add_u32 s4, s66, 4
    s_and_b32 s4, s4, 7
    s_mul_i32 s4, s4, 147456
    s_add_u32 s4, s4, s68
    s_add_u32 s4, s4, 0
    s_add_u32 m0, s65, 122880
    s_nop 0
    buffer_load_dwordx4 v93, s[60:63], s4 offen lds
    v_mfma_f32_16x16x32_bf16 v[120:123], v[52:55], a[236:239], v[120:123]
    v_mfma_f32_16x16x32_bf16 v[124:127], v[56:59], a[228:231], v[124:127]
    s_add_u32 m0, s65, 123904
    s_nop 0
    buffer_load_dwordx4 v94, s[60:63], s4 offen lds
    v_mfma_f32_16x16x32_bf16 v[128:131], v[56:59], a[232:235], v[128:131]
    s_add_u32 m0, s65, 124928
    s_nop 0
    buffer_load_dwordx4 v95, s[60:63], s4 offen lds
    v_mfma_f32_16x16x32_bf16 v[132:135], v[56:59], a[236:239], v[132:135]
    s_add_u32 m0, s65, 125952
    s_nop 0
    buffer_load_dwordx4 v96, s[60:63], s4 offen lds
    v_mfma_f32_16x16x32_bf16 v[136:139], v[60:63], a[228:231], v[136:139]
    v_mfma_f32_16x16x32_bf16 v[140:143], v[60:63], a[232:235], v[140:143]
    s_add_u32 m0, s65, 126976
    s_nop 0
    buffer_load_dwordx4 v97, s[60:63], s4 offen lds
    v_mfma_f32_16x16x32_bf16 v[144:147], v[60:63], a[236:239], v[144:147]
    s_add_u32 m0, s65, 128000
    s_nop 0
    buffer_load_dwordx4 v98, s[60:63], s4 offen lds
    v_mfma_f32_16x16x32_bf16 v[148:151], v[64:67], a[228:231], v[148:151]
    v_mfma_f32_16x16x32_bf16 v[152:155], v[64:67], a[232:235], v[152:155]
    s_add_u32 m0, s65, 129024
    s_nop 0
    buffer_load_dwordx4 v99, s[60:63], s4 offen lds
    v_mfma_f32_16x16x32_bf16 v[156:159], v[64:67], a[236:239], v[156:159]
    s_add_u32 m0, s65, 130048
    s_nop 0
    buffer_load_dwordx4 v100, s[60:63], s4 offen lds
    v_mfma_f32_16x16x32_bf16 v[160:163], v[68:71], a[228:231], v[160:163]
    s_add_u32 m0, s65, 131072
    s_nop 0
    buffer_load_dwordx4 v101, s[60:63], s4 offen lds
    v_mfma_f32_16x16x32_bf16 v[164:167], v[68:71], a[232:235], v[164:167]
    v_mfma_f32_16x16x32_bf16 v[168:171], v[68:71], a[236:239], v[168:171]
    s_add_u32 s4, s66, 4
    s_and_b32 s4, s4, 7
    s_mul_i32 s4, s4, 147456
    s_add_u32 s4, s4, s68
    s_add_u32 s4, s4, 73728
    s_add_u32 m0, s65, 141312
    s_nop 0
    buffer_load_dwordx4 v224, s[60:63], s4 offen lds
    v_mfma_f32_16x16x32_bf16 v[172:175], v[72:75], a[228:231], v[172:175]
    v_mfma_f32_16x16x32_bf16 v[176:179], v[72:75], a[232:235], v[176:179]
    s_add_u32 m0, s65, 142336
    s_nop 0
    buffer_load_dwordx4 v225, s[60:63], s4 offen lds
    v_mfma_f32_16x16x32_bf16 v[180:183], v[72:75], a[236:239], v[180:183]
    s_add_u32 m0, s65, 143360
    s_nop 0
    buffer_load_dwordx4 v226, s[60:63], s4 offen lds
    v_mfma_f32_16x16x32_bf16 v[184:187], v[76:79], a[228:231], v[184:187]
    v_mfma_f32_16x16x32_bf16 v[188:191], v[76:79], a[232:235], v[188:191]
    s_add_u32 m0, s65, 144384
    s_nop 0
    buffer_load_dwordx4 v227, s[60:63], s4 offen lds
    v_mfma_f32_16x16x32_bf16 v[192:195], v[76:79], a[236:239], v[192:195]
    s_add_u32 m0, s65, 145408
    s_nop 0
    buffer_load_dwordx4 v228, s[60:63], s4 offen lds
    v_mfma_f32_16x16x32_bf16 v[196:199], v[80:83], a[228:231], v[196:199]
    v_mfma_f32_16x16x32_bf16 v[200:203], v[80:83], a[232:235], v[200:203]
    s_add_u32 m0, s65, 146432
    s_nop 0
    buffer_load_dwordx4 v229, s[60:63], s4 offen lds
    v_mfma_f32_16x16x32_bf16 v[204:207], v[80:83], a[236:239], v[204:207]
    s_add_u32 m0, s65, 147456
    s_nop 0
    buffer_load_dwordx4 v230, s[60:63], s4 offen lds
    v_mfma_f32_16x16x32_bf16 v[208:211], v[84:87], a[228:231], v[208:211]
    s_add_u32 m0, s65, 148480
    s_nop 0
    buffer_load_dwordx4 v231, s[60:63], s4 offen lds
    v_mfma_f32_16x16x32_bf16 v[212:215], v[84:87], a[232:235], v[212:215]
    v_mfma_f32_16x16x32_bf16 v[216:219], v[84:87], a[236:239], v[216:219]
    s_add_u32 m0, s65, 149504
    s_nop 0
    buffer_load_dwordx4 v232, s[60:63], s4 offen lds
    s_add_u32 s47, s66, 2
    s_and_b32 s47, s47, 7
    s_mul_i32 s47, s47, 24576
    s_add_u32 s47, s47, s37
    buffer_load_dwordx4 a[24:27], v102, s[24:27], s47 offen offset:0 sc1
    buffer_load_dwordx4 a[28:31], v102, s[24:27], s47 offen offset:1024 sc1
    buffer_load_dwordx4 a[32:35], v102, s[24:27], s47 offen offset:2048 sc1
    s_add_u32 s47, s47, 6144
    buffer_load_dwordx4 a[36:39], v102, s[24:27], s47 offen offset:0 sc1
    buffer_load_dwordx4 a[40:43], v102, s[24:27], s47 offen offset:1024 sc1
    buffer_load_dwordx4 a[44:47], v102, s[24:27], s47 offen offset:2048 sc1
    s_add_u32 s47, s66, 4
    s_and_b32 s47, s47, 7
    s_mul_i32 s47, s47, 24576
    s_add_u32 s47, s47, s37
    buffer_load_dwordx4 a[48:51], v102, s[24:27], s47 offen offset:0 sc1
    buffer_load_dwordx4 a[52:55], v102, s[24:27], s47 offen offset:1024 sc1
    buffer_load_dwordx4 a[56:59], v102, s[24:27], s47 offen offset:2048 sc1
    s_add_u32 s47, s47, 6144
    buffer_load_dwordx4 a[60:63], v102, s[24:27], s47 offen offset:0 sc1
    buffer_load_dwordx4 a[64:67], v102, s[24:27], s47 offen offset:1024 sc1
    buffer_load_dwordx4 a[68:71], v102, s[24:27], s47 offen offset:2048 sc1
    s_add_u32 s47, s66, 6
    s_and_b32 s47, s47, 7
    s_mul_i32 s47, s47, 24576
    s_add_u32 s47, s47, s37
    buffer_load_dwordx4 a[72:75], v102, s[24:27], s47 offen offset:0 sc1
    buffer_load_dwordx4 a[76:79], v102, s[24:27], s47 offen offset:1024 sc1
    buffer_load_dwordx4 a[80:83], v102, s[24:27], s47 offen offset:2048 sc1
    s_add_u32 s47, s47, 6144
    buffer_load_dwordx4 a[84:87], v102, s[24:27], s47 offen offset:0 sc1
    buffer_load_dwordx4 a[88:91], v102, s[24:27], s47 offen offset:1024 sc1
    buffer_load_dwordx4 a[92:95], v102, s[24:27], s47 offen offset:2048 sc1
    s_waitcnt vmcnt(0)
    s_branch L_join
L_tailY:
    s_cmp_eq_u32 s45, 1
    s_cbranch_scc1 L_hadearly
    s_add_u32 s69, s71, 50331648
    v_and_b32 v13, 3, v1
    v_lshlrev_b32 v13, 10, v13
    v_and_b32 v14, 4, v1
    v_add_u32 v13, v13, v14
    buffer_load_dword v12, v13, s[24:27], s69 offen sc1
    s_mov_b32 s4, 0x100000
L_pollY:
    s_waitcnt vmcnt(0)
    v_cmp_ne_u32 vcc, s75, v12
    s_cbranch_vccz L_gotY
    s_sleep 1
    buffer_load_dword v12, v13, s[24:27], s69 offen sc1
    s_sub_u32 s4, s4, 1
    s_cmp_lg_u32 s4, 0
    s_cbranch_scc1 L_pollY
L_gotY:
    s_waitcnt vmcnt(0)
    s_add_u32 s47, s66, 2
    s_and_b32 s47, s47, 7
    s_mul_i32 s47, s47, 24576
    s_add_u32 s47, s47, s37
    buffer_load_dwordx4 a[24:27], v102, s[24:27], s47 offen offset:0 sc1
    buffer_load_dwordx4 a[28:31], v102, s[24:27], s47 offen offset:1024 sc1
    buffer_load_dwordx4 a[32:35], v102, s[24:27], s47 offen offset:2048 sc1
    s_add_u32 s47, s47, 6144
    buffer_load_dwordx4 a[36:39], v102, s[24:27], s47 offen offset:0 sc1
    buffer_load_dwordx4 a[40:43], v102, s[24:27], s47 offen offset:1024 sc1
    buffer_load_dwordx4 a[44:47], v102, s[24:27], s47 offen offset:2048 sc1
    s_add_u32 s47, s66, 4
    s_and_b32 s47, s47, 7
    s_mul_i32 s47, s47, 24576
    s_add_u32 s47, s47, s37
    buffer_load_dwordx4 a[48:51], v102, s[24:27], s47 offen offset:0 sc1
    buffer_load_dwordx4 a[52:55], v102, s[24:27], s47 offen offset:1024 sc1
    buffer_load_dwordx4 a[56:59], v102, s[24:27], s47 offen offset:2048 sc1
    s_add_u32 s47, s47, 6144
    buffer_load_dwordx4 a[60:63], v102, s[24:27], s47 offen offset:0 sc1
    buffer_load_dwordx4 a[64:67], v102, s[24:27], s47 offen offset:1024 sc1
    buffer_load_dwordx4 a[68:71], v102, s[24:27], s47 offen offset:2048 sc1
    s_add_u32 s47, s66, 6
    s_and_b32 s47, s47, 7
    s_mul_i32 s47, s47, 24576
    s_add_u32 s47, s47, s37
    buffer_load_dwordx4 a[72:75], v102, s[24:27], s47 offen offset:0 sc1
    buffer_load_dwordx4 a[76:79], v102, s[24:27], s47 offen offset:1024 sc1
    buffer_load_dwordx4 a[80:83], v102, s[24:27], s47 offen offset:2048 sc1
    s_add_u32 s47, s47, 6144
    buffer_load_dwordx4 a[84:87], v102, s[24:27], s47 offen offset:0 sc1
    buffer_load_dwordx4 a[88:91], v102, s[24:27], s47 offen offset:1024 sc1
    buffer_load_dwordx4 a[92:95], v102, s[24:27], s47 offen offset:2048 sc1
L_hadearly:
    s_waitcnt lgkmcnt(0)
L_join:
    s_add_u32 s71, s71, 8
    v_add_u32 v220, 86016, v104
    v_add_u32 v221, 49152, v104
    s_mul_i32 s3, s7, -8192
    s_add_u32 s3, s3, 57344
    v_add_u32 v2, s3, v102
    v_mov_b32 v15, s75
    s_barrier
    ds_read_b64_tr_b16 v[16:17], v104 offset:0
    ds_read_b64_tr_b16 v[18:19], v104 offset:2304
    ds_read_b64_tr_b16 v[20:21], v104 offset:32
    ds_read_b64_tr_b16 v[22:23], v104 offset:2336
    ds_read_b64_tr_b16 v[24:25], v104 offset:64
    ds_read_b64_tr_b16 v[26:27], v104 offset:2368
    ds_read_b64_tr_b16 v[28:29], v104 offset:96
    ds_read_b64_tr_b16 v[30:31], v104 offset:2400
    ds_read_b64_tr_b16 v[32:33], v104 offset:128
    ds_read_b64_tr_b16 v[34:35], v104 offset:2432
    ds_read_b64_tr_b16 v[36:37], v104 offset:160
    ds_read_b64_tr_b16 v[38:39], v104 offset:2464
    ds_read_b64_tr_b16 v[40:41], v104 offset:192
    ds_read_b64_tr_b16 v[42:43], v104 offset:2496
    ds_read_b64_tr_b16 v[44:45], v104 offset:224
    ds_read_b64_tr_b16 v[46:47], v104 offset:2528
    ds_read_b64_tr_b16 v[48:49], v104 offset:256
    ds_read_b64_tr_b16 v[50:51], v104 offset:2560
    s_cmp_eq_u32 s6, 1
    s_cbranch_scc1 L_own1
    ds_read_b128 a[96:99], v2 offset:0
    ds_read_b128 a[100:103], v2 offset:1024
    ds_read_b128 a[104:107], v2 offset:2048
    ds_read_b128 a[108:111], v2 offset:6144
    ds_read_b128 a[112:115], v2 offset:7168
    ds_read_b128 a[116:119], v2 offset:16384
    s_branch L_own2
L_own1:
    ds_read_b128 a[96:99], v2 offset:3072
    ds_read_b128 a[100:103], v2 offset:4096
    ds_read_b128 a[104:107], v2 offset:5120
    ds_read_b128 a[108:111], v2 offset:17408
    ds_read_b128 a[112:115], v2 offset:18432
    ds_read_b128 a[116:119], v2 offset:19456
L_own2:
    s_waitcnt vmcnt(12)
    s_cmp_eq_u32 s7, 1
    s_cbranch_scc1 L_fy
    s_waitcnt lgkmcnt(0)
    v_mfma_f32_16x16x32_bf16 v[112:115], v[16:19], a[24:27], v[112:115]
    ds_read_b64_tr_b16 v[52:53], v104 offset:9216
    v_mfma_f32_16x16x32_bf16 v[116:119], v[16:19], a[28:31], v[116:119]
    ds_read_b64_tr_b16 v[54:55], v104 offset:11520
    v_mfma_f32_16x16x32_bf16 v[120:123], v[16:19], a[32:35], v[120:123]
    ds_read_b64_tr_b16 v[56:57], v104 offset:9248
    v_mfma_f32_16x16x32_bf16 v[124:127], v[20:23], a[24:27], v[124:127]
    ds_read_b64_tr_b16 v[58:59], v104 offset:11552
    v_mfma_f32_16x16x32_bf16 v[128:131], v[20:23], a[28:31], v[128:131]
    v_mfma_f32_16x16x32_bf16 v[132:135], v[20:23], a[32:35], v[132:135]
    ds_read_b64_tr_b16 v[60:61], v104 offset:9280
    v_mfma_f32_16x16x32_bf16 v[136:139], v[24:27], a[24:27], v[136:139]
    ds_read_b64_tr_b16 v[62:63], v104 offset:11584
    v_mfma_f32_16x16x32_bf16 v[140:143], v[24:27], a[28:31], v[140:143]
    ds_read_b64_tr_b16 v[64:65], v104 offset:9312
    v_mfma_f32_16x16x32_bf16 v[144:147], v[24:27], a[32:35], v[144:147]
    ds_read_b64_tr_b16 v[66:67], v104 offset:11616
    v_mfma_f32_16x16x32_bf16 v[148:151], v[28:31], a[24:27], v[148:151]
    ds_read_b64_tr_b16 v[68:69], v104 offset:9344
    v_mfma_f32_16x16x32_bf16 v[152:155], v[28:31], a[28:31], v[152:155]
    ds_read_b64_tr_b16 v[70:71], v104 offset:11648
    v_mfma_f32_16x16x32_bf16 v[156:159], v[28:31], a[32:35], v[156:159]
    ds_read_b64_tr_b16 v[72:73], v104 offset:9376
    v_mfma_f32_16x16x32_bf16 v[160:163], v[32:35], a[24:27], v[160:163]
    ds_read_b64_tr_b16 v[74:75], v104 offset:11680
    v_mfma_f32_16x16x32_bf16 v[164:167], v[32:35], a[28:31], v[164:167]
    ds_read_b64_tr_b16 v[76:77], v104 offset:9408
    v_mfma_f32_16x16x32_bf16 v[168:171], v[32:35], a[32:35], v[168:171]
    v_mfma_f32_16x16x32_bf16 v[172:175], v[36:39], a[24:27], v[172:175]
    ds_read_b64_tr_b16 v[78:79], v104 offset:11712
    v_mfma_f32_16x16x32_bf16 v[176:179], v[36:39], a[28:31], v[176:179]
    ds_read_b64_tr_b16 v[80:81], v104 offset:9440
    v_mfma_f32_16x16x32_bf16 v[180:183], v[36:39], a[32:35], v[180:183]
    ds_read_b64_tr_b16 v[82:83], v104 offset:11744
    v_mfma_f32_16x16x32_bf16 v[184:187], v[40:43], a[24:27], v[184:187]
    ds_read_b64_tr_b16 v[84:85], v104 offset:9472
    v_mfma_f32_16x16x32_bf16 v[188:191], v[40:43], a[28:31], v[188:191]
    ds_read_b64_tr_b16 v[86:87], v104 offset:11776
    v_mfma_f32_16x16x32_bf16 v[192:195], v[40:43], a[32:35], v[192:195]
    v_mfma_f32_16x16x32_bf16 v[196:199], v[44:47], a[24:27], v[196:199]
    v_mfma_f32_16x16x32_bf16 v[200:203], v[44:47], a[28:31], v[200:203]
    v_mfma_f32_16x16x32_bf16 v[204:207], v[44:47], a[32:35], v[204:207]
    v_mfma_f32_16x16x32_bf16 v[208:211], v[48:51], a[24:27], v[208:211]
    v_mfma_f32_16x16x32_bf16 v[212:215], v[48:51], a[28:31], v[212:215]
    v_mfma_f32_16x16x32_bf16 v[216:219], v[48:51], a[32:35], v[216:219]
    s_branch L_fx
L_fy:
    s_waitcnt lgkmcnt(0)
    v_mfma_f32_16x16x32_bf16 v[112:115], v[16:19], a[24:27], 0
    ds_read_b64_tr_b16 v[52:53], v104 offset:9216
    v_mfma_f32_16x16x32_bf16 v[116:119], v[16:19], a[28:31], 0
    ds_read_b64_tr_b16 v[54:55], v104 offset:11520
    v_mfma_f32_16x16x32_bf16 v[120:123], v[16:19], a[32:35], 0
    ds_read_b64_tr_b16 v[56:57], v104 offset:9248
    v_mfma_f32_16x16x32_bf16 v[124:127], v[20:23], a[24:27], 0
    ds_read_b64_tr_b16 v[58:59], v104 offset:11552
    v_mfma_f32_16x16x32_bf16 v[128:131], v[20:23], a[28:31], 0
    v_mfma_f32_16x16x32_bf16 v[132:135], v[20:23], a[32:35], 0
    ds_read_b64_tr_b16 v[60:61], v104 offset:9280
    v_mfma_f32_16x16x32_bf16 v[136:139], v[24:27], a[24:27], 0
    ds_read_b64_tr_b16 v[62:63], v104 offset:11584
    v_mfma_f32_16x16x32_bf16 v[140:143], v[24:27], a[28:31], 0
    ds_read_b64_tr_b16 v[64:65], v104 offset:9312
    v_mfma_f32_16x16x32_bf16 v[144:147], v[24:27], a[32:35], 0
    ds_read_b64_tr_b16 v[66:67], v104 offset:11616
    v_mfma_f32_16x16x32_bf16 v[148:151], v[28:31], a[24:27], 0
    ds_read_b64_tr_b16 v[68:69], v104 offset:9344
    v_mfma_f32_16x16x32_bf16 v[152:155], v[28:31], a[28:31], 0
    ds_read_b64_tr_b16 v[70:71], v104 offset:11648
    v_mfma_f32_16x16x32_bf16 v[156:159], v[28:31], a[32:35], 0
    ds_read_b64_tr_b16 v[72:73], v104 offset:9376
    v_mfma_f32_16x16x32_bf16 v[160:163], v[32:35], a[24:27], 0
    ds_read_b64_tr_b16 v[74:75], v104 offset:11680
    v_mfma_f32_16x16x32_bf16 v[164:167], v[32:35], a[28:31], 0
    ds_read_b64_tr_b16 v[76:77], v104 offset:9408
    v_mfma_f32_16x16x32_bf16 v[168:171], v[32:35], a[32:35], 0
    v_mfma_f32_16x16x32_bf16 v[172:175], v[36:39], a[24:27], 0
    ds_read_b64_tr_b16 v[78:79], v104 offset:11712
    v_mfma_f32_16x16x32_bf16 v[176:179], v[36:39], a[28:31], 0
    ds_read_b64_tr_b16 v[80:81], v104 offset:9440
    v_mfma_f32_16x16x32_bf16 v[180:183], v[36:39], a[32:35], 0
    ds_read_b64_tr_b16 v[82:83], v104 offset:11744
    v_mfma_f32_16x16x32_bf16 v[184:187], v[40:43], a[24:27], 0
    ds_read_b64_tr_b16 v[84:85], v104 offset:9472
    v_mfma_f32_16x16x32_bf16 v[188:191], v[40:43], a[28:31], 0
    ds_read_b64_tr_b16 v[86:87], v104 offset:11776
    v_mfma_f32_16x16x32_bf16 v[192:195], v[40:43], a[32:35], 0
    v_mfma_f32_16x16x32_bf16 v[196:199], v[44:47], a[24:27], 0
    v_mfma_f32_16x16x32_bf16 v[200:203], v[44:47], a[28:31], 0
    v_mfma_f32_16x16x32_bf16 v[204:207], v[44:47], a[32:35], 0
    v_mfma_f32_16x16x32_bf16 v[208:211], v[48:51], a[24:27], 0
    v_mfma_f32_16x16x32_bf16 v[212:215], v[48:51], a[28:31], 0
    v_mfma_f32_16x16x32_bf16 v[216:219], v[48:51], a[32:35], 0
    s_waitcnt vmcnt(0)
    buffer_store_dword v15, v108, s[24:27], s70 offen sc1
L_fx:
    s_waitcnt lgkmcnt(0)
    s_barrier
    s_waitcnt lgkmcnt(0)
    v_mfma_f32_16x16x32_bf16 v[112:115], v[52:55], a[36:39], v[112:115]
    ds_read_b64_tr_b16 v[16:17], v103 offset:0
    v_mfma_f32_16x16x32_bf16 v[116:119], v[52:55], a[40:43], v[116:119]
    ds_read_b64_tr_b16 v[18:19], v103 offset:2304
    v_mfma_f32_16x16x32_bf16 v[120:123], v[52:55], a[44:47], v[120:123]
    ds_read_b64_tr_b16 v[20:21], v103 offset:32
    s_add_u32 s4, s66, 6
    s_and_b32 s4, s4, 7
    s_mul_i32 s4, s4, 147456
    s_add_u32 s4, s4, s68
    s_add_u32 s4, s4, 0
    s_add_u32 m0, s65, 86016
    s_nop 0
    buffer_load_dwordx4 v93, s[60:63], s4 offen lds
    v_mfma_f32_16x16x32_bf16 v[124:127], v[56:59], a[36:39], v[124:127]
    ds_read_b64_tr_b16 v[22:23], v103 offset:2336
    v_mfma_f32_16x16x32_bf16 v[128:131], v[56:59], a[40:43], v[128:131]
    v_mfma_f32_16x16x32_bf16 v[132:135], v[56:59], a[44:47], v[132:135]
    ds_read_b64_tr_b16 v[24:25], v103 offset:64
    v_mfma_f32_16x16x32_bf16 v[136:139], v[60:63], a[36:39], v[136:139]
    ds_read_b64_tr_b16 v[26:27], v103 offset:2368
    s_add_u32 m0, s65, 87040
    s_nop 0
    buffer_load_dwordx4 v94, s[60:63], s4 offen lds
    v_mfma_f32_16x16x32_bf16 v[140:143], v[60:63], a[40:43], v[140:143]
    ds_read_b64_tr_b16 v[28:29], v103 offset:96
    v_mfma_f32_16x16x32_bf16 v[144:147], v[60:63], a[44:47], v[144:147]
    ds_read_b64_tr_b16 v[30:31], v103 offset:2400
    s_add_u32 m0, s65, 88064
    s_nop 0
    buffer_load_dwordx4 v95, s[60:63], s4 offen lds
    v_mfma_f32_16x16x32_bf16 v[148:151], v[64:67], a[36:39], v[148:151]
    ds_read_b64_tr_b16 v[32:33], v103 offset:128
    v_mfma_f32_16x16x32_bf16 v[152:155], v[64:67], a[40:43], v[152:155]
    ds_read_b64_tr_b16 v[34:35], v103 offset:2432
    v_mfma_f32_16x16x32_bf16 v[156:159], v[64:67], a[44:47], v[156:159]
    ds_read_b64_tr_b16 v[36:37], v103 offset:160
    s_add_u32 m0, s65, 89088
    s_nop 0
    buffer_load_dwordx4 v96, s[60:63], s4 offen lds
    v_mfma_f32_16x16x32_bf16 v[160:163], v[68:71], a[36:39], v[160:163]
    ds_read_b64_tr_b16 v[38:39], v103 offset:2464
    v_mfma_f32_16x16x32_bf16 v[164:167], v[68:71], a[40:43], v[164:167]
    ds_read_b64_tr_b16 v[40:41], v103 offset:192
    v_mfma_f32_16x16x32_bf16 v[168:171], v[68:71], a[44:47], v[168:171]
    s_add_u32 m0, s65, 90112
    s_nop 0
    buffer_load_dwordx4 v97, s[60:63], s4 offen lds
    v_mfma_f32_16x16x32_bf16 v[172:175], v[72:75], a[36:39], v[172:175]
    ds_read_b64_tr_b16 v[42:43], v103 offset:2496
    v_mfma_f32_16x16x32_bf16 v[176:179], v[72:75], a[40:43], v[176:179]
    ds_read_b64_tr_b16 v[44:45], v103 offset:224
    v_mfma_f32_16x16x32_bf16 v[180:183], v[72:75], a[44:47], v[180:183]
    ds_read_b64_tr_b16 v[46:47], v103 offset:2528
    s_add_u32 m0, s65, 91136
    s_nop 0
    buffer_load_dwordx4 v98, s[60:63], s4 offen lds
    v_mfma_f32_16x16x32_bf16 v[184:187], v[76:79], a[36:39], v[184:187]
    ds_read_b64_tr_b16 v[48:49], v103 offset:256
    v_mfma_f32_16x16x32_bf16 v[188:191], v[76:79], a[40:43], v[188:191]
    ds_read_b64_tr_b16 v[50:51], v103 offset:2560
    v_mfma_f32_16x16x32_bf16 v[192:195], v[76:79], a[44:47], v[192:195]
    s_add_u32 m0, s65, 92160
    s_nop 0
    buffer_load_dwordx4 v99, s[60:63], s4 offen lds
    v_mfma_f32_16x16x32_bf16 v[196:199], v[80:83], a[36:39], v[196:199]
    v_mfma_f32_16x16x32_bf16 v[200:203], v[80:83], a[40:43], v[200:203]
    s_add_u32 m0, s65, 93184
    s_nop 0
    buffer_load_dwordx4 v100, s[60:63], s4 offen lds
    v_mfma_f32_16x16x32_bf16 v[204:207], v[80:83], a[44:47], v[204:207]
    v_mfma_f32_16x16x32_bf16 v[208:211], v[84:87], a[36:39], v[208:211]
    v_mfma_f32_16x16x32_bf16 v[212:215], v[84:87], a[40:43], v[212:215]
    s_add_u32 m0, s65, 94208
    s_nop 0
    buffer_load_dwordx4 v101, s[60:63], s4 offen lds
    v_mfma_f32_16x16x32_bf16 v[216:219], v[84:87], a[44:47], v[216:219]
    s_waitcnt lgkmcnt(0)
    v_mfma_f32_16x16x32_bf16 v[112:115], v[16:19], a[48:51], v[112:115]
    ds_read_b64_tr_b16 v[52:53], v103 offset:9216
    v_mfma_f32_16x16x32_bf16 v[116:119], v[16:19], a[52:55], v[116:119]
    ds_read_b64_tr_b16 v[54:55], v103 offset:11520
    v_mfma_f32_16x16x32_bf16 v[120:123], v[16:19], a[56:59], v[120:123]
    ds_read_b64_tr_b16 v[56:57], v103 offset:9248
    s_add_u32 s4, s66, 1
    s_and_b32 s4, s4, 7
    s_mul_i32 s4, s4, 147456
    s_add_u32 s4, s4, s68
    s_add_u32 s4, s4, 0
    s_add_u32 m0, s65, 49152
    s_nop 0
    buffer_load_dwordx4 v93, s[60:63], s4 offen lds
    v_mfma_f32_16x16x32_bf16 v[124:127], v[20:23], a[48:51], v[124:127]
    ds_read_b64_tr_b16 v[58:59], v103 offset:11552
    v_mfma_f32_16x16x32_bf16 v[128:131], v[20:23], a[52:55], v[128:131]
    v_mfma_f32_16x16x32_bf16 v[132:135], v[20:23], a[56:59], v[132:135]
    ds_read_b64_tr_b16 v[60:61], v103 offset:9280
    v_mfma_f32_16x16x32_bf16 v[136:139], v[24:27], a[48:51], v[136:139]
    ds_read_b64_tr_b16 v[62:63], v103 offset:11584
    s_add_u32 m0, s65, 50176
    s_nop 0
    buffer_load_dwordx4 v94, s[60:63], s4 offen lds
    v_mfma_f32_16x16x32_bf16 v[140:143], v[24:27], a[52:55], v[140:143]
    ds_read_b64_tr_b16 v[64:65], v103 offset:9312
    v_mfma_f32_16x16x32_bf16 v[144:147], v[24:27], a[56:59], v[144:147]
    ds_read_b64_tr_b16 v[66:67], v103 offset:11616
    s_add_u32 m0, s65, 51200
    s_nop 0
    buffer_load_dwordx4 v95, s[60:63], s4 offen lds
    v_mfma_f32_16x16x32_bf16 v[148:151], v[28:31], a[48:51], v[148:151]
    ds_read_b64_tr_b16 v[68:69], v103 offset:9344
    v_mfma_f32_16x16x32_bf16 v[152:155], v[28:31], a[52:55], v[152:155]
    ds_read_b64_tr_b16 v[70:71], v103 offset:11648
    v_mfma_f32_16x16x32_bf16 v[156:159], v[28:31], a[56:59], v[156:159]
    ds_read_b64_tr_b16 v[72:73], v103 offset:9376
    s_add_u32 m0, s65, 52224
    s_nop 0
    buffer_load_dwordx4 v96, s[60:63], s4 offen lds
    v_mfma_f32_16x16x32_bf16 v[160:163], v[32:35], a[48:51], v[160:163]
    ds_read_b64_tr_b16 v[74:75], v103 offset:11680
    v_mfma_f32_16x16x32_bf16 v[164:167], v[32:35], a[52:55], v[164:167]
    ds_read_b64_tr_b16 v[76:77], v103 offset:9408
    v_mfma_f32_16x16x32_bf16 v[168:171], v[32:35], a[56:59], v[168:171]
    s_add_u32 m0, s65, 53248
    s_nop 0
    buffer_load_dwordx4 v97, s[60:63], s4 offen lds
    v_mfma_f32_16x16x32_bf16 v[172:175], v[36:39], a[48:51], v[172:175]
    ds_read_b64_tr_b16 v[78:79], v103 offset:11712
    v_mfma_f32_16x16x32_bf16 v[176:179], v[36:39], a[52:55], v[176:179]
    ds_read_b64_tr_b16 v[80:81], v103 offset:9440
    v_mfma_f32_16x16x32_bf16 v[180:183], v[36:39], a[56:59], v[180:183]
    ds_read_b64_tr_b16 v[82:83], v103 offset:11744
    s_add_u32 m0, s65, 54272
    s_nop 0
    buffer_load_dwordx4 v98, s[60:63], s4 offen lds
    v_mfma_f32_16x16x32_bf16 v[184:187], v[40:43], a[48:51], v[184:187]
    ds_read_b64_tr_b16 v[84:85], v103 offset:9472
    v_mfma_f32_16x16x32_bf16 v[188:191], v[40:43], a[52:55], v[188:191]
    ds_read_b64_tr_b16 v[86:87], v103 offset:11776
    v_mfma_f32_16x16x32_bf16 v[192:195], v[40:43], a[56:59], v[192:195]
    s_add_u32 m0, s65, 55296
    s_nop 0
    buffer_load_dwordx4 v99, s[60:63], s4 offen lds
    v_mfma_f32_16x16x32_bf16 v[196:199], v[44:47], a[48:51], v[196:199]
    v_mfma_f32_16x16x32_bf16 v[200:203], v[44:47], a[52:55], v[200:203]
    s_add_u32 m0, s65, 56320
    s_nop 0
    buffer_load_dwordx4 v100, s[60:63], s4 offen lds
    v_mfma_f32_16x16x32_bf16 v[204:207], v[44:47], a[56:59], v[204:207]
    v_mfma_f32_16x16x32_bf16 v[208:211], v[48:51], a[48:51], v[208:211]
    v_mfma_f32_16x16x32_bf16 v[212:215], v[48:51], a[52:55], v[212:215]
    s_add_u32 m0, s65, 57344
    s_nop 0
    buffer_load_dwordx4 v101, s[60:63], s4 offen lds
    v_mfma_f32_16x16x32_bf16 v[216:219], v[48:51], a[56:59], v[216:219]
    s_waitcnt vmcnt(9) lgkmcnt(0)
    s_barrier
    s_waitcnt lgkmcnt(0)
    v_mfma_f32_16x16x32_bf16 v[112:115], v[52:55], a[60:63], v[112:115]
    ds_read_b64_tr_b16 v[16:17], v220 offset:0
    v_mfma_f32_16x16x32_bf16 v[116:119], v[52:55], a[64:67], v[116:119]
    ds_read_b64_tr_b16 v[18:19], v220 offset:2304
    v_mfma_f32_16x16x32_bf16 v[120:123], v[52:55], a[68:71], v[120:123]
    ds_read_b64_tr_b16 v[20:21], v220 offset:32
    s_add_u32 s4, s66, 3
    s_and_b32 s4, s4, 7
    s_mul_i32 s4, s4, 147456
    s_add_u32 s4, s4, s68
    s_add_u32 s4, s4, 0
    s_add_u32 m0, s65, 0
    s_nop 0
    buffer_load_dwordx4 v93, s[60:63], s4 offen lds
    v_mfma_f32_16x16x32_bf16 v[124:127], v[56:59], a[60:63], v[124:127]
    ds_read_b64_tr_b16 v[22:23], v220 offset:2336
    v_mfma_f32_16x16x32_bf16 v[128:131], v[56:59], a[64:67], v[128:131]
    v_mfma_f32_16x16x32_bf16 v[132:135], v[56:59], a[68:71], v[132:135]
    ds_read_b64_tr_b16 v[24:25], v220 offset:64
    v_mfma_f32_16x16x32_bf16 v[136:139], v[60:63], a[60:63], v[136:139]
    ds_read_b64_tr_b16 v[26:27], v220 offset:2368
    s_add_u32 m0, s65, 1024
    s_nop 0
    buffer_load_dwordx4 v94, s[60:63], s4 offen lds
    v_mfma_f32_16x16x32_bf16 v[140:143], v[60:63], a[64:67], v[140:143]
    ds_read_b64_tr_b16 v[28:29], v220 offset:96
    v_mfma_f32_16x16x32_bf16 v[144:147], v[60:63], a[68:71], v[144:147]
    ds_read_b64_tr_b16 v[30:31], v220 offset:2400
    s_add_u32 m0, s65, 2048
    s_nop 0
    buffer_load_dwordx4 v95, s[60:63], s4 offen lds
    v_mfma_f32_16x16x32_bf16 v[148:151], v[64:67], a[60:63], v[148:151]
    ds_read_b64_tr_b16 v[32:33], v220 offset:128
    v_mfma_f32_16x16x32_bf16 v[152:155], v[64:67], a[64:67], v[152:155]
    ds_read_b64_tr_b16 v[34:35], v220 offset:2432
    v_mfma_f32_16x16x32_bf16 v[156:159], v[64:67], a[68:71], v[156:159]
    ds_read_b64_tr_b16 v[36:37], v220 offset:160
    s_add_u32 m0, s65, 3072
    s_nop 0
    buffer_load_dwordx4 v96, s[60:63], s4 offen lds
    v_mfma_f32_16x16x32_bf16 v[160:163], v[68:71], a[60:63], v[160:163]
    ds_read_b64_tr_b16 v[38:39], v220 offset:2464
    v_mfma_f32_16x16x32_bf16 v[164:167], v[68:71], a[64:67], v[164:167]
    ds_read_b64_tr_b16 v[40:41], v220 offset:192
    v_mfma_f32_16x16x32_bf16 v[168:171], v[68:71], a[68:71], v[168:171]
    s_add_u32 m0, s65, 4096
    s_nop 0
    buffer_load_dwordx4 v97, s[60:63], s4 offen lds
    v_mfma_f32_16x16x32_bf16 v[172:175], v[72:75], a[60:63], v[172:175]
    ds_read_b64_tr_b16 v[42:43], v220 offset:2496
    v_mfma_f32_16x16x32_bf16 v[176:179], v[72:75], a[64:67], v[176:179]
    ds_read_b64_tr_b16 v[44:45], v220 offset:224
    v_mfma_f32_16x16x32_bf16 v[180:183], v[72:75], a[68:71], v[180:183]
    ds_read_b64_tr_b16 v[46:47], v220 offset:2528
    s_add_u32 m0, s65, 5120
    s_nop 0
    buffer_load_dwordx4 v98, s[60:63], s4 offen lds
    v_mfma_f32_16x16x32_bf16 v[184:187], v[76:79], a[60:63], v[184:187]
    ds_read_b64_tr_b16 v[48:49], v220 offset:256
    v_mfma_f32_16x16x32_bf16 v[188:191], v[76:79], a[64:67], v[188:191]
    ds_read_b64_tr_b16 v[50:51], v220 offset:2560
    v_mfma_f32_16x16x32_bf16 v[192:195], v[76:79], a[68:71], v[192:195]
    s_add_u32 m0, s65, 6144
    s_nop 0
    buffer_load_dwordx4 v99, s[60:63], s4 offen lds
    v_mfma_f32_16x16x32_bf16 v[196:199], v[80:83], a[60:63], v[196:199]
    v_mfma_f32_16x16x32_bf16 v[200:203], v[80:83], a[64:67], v[200:203]
    s_add_u32 m0, s65, 7168
    s_nop 0
    buffer_load_dwordx4 v100, s[60:63], s4 offen lds
    v_mfma_f32_16x16x32_bf16 v[204:207], v[80:83], a[68:71], v[204:207]
    v_mfma_f32_16x16x32_bf16 v[208:211], v[84:87], a[60:63], v[208:211]
    v_mfma_f32_16x16x32_bf16 v[212:215], v[84:87], a[64:67], v[212:215]
    s_add_u32 m0, s65, 8192
    s_nop 0
    buffer_load_dwordx4 v101, s[60:63], s4 offen lds
    v_mfma_f32_16x16x32_bf16 v[216:219], v[84:87], a[68:71], v[216:219]
    s_add_u32 s69, s71, 50331648
    v_and_b32 v13, 3, v1
    v_lshlrev_b32 v13, 10, v13
    v_and_b32 v14, 4, v1
    v_add_u32 v13, v13, v14
    buffer_load_dword v12, v13, s[24:27], s69 offen sc1
    s_waitcnt lgkmcnt(0)
    v_mfma_f32_16x16x32_bf16 v[112:115], v[16:19], a[72:75], v[112:115]
    ds_read_b64_tr_b16 v[52:53], v220 offset:9216
    v_mfma_f32_16x16x32_bf16 v[116:119], v[16:19], a[76:79], v[116:119]
    ds_read_b64_tr_b16 v[54:55], v220 offset:11520
    v_mfma_f32_16x16x32_bf16 v[120:123], v[16:19], a[80:83], v[120:123]
    ds_read_b64_tr_b16 v[56:57], v220 offset:9248
    v_mfma_f32_16x16x32_bf16 v[124:127], v[20:23], a[72:75], v[124:127]
    ds_read_b64_tr_b16 v[58:59], v220 offset:11552
    v_mfma_f32_16x16x32_bf16 v[128:131], v[20:23], a[76:79], v[128:131]
    v_mfma_f32_16x16x32_bf16 v[132:135], v[20:23], a[80:83], v[132:135]
    ds_read_b64_tr_b16 v[60:61], v220 offset:9280
    v_mfma_f32_16x16x32_bf16 v[136:139], v[24:27], a[72:75], v[136:139]
    ds_read_b64_tr_b16 v[62:63], v220 offset:11584
    v_mfma_f32_16x16x32_bf16 v[140:143], v[24:27], a[76:79], v[140:143]
    ds_read_b64_tr_b16 v[64:65], v220 offset:9312
    v_mfma_f32_16x16x32_bf16 v[144:147], v[24:27], a[80:83], v[144:147]
    ds_read_b64_tr_b16 v[66:67], v220 offset:11616
    v_mfma_f32_16x16x32_bf16 v[148:151], v[28:31], a[72:75], v[148:151]
    ds_read_b64_tr_b16 v[68:69], v220 offset:9344
    v_mfma_f32_16x16x32_bf16 v[152:155], v[28:31], a[76:79], v[152:155]
    ds_read_b64_tr_b16 v[70:71], v220 offset:11648
    v_mfma_f32_16x16x32_bf16 v[156:159], v[28:31], a[80:83], v[156:159]
    ds_read_b64_tr_b16 v[72:73], v220 offset:9376
    v_mfma_f32_16x16x32_bf16 v[160:163], v[32:35], a[72:75], v[160:163]
    ds_read_b64_tr_b16 v[74:75], v220 offset:11680
    v_mfma_f32_16x16x32_bf16 v[164:167], v[32:35], a[76:79], v[164:167]
    ds_read_b64_tr_b16 v[76:77], v220 offset:9408
    v_mfma_f32_16x16x32_bf16 v[168:171], v[32:35], a[80:83], v[168:171]
    v_mfma_f32_16x16x32_bf16 v[172:175], v[36:39], a[72:75], v[172:175]
    ds_read_b64_tr_b16 v[78:79], v220 offset:11712
    v_mfma_f32_16x16x32_bf16 v[176:179], v[36:39], a[76:79], v[176:179]
    ds_read_b64_tr_b16 v[80:81], v220 offset:9440
    v_mfma_f32_16x16x32_bf16 v[180:183], v[36:39], a[80:83], v[180:183]
    ds_read_b64_tr_b16 v[82:83], v220 offset:11744
    v_mfma_f32_16x16x32_bf16 v[184:187], v[40:43], a[72:75], v[184:187]
    ds_read_b64_tr_b16 v[84:85], v220 offset:9472
    v_mfma_f32_16x16x32_bf16 v[188:191], v[40:43], a[76:79], v[188:191]
    ds_read_b64_tr_b16 v[86:87], v220 offset:11776
    v_mfma_f32_16x16x32_bf16 v[192:195], v[40:43], a[80:83], v[192:195]
    v_mfma_f32_16x16x32_bf16 v[196:199], v[44:47], a[72:75], v[196:199]
    v_mfma_f32_16x16x32_bf16 v[200:203], v[44:47], a[76:79], v[200:203]
    v_mfma_f32_16x16x32_bf16 v[204:207], v[44:47], a[80:83], v[204:207]
    v_mfma_f32_16x16x32_bf16 v[208:211], v[48:51], a[72:75], v[208:211]
    v_mfma_f32_16x16x32_bf16 v[212:215], v[48:51], a[76:79], v[212:215]
    v_mfma_f32_16x16x32_bf16 v[216:219], v[48:51], a[80:83], v[216:219]
    s_mov_b32 s4, 0x100000
L_pollB:
    s_waitcnt vmcnt(0)
    v_cmp_ne_u32 vcc, s75, v12
    s_cbranch_vccz L_gotB
    s_sleep 1
    buffer_load_dword v12, v13, s[24:27], s69 offen sc1
    s_sub_u32 s4, s4, 1
    s_cmp_lg_u32 s4, 0
    s_cbranch_scc1 L_pollB
L_gotB:
    s_waitcnt vmcnt(0)
    s_waitcnt lgkmcnt(0)
    s_barrier
    s_waitcnt lgkmcnt(0)
    v_mfma_f32_16x16x32_bf16 v[112:115], v[52:55], a[84:87], v[112:115]
    ds_read_b64_tr_b16 v[16:17], v221 offset:0
    v_mfma_f32_16x16x32_bf16 v[116:119], v[52:55], a[88:91], v[116:119]
    ds_read_b64_tr_b16 v[18:19], v221 offset:2304
    v_mfma_f32_16x16x32_bf16 v[120:123], v[52:55], a[92:95], v[120:123]
    ds_read_b64_tr_b16 v[20:21], v221 offset:32
    s_add_u32 s47, s66, 3
    s_and_b32 s47, s47, 7
    s_mul_i32 s47, s47, 24576
    s_add_u32 s47, s47, s37
    buffer_load_dwordx4 a[120:123], v102, s[24:27], s47 offen offset:0 sc1
    v_mfma_f32_16x16x32_bf16 v[124:127], v[56:59], a[84:87], v[124:127]
    ds_read_b64_tr_b16 v[22:23], v221 offset:2336
    v_mfma_f32_16x16x32_bf16 v[128:131], v[56:59], a[88:91], v[128:131]
    v_mfma_f32_16x16x32_bf16 v[132:135], v[56:59], a[92:95], v[132:135]
    ds_read_b64_tr_b16 v[24:25], v221 offset:64
    buffer_load_dwordx4 a[124:127], v102, s[24:27], s47 offen offset:1024 sc1
    v_mfma_f32_16x16x32_bf16 v[136:139], v[60:63], a[84:87], v[136:139]
    ds_read_b64_tr_b16 v[26:27], v221 offset:2368
    v_mfma_f32_16x16x32_bf16 v[140:143], v[60:63], a[88:91], v[140:143]
    ds_read_b64_tr_b16 v[28:29], v221 offset:96
    v_mfma_f32_16x16x32_bf16 v[144:147], v[60:63], a[92:95], v[144:147]
    ds_read_b64_tr_b16 v[30:31], v221 offset:2400
    buffer_load_dwordx4 a[128:131], v102, s[24:27], s47 offen offset:2048 sc1
    v_mfma_f32_16x16x32_bf16 v[148:151], v[64:67], a[84:87], v[148:151]
    ds_read_b64_tr_b16 v[32:33], v221 offset:128
    v_mfma_f32_16x16x32_bf16 v[152:155], v[64:67], a[88:91], v[152:155]
    ds_read_b64_tr_b16 v[34:35], v221 offset:2432
    s_add_u32 s47, s47, 6144
    buffer_load_dwordx4 a[132:135], v102, s[24:27], s47 offen offset:0 sc1
    v_mfma_f32_16x16x32_bf16 v[156:159], v[64:67], a[92:95], v[156:159]
    ds_read_b64_tr_b16 v[36:37], v221 offset:160
    v_mfma_f32_16x16x32_bf16 v[160:163], v[68:71], a[84:87], v[160:163]
    ds_read_b64_tr_b16 v[38:39], v221 offset:2464
    v_mfma_f32_16x16x32_bf16 v[164:167], v[68:71], a[88:91], v[164:167]
    ds_read_b64_tr_b16 v[40:41], v221 offset:192
    buffer_load_dwordx4 a[136:139], v102, s[24:27], s47 offen offset:1024 sc1
    v_mfma_f32_16x16x32_bf16 v[168:171], v[68:71], a[92:95], v[168:171]
    v_mfma_f32_16x16x32_bf16 v[172:175], v[72:75], a[84:87], v[172:175]
    ds_read_b64_tr_b16 v[42:43], v221 offset:2496
    v_mfma_f32_16x16x32_bf16 v[176:179], v[72:75], a[88:91], v[176:179]
    ds_read_b64_tr_b16 v[44:45], v221 offset:224
    buffer_load_dwordx4 a[140:143], v102, s[24:27], s47 offen offset:2048 sc1
    v_mfma_f32_16x16x32_bf16 v[180:183], v[72:75], a[92:95], v[180:183]
    ds_read_b64_tr_b16 v[46:47], v221 offset:2528
    v_mfma_f32_16x16x32_bf16 v[184:187], v[76:79], a[84:87], v[184:187]
    ds_read_b64_tr_b16 v[48:49], v221 offset:256
    v_mfma_f32_16x16x32_bf16 v[188:191], v[76:79], a[88:91], v[188:191]
    ds_read_b64_tr_b16 v[50:51], v221 offset:2560
    s_add_u32 s47, s66, 5
    s_and_b32 s47, s47, 7
    s_mul_i32 s47, s47, 24576
    s_add_u32 s47, s47, s37
    buffer_load_dwordx4 a[144:147], v102, s[24:27], s47 offen offset:0 sc1
    v_mfma_f32_16x16x32_bf16 v[192:195], v[76:79], a[92:95], v[192:195]
    v_mfma_f32_16x16x32_bf16 v[196:199], v[80:83], a[84:87], v[196:199]
    v_mfma_f32_16x16x32_bf16 v[200:203], v[80:83], a[88:91], v[200:203]
    v_mfma_f32_16x16x32_bf16 v[204:207], v[80:83], a[92:95], v[204:207]
    buffer_load_dwordx4 a[148:151], v102, s[24:27], s47 offen offset:1024 sc1
    v_mfma_f32_16x16x32_bf16 v[208:211], v[84:87], a[84:87], v[208:211]
    v_mfma_f32_16x16x32_bf16 v[212:215], v[84:87], a[88:91], v[212:215]
    buffer_load_dwordx4 a[152:155], v102, s[24:27], s47 offen offset:2048 sc1
    v_mfma_f32_16x16x32_bf16 v[216:219], v[84:87], a[92:95], v[216:219]
    s_waitcnt lgkmcnt(0)
    v_mfma_f32_16x16x32_bf16 v[112:115], v[16:19], a[96:99], v[112:115]
    ds_read_b64_tr_b16 v[52:53], v221 offset:9216
    v_mfma_f32_16x16x32_bf16 v[116:119], v[16:19], a[100:103], v[116:119]
    ds_read_b64_tr_b16 v[54:55], v221 offset:11520
    s_add_u32 s47, s47, 6144
    buffer_load_dwordx4 a[156:159], v102, s[24:27], s47 offen offset:0 sc1
    v_mfma_f32_16x16x32_bf16 v[120:123], v[16:19], a[104:107], v[120:123]
    ds_read_b64_tr_b16 v[56:57], v221 offset:9248
    v_mfma_f32_16x16x32_bf16 v[124:127], v[20:23], a[96:99], v[124:127]
    ds_read_b64_tr_b16 v[58:59], v221 offset:11552
    v_mfma_f32_16x16x32_bf16 v[128:131], v[20:23], a[100:103], v[128:131]
    buffer_load_dwordx4 a[160:163], v102, s[24:27], s47 offen offset:1024 sc1
    v_mfma_f32_16x16x32_bf16 v[132:135], v[20:23], a[104:107], v[132:135]
    ds_read_b64_tr_b16 v[60:61], v221 offset:9280
    v_mfma_f32_16x16x32_bf16 v[136:139], v[24:27], a[96:99], v[136:139]
    ds_read_b64_tr_b16 v[62:63], v221 offset:11584
    v_mfma_f32_16x16x32_bf16 v[140:143], v[24:27], a[100:103], v[140:143]
    ds_read_b64_tr_b16 v[64:65], v221 offset:9312
    buffer_load_dwordx4 a[164:167], v102, s[24:27], s47 offen offset:2048 sc1
    v_mfma_f32_16x16x32_bf16 v[144:147], v[24:27], a[104:107], v[144:147]
    ds_read_b64_tr_b16 v[66:67], v221 offset:11616
    v_mfma_f32_16x16x32_bf16 v[148:151], v[28:31], a[96:99], v[148:151]
    ds_read_b64_tr_b16 v[68:69], v221 offset:9344
    v_mfma_f32_16x16x32_bf16 v[152:155], v[28:31], a[100:103], v[152:155]
    ds_read_b64_tr_b16 v[70:71], v221 offset:11648
    s_add_u32 s47, s66, 7
    s_and_b32 s47, s47, 7
    s_mul_i32 s47, s47, 24576
    s_add_u32 s47, s47, s37
    buffer_load_dwordx4 a[168:171], v102, s[24:27], s47 offen offset:0 sc1
    v_mfma_f32_16x16x32_bf16 v[156:159], v[28:31], a[104:107], v[156:159]
    ds_read_b64_tr_b16 v[72:73], v221 offset:9376
    v_mfma_f32_16x16x32_bf16 v[160:163], v[32:35], a[96:99], v[160:163]
    ds_read_b64_tr_b16 v[74:75], v221 offset:11680
    v_mfma_f32_16x16x32_bf16 v[164:167], v[32:35], a[100:103], v[164:167]
    ds_read_b64_tr_b16 v[76:77], v221 offset:9408
    v_mfma_f32_16x16x32_bf16 v[168:171], v[32:35], a[104:107], v[168:171]
    buffer_load_dwordx4 a[172:175], v102, s[24:27], s47 offen offset:1024 sc1
    v_mfma_f32_16x16x32_bf16 v[172:175], v[36:39], a[96:99], v[172:175]
    ds_read_b64_tr_b16 v[78:79], v221 offset:11712
    v_mfma_f32_16x16x32_bf16 v[176:179], v[36:39], a[100:103], v[176:179]
    ds_read_b64_tr_b16 v[80:81], v221 offset:9440
    v_mfma_f32_16x16x32_bf16 v[180:183], v[36:39], a[104:107], v[180:183]
    ds_read_b64_tr_b16 v[82:83], v221 offset:11744
    buffer_load_dwordx4 a[176:179], v102, s[24:27], s47 offen offset:2048 sc1
    v_mfma_f32_16x16x32_bf16 v[184:187], v[40:43], a[96:99], v[184:187]
    ds_read_b64_tr_b16 v[84:85], v221 offset:9472
    v_mfma_f32_16x16x32_bf16 v[188:191], v[40:43], a[100:103], v[188:191]
    ds_read_b64_tr_b16 v[86:87], v221 offset:11776
    v_mfma_f32_16x16x32_bf16 v[192:195], v[40:43], a[104:107], v[192:195]
    s_add_u32 s47, s47, 6144
    buffer_load_dwordx4 a[180:183], v102, s[24:27], s47 offen offset:0 sc1
    v_mfma_f32_16x16x32_bf16 v[196:199], v[44:47], a[96:99], v[196:199]
    v_mfma_f32_16x16x32_bf16 v[200:203], v[44:47], a[100:103], v[200:203]
    buffer_load_dwordx4 a[184:187], v102, s[24:27], s47 offen offset:1024 sc1
    v_mfma_f32_16x16x32_bf16 v[204:207], v[44:47], a[104:107], v[204:207]
    v_mfma_f32_16x16x32_bf16 v[208:211], v[48:51], a[96:99], v[208:211]
    v_mfma_f32_16x16x32_bf16 v[212:215], v[48:51], a[100:103], v[212:215]
    buffer_load_dwordx4 a[188:191], v102, s[24:27], s47 offen offset:2048 sc1
    v_mfma_f32_16x16x32_bf16 v[216:219], v[48:51], a[104:107], v[216:219]
    s_waitcnt lgkmcnt(0)
    s_barrier
    s_waitcnt lgkmcnt(0)
    v_mfma_f32_16x16x32_bf16 v[112:115], v[52:55], a[108:111], v[112:115]
    ds_read_b64_tr_b16 v[16:17], v104 offset:0
    v_mfma_f32_16x16x32_bf16 v[116:119], v[52:55], a[112:115], v[116:119]
    ds_read_b64_tr_b16 v[18:19], v104 offset:2304
    v_mfma_f32_16x16x32_bf16 v[120:123], v[52:55], a[116:119], v[120:123]
    ds_read_b64_tr_b16 v[20:21], v104 offset:32
    s_add_u32 s4, s66, 5
    s_and_b32 s4, s4, 7
    s_mul_i32 s4, s4, 147456
    s_add_u32 s4, s4, s68
    s_add_u32 s4, s4, 0
    s_add_u32 m0, s65, 122880
    s_nop 0
    buffer_load_dwordx4 v93, s[60:63], s4 offen lds
    v_mfma_f32_16x16x32_bf16 v[124:127], v[56:59], a[108:111], v[124:127]
    ds_read_b64_tr_b16 v[22:23], v104 offset:2336
    v_mfma_f32_16x16x32_bf16 v[128:131], v[56:59], a[112:115], v[128:131]
    v_mfma_f32_16x16x32_bf16 v[132:135], v[56:59], a[116:119], v[132:135]
    ds_read_b64_tr_b16 v[24:25], v104 offset:64
    v_mfma_f32_16x16x32_bf16 v[136:139], v[60:63], a[108:111], v[136:139]
    ds_read_b64_tr_b16 v[26:27], v104 offset:2368
    s_add_u32 m0, s65, 123904
    s_nop 0
    buffer_load_dwordx4 v94, s[60:63], s4 offen lds
    v_mfma_f32_16x16x32_bf16 v[140:143], v[60:63], a[112:115], v[140:143]
    ds_read_b64_tr_b16 v[28:29], v104 offset:96
    v_mfma_f32_16x16x32_bf16 v[144:147], v[60:63], a[116:119], v[144:147]
    ds_read_b64_tr_b16 v[30:31], v104 offset:2400
    s_add_u32 m0, s65, 124928
    s_nop 0
    buffer_load_dwordx4 v95, s[60:63], s4 offen lds
    v_mfma_f32_16x16x32_bf16 v[148:151], v[64:67], a[108:111], v[148:151]
    ds_read_b64_tr_b16 v[32:33], v104 offset:128
    v_mfma_f32_16x16x32_bf16 v[152:155], v[64:67], a[112:115], v[152:155]
    ds_read_b64_tr_b16 v[34:35], v104 offset:2432
    v_mfma_f32_16x16x32_bf16 v[156:159], v[64:67], a[116:119], v[156:159]
    ds_read_b64_tr_b16 v[36:37], v104 offset:160
    s_add_u32 m0, s65, 125952
    s_nop 0
    buffer_load_dwordx4 v96, s[60:63], s4 offen lds
    v_mfma_f32_16x16x32_bf16 v[160:163], v[68:71], a[108:111], v[160:163]
    ds_read_b64_tr_b16 v[38:39], v104 offset:2464
    v_mfma_f32_16x16x32_bf16 v[164:167], v[68:71], a[112:115], v[164:167]
    ds_read_b64_tr_b16 v[40:41], v104 offset:192
    v_mfma_f32_16x16x32_bf16 v[168:171], v[68:71], a[116:119], v[168:171]
    s_add_u32 m0, s65, 126976
    s_nop 0
    buffer_load_dwordx4 v97, s[60:63], s4 offen lds
    v_mfma_f32_16x16x32_bf16 v[172:175], v[72:75], a[108:111], v[172:175]
    ds_read_b64_tr_b16 v[42:43], v104 offset:2496
    v_mfma_f32_16x16x32_bf16 v[176:179], v[72:75], a[112:115], v[176:179]
    ds_read_b64_tr_b16 v[44:45], v104 offset:224
    v_mfma_f32_16x16x32_bf16 v[180:183], v[72:75], a[116:119], v[180:183]
    ds_read_b64_tr_b16 v[46:47], v104 offset:2528
    s_add_u32 m0, s65, 128000
    s_nop 0
    buffer_load_dwordx4 v98, s[60:63], s4 offen lds
    v_mfma_f32_16x16x32_bf16 v[184:187], v[76:79], a[108:111], v[184:187]
    ds_read_b64_tr_b16 v[48:49], v104 offset:256
    v_mfma_f32_16x16x32_bf16 v[188:191], v[76:79], a[112:115], v[188:191]
    ds_read_b64_tr_b16 v[50:51], v104 offset:2560
    v_mfma_f32_16x16x32_bf16 v[192:195], v[76:79], a[116:119], v[192:195]
    s_add_u32 m0, s65, 129024
    s_nop 0
    buffer_load_dwordx4 v99, s[60:63], s4 offen lds
    v_mfma_f32_16x16x32_bf16 v[196:199], v[80:83], a[108:111], v[196:199]
    v_mfma_f32_16x16x32_bf16 v[200:203], v[80:83], a[112:115], v[200:203]
    s_add_u32 m0, s65, 130048
    s_nop 0
    buffer_load_dwordx4 v100, s[60:63], s4 offen lds
    v_mfma_f32_16x16x32_bf16 v[204:207], v[80:83], a[116:119], v[204:207]
    v_mfma_f32_16x16x32_bf16 v[208:211], v[84:87], a[108:111], v[208:211]
    v_mfma_f32_16x16x32_bf16 v[212:215], v[84:87], a[112:115], v[212:215]
    s_add_u32 m0, s65, 131072
    s_nop 0
    buffer_load_dwordx4 v101, s[60:63], s4 offen lds
    v_mfma_f32_16x16x32_bf16 v[216:219], v[84:87], a[116:119], v[216:219]
    s_waitcnt vmcnt(12)
    s_waitcnt lgkmcnt(0)
    v_mfma_f32_16x16x32_bf16 v[112:115], v[16:19], a[120:123], v[112:115]
    ds_read_b64_tr_b16 v[52:53], v104 offset:9216
    v_mfma_f32_16x16x32_bf16 v[116:119], v[16:19], a[124:127], v[116:119]
    ds_read_b64_tr_b16 v[54:55], v104 offset:11520
    v_mfma_f32_16x16x32_bf16 v[120:123], v[16:19], a[128:131], v[120:123]
    ds_read_b64_tr_b16 v[56:57], v104 offset:9248
    s_add_u32 s4, s66, 7
    s_and_b32 s4, s4, 7
    s_mul_i32 s4, s4, 147456
    s_add_u32 s4, s4, s68
    s_add_u32 s4, s4, 0
    s_add_u32 m0, s65, 86016
    s_nop 0
    buffer_load_dwordx4 v93, s[60:63], s4 offen lds
    v_mfma_f32_16x16x32_bf16 v[124:127], v[20:23], a[120:123], v[124:127]
    ds_read_b64_tr_b16 v[58:59], v104 offset:11552
    v_mfma_f32_16x16x32_bf16 v[128:131], v[20:23], a[124:127], v[128:131]
    v_mfma_f32_16x16x32_bf16 v[132:135], v[20:23], a[128:131], v[132:135]
    ds_read_b64_tr_b16 v[60:61], v104 offset:9280
    v_mfma_f32_16x16x32_bf16 v[136:139], v[24:27], a[120:123], v[136:139]
    ds_read_b64_tr_b16 v[62:63], v104 offset:11584
    s_add_u32 m0, s65, 87040
    s_nop 0
    buffer_load_dwordx4 v94, s[60:63], s4 offen lds
    v_mfma_f32_16x16x32_bf16 v[140:143], v[24:27], a[124:127], v[140:143]
    ds_read_b64_tr_b16 v[64:65], v104 offset:9312
    v_mfma_f32_16x16x32_bf16 v[144:147], v[24:27], a[128:131], v[144:147]
    ds_read_b64_tr_b16 v[66:67], v104 offset:11616
    s_add_u32 m0, s65, 88064
    s_nop 0
    buffer_load_dwordx4 v95, s[60:63], s4 offen lds
    v_mfma_f32_16x16x32_bf16 v[148:151], v[28:31], a[120:123], v[148:151]
    ds_read_b64_tr_b16 v[68:69], v104 offset:9344
    v_mfma_f32_16x16x32_bf16 v[152:155], v[28:31], a[124:127], v[152:155]
    ds_read_b64_tr_b16 v[70:71], v104 offset:11648
    v_mfma_f32_16x16x32_bf16 v[156:159], v[28:31], a[128:131], v[156:159]
    ds_read_b64_tr_b16 v[72:73], v104 offset:9376
    s_add_u32 m0, s65, 89088
    s_nop 0
    buffer_load_dwordx4 v96, s[60:63], s4 offen lds
    v_mfma_f32_16x16x32_bf16 v[160:163], v[32:35], a[120:123], v[160:163]
    ds_read_b64_tr_b16 v[74:75], v104 offset:11680
    v_mfma_f32_16x16x32_bf16 v[164:167], v[32:35], a[124:127], v[164:167]
    ds_read_b64_tr_b16 v[76:77], v104 offset:9408
    v_mfma_f32_16x16x32_bf16 v[168:171], v[32:35], a[128:131], v[168:171]
    s_add_u32 m0, s65, 90112
    s_nop 0
    buffer_load_dwordx4 v97, s[60:63], s4 offen lds
    v_mfma_f32_16x16x32_bf16 v[172:175], v[36:39], a[120:123], v[172:175]
    ds_read_b64_tr_b16 v[78:79], v104 offset:11712
    v_mfma_f32_16x16x32_bf16 v[176:179], v[36:39], a[124:127], v[176:179]
    ds_read_b64_tr_b16 v[80:81], v104 offset:9440
    v_mfma_f32_16x16x32_bf16 v[180:183], v[36:39], a[128:131], v[180:183]
    ds_read_b64_tr_b16 v[82:83], v104 offset:11744
    s_add_u32 m0, s65, 91136
    s_nop 0
    buffer_load_dwordx4 v98, s[60:63], s4 offen lds
    v_mfma_f32_16x16x32_bf16 v[184:187], v[40:43], a[120:123], v[184:187]
    ds_read_b64_tr_b16 v[84:85], v104 offset:9472
    v_mfma_f32_16x16x32_bf16 v[188:191], v[40:43], a[124:127], v[188:191]
    ds_read_b64_tr_b16 v[86:87], v104 offset:11776
    v_mfma_f32_16x16x32_bf16 v[192:195], v[40:43], a[128:131], v[192:195]
    s_add_u32 m0, s65, 92160
    s_nop 0
    buffer_load_dwordx4 v99, s[60:63], s4 offen lds
    v_mfma_f32_16x16x32_bf16 v[196:199], v[44:47], a[120:123], v[196:199]
    v_mfma_f32_16x16x32_bf16 v[200:203], v[44:47], a[124:127], v[200:203]
    s_add_u32 m0, s65, 93184
    s_nop 0
    buffer_load_dwordx4 v100, s[60:63], s4 offen lds
    v_mfma_f32_16x16x32_bf16 v[204:207], v[44:47], a[128:131], v[204:207]
    v_mfma_f32_16x16x32_bf16 v[208:211], v[48:51], a[120:123], v[208:211]
    v_mfma_f32_16x16x32_bf16 v[212:215], v[48:51], a[124:127], v[212:215]
    s_add_u32 m0, s65, 94208
    s_nop 0
    buffer_load_dwordx4 v101, s[60:63], s4 offen lds
    v_mfma_f32_16x16x32_bf16 v[216:219], v[48:51], a[128:131], v[216:219]
    s_waitcnt vmcnt(9) lgkmcnt(0)
    s_barrier
    s_waitcnt lgkmcnt(0)
    v_mfma_f32_16x16x32_bf16 v[112:115], v[52:55], a[132:135], v[112:115]
    ds_read_b64_tr_b16 v[16:17], v103 offset:0
    v_mfma_f32_16x16x32_bf16 v[116:119], v[52:55], a[136:139], v[116:119]
    ds_read_b64_tr_b16 v[18:19], v103 offset:2304
    v_mfma_f32_16x16x32_bf16 v[120:123], v[52:55], a[140:143], v[120:123]
    ds_read_b64_tr_b16 v[20:21], v103 offset:32
    v_mfma_f32_16x16x32_bf16 v[124:127], v[56:59], a[132:135], v[124:127]
    ds_read_b64_tr_b16 v[22:23], v103 offset:2336
    v_mfma_f32_16x16x32_bf16 v[128:131], v[56:59], a[136:139], v[128:131]
    v_mfma_f32_16x16x32_bf16 v[132:135], v[56:59], a[140:143], v[132:135]
    ds_read_b64_tr_b16 v[24:25], v103 offset:64
    v_mfma_f32_16x16x32_bf16 v[136:139], v[60:63], a[132:135], v[136:139]
    ds_read_b64_tr_b16 v[26:27], v103 offset:2368
    v_mfma_f32_16x16x32_bf16 v[140:143], v[60:63], a[136:139], v[140:143]
    ds_read_b64_tr_b16 v[28:29], v103 offset:96
    v_mfma_f32_16x16x32_bf16 v[144:147], v[60:63], a[140:143], v[144:147]
    ds_read_b64_tr_b16 v[30:31], v103 offset:2400
    v_mfma_f32_16x16x32_bf16 v[148:151], v[64:67], a[132:135], v[148:151]
    ds_read_b64_tr_b16 v[32:33], v103 offset:128
    v_mfma_f32_16x16x32_bf16 v[152:155], v[64:67], a[136:139], v[152:155]
    ds_read_b64_tr_b16 v[34:35], v103 offset:2432
    v_mfma_f32_16x16x32_bf16 v[156:159], v[64:67], a[140:143], v[156:159]
    ds_read_b64_tr_b16 v[36:37], v103 offset:160
    v_mfma_f32_16x16x32_bf16 v[160:163], v[68:71], a[132:135], v[160:163]
    ds_read_b64_tr_b16 v[38:39], v103 offset:2464
    v_mfma_f32_16x16x32_bf16 v[164:167], v[68:71], a[136:139], v[164:167]
    ds_read_b64_tr_b16 v[40:41], v103 offset:192
    v_mfma_f32_16x16x32_bf16 v[168:171], v[68:71], a[140:143], v[168:171]
    v_mfma_f32_16x16x32_bf16 v[172:175], v[72:75], a[132:135], v[172:175]
    ds_read_b64_tr_b16 v[42:43], v103 offset:2496
    v_mfma_f32_16x16x32_bf16 v[176:179], v[72:75], a[136:139], v[176:179]
    ds_read_b64_tr_b16 v[44:45], v103 offset:224
    v_mfma_f32_16x16x32_bf16 v[180:183], v[72:75], a[140:143], v[180:183]
    ds_read_b64_tr_b16 v[46:47], v103 offset:2528
    v_mfma_f32_16x16x32_bf16 v[184:187], v[76:79], a[132:135], v[184:187]
    ds_read_b64_tr_b16 v[48:49], v103 offset:256
    v_mfma_f32_16x16x32_bf16 v[188:191], v[76:79], a[136:139], v[188:191]
    ds_read_b64_tr_b16 v[50:51], v103 offset:2560
    v_mfma_f32_16x16x32_bf16 v[192:195], v[76:79], a[140:143], v[192:195]
    v_mfma_f32_16x16x32_bf16 v[196:199], v[80:83], a[132:135], v[196:199]
    v_mfma_f32_16x16x32_bf16 v[200:203], v[80:83], a[136:139], v[200:203]
    v_mfma_f32_16x16x32_bf16 v[204:207], v[80:83], a[140:143], v[204:207]
    v_mfma_f32_16x16x32_bf16 v[208:211], v[84:87], a[132:135], v[208:211]
    v_mfma_f32_16x16x32_bf16 v[212:215], v[84:87], a[136:139], v[212:215]
    v_mfma_f32_16x16x32_bf16 v[216:219], v[84:87], a[140:143], v[216:219]
    s_waitcnt vmcnt(6)
    s_waitcnt lgkmcnt(0)
    v_mfma_f32_16x16x32_bf16 v[112:115], v[16:19], a[144:147], v[112:115]
    ds_read_b64_tr_b16 v[52:53], v103 offset:9216
    v_mfma_f32_16x16x32_bf16 v[116:119], v[16:19], a[148:151], v[116:119]
    ds_read_b64_tr_b16 v[54:55], v103 offset:11520
    v_mfma_f32_16x16x32_bf16 v[120:123], v[16:19], a[152:155], v[120:123]
    ds_read_b64_tr_b16 v[56:57], v103 offset:9248
    v_mfma_f32_16x16x32_bf16 v[124:127], v[20:23], a[144:147], v[124:127]
    ds_read_b64_tr_b16 v[58:59], v103 offset:11552
    v_mfma_f32_16x16x32_bf16 v[128:131], v[20:23], a[148:151], v[128:131]
    v_mfma_f32_16x16x32_bf16 v[132:135], v[20:23], a[152:155], v[132:135]
    ds_read_b64_tr_b16 v[60:61], v103 offset:9280
    v_mfma_f32_16x16x32_bf16 v[136:139], v[24:27], a[144:147], v[136:139]
    ds_read_b64_tr_b16 v[62:63], v103 offset:11584
    v_mfma_f32_16x16x32_bf16 v[140:143], v[24:27], a[148:151], v[140:143]
    ds_read_b64_tr_b16 v[64:65], v103 offset:9312
    v_mfma_f32_16x16x32_bf16 v[144:147], v[24:27], a[152:155], v[144:147]
    ds_read_b64_tr_b16 v[66:67], v103 offset:11616
    v_mfma_f32_16x16x32_bf16 v[148:151], v[28:31], a[144:147], v[148:151]
    ds_read_b64_tr_b16 v[68:69], v103 offset:9344
    v_mfma_f32_16x16x32_bf16 v[152:155], v[28:31], a[148:151], v[152:155]
    ds_read_b64_tr_b16 v[70:71], v103 offset:11648
    v_mfma_f32_16x16x32_bf16 v[156:159], v[28:31], a[152:155], v[156:159]
    ds_read_b64_tr_b16 v[72:73], v103 offset:9376
    v_mfma_f32_16x16x32_bf16 v[160:163], v[32:35], a[144:147], v[160:163]
    ds_read_b64_tr_b16 v[74:75], v103 offset:11680
    v_mfma_f32_16x16x32_bf16 v[164:167], v[32:35], a[148:151], v[164:167]
    ds_read_b64_tr_b16 v[76:77], v103 offset:9408
    v_mfma_f32_16x16x32_bf16 v[168:171], v[32:35], a[152:155], v[168:171]
    v_mfma_f32_16x16x32_bf16 v[172:175], v[36:39], a[144:147], v[172:175]
    ds_read_b64_tr_b16 v[78:79], v103 offset:11712
    v_mfma_f32_16x16x32_bf16 v[176:179], v[36:39], a[148:151], v[176:179]
    ds_read_b64_tr_b16 v[80:81], v103 offset:9440
    v_mfma_f32_16x16x32_bf16 v[180:183], v[36:39], a[152:155], v[180:183]
    ds_read_b64_tr_b16 v[82:83], v103 offset:11744
    v_mfma_f32_16x16x32_bf16 v[184:187], v[40:43], a[144:147], v[184:187]
    ds_read_b64_tr_b16 v[84:85], v103 offset:9472
    v_mfma_f32_16x16x32_bf16 v[188:191], v[40:43], a[148:151], v[188:191]
    ds_read_b64_tr_b16 v[86:87], v103 offset:11776
    v_mfma_f32_16x16x32_bf16 v[192:195], v[40:43], a[152:155], v[192:195]
    v_mfma_f32_16x16x32_bf16 v[196:199], v[44:47], a[144:147], v[196:199]
    v_mfma_f32_16x16x32_bf16 v[200:203], v[44:47], a[148:151], v[200:203]
    v_mfma_f32_16x16x32_bf16 v[204:207], v[44:47], a[152:155], v[204:207]
    v_mfma_f32_16x16x32_bf16 v[208:211], v[48:51], a[144:147], v[208:211]
    v_mfma_f32_16x16x32_bf16 v[212:215], v[48:51], a[148:151], v[212:215]
    v_mfma_f32_16x16x32_bf16 v[216:219], v[48:51], a[152:155], v[216:219]
    s_waitcnt vmcnt(0) lgkmcnt(0)
    s_barrier
    s_waitcnt lgkmcnt(0)
    v_mfma_f32_16x16x32_bf16 v[112:115], v[52:55], a[156:159], v[112:115]
    ds_read_b64_tr_b16 v[16:17], v220 offset:0
    v_mfma_f32_16x16x32_bf16 v[116:119], v[52:55], a[160:163], v[116:119]
    ds_read_b64_tr_b16 v[18:19], v220 offset:2304
    v_mfma_f32_16x16x32_bf16 v[120:123], v[52:55], a[164:167], v[120:123]
    ds_read_b64_tr_b16 v[20:21], v220 offset:32
    v_mfma_f32_16x16x32_bf16 v[124:127], v[56:59], a[156:159], v[124:127]
    ds_read_b64_tr_b16 v[22:23], v220 offset:2336
    v_mfma_f32_16x16x32_bf16 v[128:131], v[56:59], a[160:163], v[128:131]
    v_mfma_f32_16x16x32_bf16 v[132:135], v[56:59], a[164:167], v[132:135]
    ds_read_b64_tr_b16 v[24:25], v220 offset:64
    v_mfma_f32_16x16x32_bf16 v[136:139], v[60:63], a[156:159], v[136:139]
    ds_read_b64_tr_b16 v[26:27], v220 offset:2368
    v_mfma_f32_16x16x32_bf16 v[140:143], v[60:63], a[160:163], v[140:143]
    ds_read_b64_tr_b16 v[28:29], v220 offset:96
    v_mfma_f32_16x16x32_bf16 v[144:147], v[60:63], a[164:167], v[144:147]
    ds_read_b64_tr_b16 v[30:31], v220 offset:2400
    v_mfma_f32_16x16x32_bf16 v[148:151], v[64:67], a[156:159], v[148:151]
    ds_read_b64_tr_b16 v[32:33], v220 offset:128
    v_mfma_f32_16x16x32_bf16 v[152:155], v[64:67], a[160:163], v[152:155]
    ds_read_b64_tr_b16 v[34:35], v220 offset:2432
    v_mfma_f32_16x16x32_bf16 v[156:159], v[64:67], a[164:167], v[156:159]
    ds_read_b64_tr_b16 v[36:37], v220 offset:160
    v_mfma_f32_16x16x32_bf16 v[160:163], v[68:71], a[156:159], v[160:163]
    ds_read_b64_tr_b16 v[38:39], v220 offset:2464
    v_mfma_f32_16x16x32_bf16 v[164:167], v[68:71], a[160:163], v[164:167]
    ds_read_b64_tr_b16 v[40:41], v220 offset:192
    v_mfma_f32_16x16x32_bf16 v[168:171], v[68:71], a[164:167], v[168:171]
    v_mfma_f32_16x16x32_bf16 v[172:175], v[72:75], a[156:159], v[172:175]
    ds_read_b64_tr_b16 v[42:43], v220 offset:2496
    v_mfma_f32_16x16x32_bf16 v[176:179], v[72:75], a[160:163], v[176:179]
    ds_read_b64_tr_b16 v[44:45], v220 offset:224
    v_mfma_f32_16x16x32_bf16 v[180:183], v[72:75], a[164:167], v[180:183]
    ds_read_b64_tr_b16 v[46:47], v220 offset:2528
    v_mfma_f32_16x16x32_bf16 v[184:187], v[76:79], a[156:159], v[184:187]
    ds_read_b64_tr_b16 v[48:49], v220 offset:256
    v_mfma_f32_16x16x32_bf16 v[188:191], v[76:79], a[160:163], v[188:191]
    ds_read_b64_tr_b16 v[50:51], v220 offset:2560
    v_mfma_f32_16x16x32_bf16 v[192:195], v[76:79], a[164:167], v[192:195]
    v_mfma_f32_16x16x32_bf16 v[196:199], v[80:83], a[156:159], v[196:199]
    v_mfma_f32_16x16x32_bf16 v[200:203], v[80:83], a[160:163], v[200:203]
    v_mfma_f32_16x16x32_bf16 v[204:207], v[80:83], a[164:167], v[204:207]
    v_mfma_f32_16x16x32_bf16 v[208:211], v[84:87], a[156:159], v[208:211]
    v_mfma_f32_16x16x32_bf16 v[212:215], v[84:87], a[160:163], v[212:215]
    v_mfma_f32_16x16x32_bf16 v[216:219], v[84:87], a[164:167], v[216:219]
    s_waitcnt lgkmcnt(0)
    v_mfma_f32_16x16x32_bf16 v[112:115], v[16:19], a[168:171], v[112:115]
    ds_read_b64_tr_b16 v[52:53], v220 offset:9216
    v_mfma_f32_16x16x32_bf16 v[116:119], v[16:19], a[172:175], v[116:119]
    ds_read_b64_tr_b16 v[54:55], v220 offset:11520
    v_mfma_f32_16x16x32_bf16 v[120:123], v[16:19], a[176:179], v[120:123]
    ds_read_b64_tr_b16 v[56:57], v220 offset:9248
    v_mfma_f32_16x16x32_bf16 v[124:127], v[20:23], a[168:171], v[124:127]
    ds_read_b64_tr_b16 v[58:59], v220 offset:11552
    v_mfma_f32_16x16x32_bf16 v[128:131], v[20:23], a[172:175], v[128:131]
    v_mfma_f32_16x16x32_bf16 v[132:135], v[20:23], a[176:179], v[132:135]
    ds_read_b64_tr_b16 v[60:61], v220 offset:9280
    v_mfma_f32_16x16x32_bf16 v[136:139], v[24:27], a[168:171], v[136:139]
    ds_read_b64_tr_b16 v[62:63], v220 offset:11584
    v_mfma_f32_16x16x32_bf16 v[140:143], v[24:27], a[172:175], v[140:143]
    ds_read_b64_tr_b16 v[64:65], v220 offset:9312
    v_mfma_f32_16x16x32_bf16 v[144:147], v[24:27], a[176:179], v[144:147]
    ds_read_b64_tr_b16 v[66:67], v220 offset:11616
    v_mfma_f32_16x16x32_bf16 v[148:151], v[28:31], a[168:171], v[148:151]
    ds_read_b64_tr_b16 v[68:69], v220 offset:9344
    v_mfma_f32_16x16x32_bf16 v[152:155], v[28:31], a[172:175], v[152:155]
    ds_read_b64_tr_b16 v[70:71], v220 offset:11648
    v_mfma_f32_16x16x32_bf16 v[156:159], v[28:31], a[176:179], v[156:159]
    ds_read_b64_tr_b16 v[72:73], v220 offset:9376
    v_mfma_f32_16x16x32_bf16 v[160:163], v[32:35], a[168:171], v[160:163]
    ds_read_b64_tr_b16 v[74:75], v220 offset:11680
    v_mfma_f32_16x16x32_bf16 v[164:167], v[32:35], a[172:175], v[164:167]
    ds_read_b64_tr_b16 v[76:77], v220 offset:9408
    v_mfma_f32_16x16x32_bf16 v[168:171], v[32:35], a[176:179], v[168:171]
    v_mfma_f32_16x16x32_bf16 v[172:175], v[36:39], a[168:171], v[172:175]
    ds_read_b64_tr_b16 v[78:79], v220 offset:11712
    v_mfma_f32_16x16x32_bf16 v[176:179], v[36:39], a[172:175], v[176:179]
    ds_read_b64_tr_b16 v[80:81], v220 offset:9440
    v_mfma_f32_16x16x32_bf16 v[180:183], v[36:39], a[176:179], v[180:183]
    ds_read_b64_tr_b16 v[82:83], v220 offset:11744
    v_mfma_f32_16x16x32_bf16 v[184:187], v[40:43], a[168:171], v[184:187]
    ds_read_b64_tr_b16 v[84:85], v220 offset:9472
    v_mfma_f32_16x16x32_bf16 v[188:191], v[40:43], a[172:175], v[188:191]
    ds_read_b64_tr_b16 v[86:87], v220 offset:11776
    v_mfma_f32_16x16x32_bf16 v[192:195], v[40:43], a[176:179], v[192:195]
    v_mfma_f32_16x16x32_bf16 v[196:199], v[44:47], a[168:171], v[196:199]
    v_mfma_f32_16x16x32_bf16 v[200:203], v[44:47], a[172:175], v[200:203]
    v_mfma_f32_16x16x32_bf16 v[204:207], v[44:47], a[176:179], v[204:207]
    v_mfma_f32_16x16x32_bf16 v[208:211], v[48:51], a[168:171], v[208:211]
    v_mfma_f32_16x16x32_bf16 v[212:215], v[48:51], a[172:175], v[212:215]
    v_mfma_f32_16x16x32_bf16 v[216:219], v[48:51], a[176:179], v[216:219]
    s_lshl_b32 s3, s28, 14
    v_add_u32 v13, s3, v102
    v_xor_b32 v14, 32768, v13
    s_lshl_b32 s52, s39, 2
    s_add_u32 s52, s52, s32
    s_lshl_b32 s53, s52, 2
    s_add_u32 s53, s53, s30
    s_mul_i32 s53, s53, 40960
    s_mul_i32 s3, s28, 10240
    s_add_u32 s53, s53, s3
    s_add_u32 s47, s53, 16777216
    s_waitcnt lgkmcnt(0)
    s_barrier
    v_mfma_f32_16x16x32_bf16 v[208:211], v[84:87], a[180:183], v[208:211]
    v_mfma_f32_16x16x32_bf16 v[212:215], v[84:87], a[184:187], v[212:215]
    v_mfma_f32_16x16x32_bf16 v[216:219], v[84:87], a[188:191], v[216:219]
    v_mfma_f32_16x16x32_bf16 v[196:199], v[80:83], a[180:183], v[196:199]
    v_mfma_f32_16x16x32_bf16 v[200:203], v[80:83], a[184:187], v[200:203]
    v_mfma_f32_16x16x32_bf16 v[204:207], v[80:83], a[188:191], v[204:207]
    v_mfma_f32_16x16x32_bf16 v[184:187], v[76:79], a[180:183], v[184:187]
    s_nop 1
    ds_write_b128 v13, v[208:211] offset:0
    v_mfma_f32_16x16x32_bf16 v[188:191], v[76:79], a[184:187], v[188:191]
    ds_write_b128 v13, v[212:215] offset:1024
    v_mfma_f32_16x16x32_bf16 v[192:195], v[76:79], a[188:191], v[192:195]
    ds_write_b128 v13, v[216:219] offset:2048
    v_mfma_f32_16x16x32_bf16 v[172:175], v[72:75], a[180:183], v[172:175]
    ds_write_b128 v13, v[196:199] offset:3072
    v_mfma_f32_16x16x32_bf16 v[176:179], v[72:75], a[184:187], v[176:179]
    ds_write_b128 v13, v[200:203] offset:4096
    v_mfma_f32_16x16x32_bf16 v[180:183], v[72:75], a[188:191], v[180:183]
    ds_write_b128 v13, v[204:207] offset:5120
    v_mfma_f32_16x16x32_bf16 v[160:163], v[68:71], a[180:183], v[160:163]
    ds_write_b128 v13, v[184:187] offset:6144
    v_mfma_f32_16x16x32_bf16 v[164:167], v[68:71], a[184:187], v[164:167]
    ds_write_b128 v13, v[188:191] offset:7168
    v_mfma_f32_16x16x32_bf16 v[168:171], v[68:71], a[188:191], v[168:171]
    ds_write_b128 v13, v[192:195] offset:8192
    v_mfma_f32_16x16x32_bf16 v[112:115], v[52:55], a[180:183], v[112:115]
    ds_write_b128 v13, v[172:175] offset:9216
    v_mfma_f32_16x16x32_bf16 v[116:119], v[52:55], a[184:187], v[116:119]
    ds_write_b128 v13, v[176:179] offset:10240
    v_mfma_f32_16x16x32_bf16 v[120:123], v[52:55], a[188:191], v[120:123]
    ds_write_b128 v13, v[180:183] offset:11264
    v_mfma_f32_16x16x32_bf16 v[124:127], v[56:59], a[180:183], v[124:127]
    ds_write_b128 v13, v[160:163] offset:12288
    v_mfma_f32_16x16x32_bf16 v[128:131], v[56:59], a[184:187], v[128:131]
    ds_write_b128 v13, v[164:167] offset:13312
    v_mfma_f32_16x16x32_bf16 v[132:135], v[56:59], a[188:191], v[132:135]
    ds_write_b128 v13, v[168:171] offset:14336
    v_mfma_f32_16x16x32_bf16 v[136:139], v[60:63], a[180:183], v[136:139]
    v_mfma_f32_16x16x32_bf16 v[140:143], v[60:63], a[184:187], v[140:143]
    v_mfma_f32_16x16x32_bf16 v[144:147], v[60:63], a[188:191], v[144:147]
    v_mfma_f32_16x16x32_bf16 v[148:151], v[64:67], a[180:183], v[148:151]
    v_mfma_f32_16x16x32_bf16 v[152:155], v[64:67], a[184:187], v[152:155]
    v_mfma_f32_16x16x32_bf16 v[156:159], v[64:67], a[188:191], v[156:159]
    s_waitcnt lgkmcnt(0)
    s_barrier
    ds_read_b128 v[16:19], v14 offset:0
    ds_read_b128 v[20:23], v14 offset:1024
    ds_read_b128 v[24:27], v14 offset:2048
    ds_read_b128 v[28:31], v14 offset:3072
    ds_read_b128 v[32:35], v14 offset:4096
    ds_read_b128 v[36:39], v14 offset:5120
    ds_read_b128 v[40:43], v14 offset:6144
    ds_read_b128 v[44:47], v14 offset:7168
    ds_read_b128 v[48:51], v14 offset:8192
    ds_read_b128 v[52:55], v14 offset:9216
    ds_read_b128 v[56:59], v14 offset:10240
    ds_read_b128 v[60:63], v14 offset:11264
    ds_read_b128 v[64:67], v14 offset:12288
    ds_read_b128 v[68:71], v14 offset:13312
    ds_read_b128 v[72:75], v14 offset:14336
    v_mov_b32 v175, s75
    v_mov_b32 v179, s75
    v_mov_b32 v183, s75
    v_mov_b32 v187, s75
    v_mov_b32 v191, s75
    v_mov_b32 v195, s75
    v_mov_b32 v199, s75
    v_mov_b32 v203, s75
    v_mov_b32 v207, s75
    v_mov_b32 v211, s75
    s_waitcnt lgkmcnt(14)
    v_pk_add_f32 v[112:113], v[112:113], v[16:17]
    v_pk_add_f32 v[114:115], v[114:115], v[18:19]
    v_cvt_pk_bf16_f32 v172, v112, v113
    v_cvt_pk_bf16_f32 v173, v114, v115
    s_waitcnt lgkmcnt(13)
    v_pk_add_f32 v[116:117], v[116:117], v[20:21]
    v_pk_add_f32 v[118:119], v[118:119], v[22:23]
    v_cvt_pk_bf16_f32 v174, v116, v117
    v_cvt_pk_bf16_f32 v176, v118, v119
    buffer_store_dwordx4 v[172:175], v102, s[24:27], s47 offen offset:0 sc1
    s_waitcnt lgkmcnt(12)
    v_pk_add_f32 v[120:121], v[120:121], v[24:25]
    v_pk_add_f32 v[122:123], v[122:123], v[26:27]
    v_cvt_pk_bf16_f32 v177, v120, v121
    v_cvt_pk_bf16_f32 v178, v122, v123
    buffer_store_dwordx4 v[176:179], v102, s[24:27], s47 offen offset:1024 sc1
    s_waitcnt lgkmcnt(11)
    v_pk_add_f32 v[124:125], v[124:125], v[28:29]
    v_pk_add_f32 v[126:127], v[126:127], v[30:31]
    v_cvt_pk_bf16_f32 v180, v124, v125
    v_cvt_pk_bf16_f32 v181, v126, v127
    s_waitcnt lgkmcnt(10)
    v_pk_add_f32 v[128:129], v[128:129], v[32:33]
    v_pk_add_f32 v[130:131], v[130:131], v[34:35]
    v_cvt_pk_bf16_f32 v182, v128, v129
    v_cvt_pk_bf16_f32 v184, v130, v131
    buffer_store_dwordx4 v[180:183], v102, s[24:27], s47 offen offset:2048 sc1
    s_waitcnt lgkmcnt(9)
    v_pk_add_f32 v[132:133], v[132:133], v[36:37]
    v_pk_add_f32 v[134:135], v[134:135], v[38:39]
    v_cvt_pk_bf16_f32 v185, v132, v133
    v_cvt_pk_bf16_f32 v186, v134, v135
    buffer_store_dwordx4 v[184:187], v102, s[24:27], s47 offen offset:3072 sc1
    s_add_u32 s47, s47, 4096
    s_waitcnt lgkmcnt(8)
    v_pk_add_f32 v[136:137], v[136:137], v[40:41]
    v_pk_add_f32 v[138:139], v[138:139], v[42:43]
    v_cvt_pk_bf16_f32 v188, v136, v137
    v_cvt_pk_bf16_f32 v189, v138, v139
    s_waitcnt lgkmcnt(7)
    v_pk_add_f32 v[140:141], v[140:141], v[44:45]
    v_pk_add_f32 v[142:143], v[142:143], v[46:47]
    v_cvt_pk_bf16_f32 v190, v140, v141
    v_cvt_pk_bf16_f32 v192, v142, v143
    buffer_store_dwordx4 v[188:191], v102, s[24:27], s47 offen offset:0 sc1
    s_waitcnt lgkmcnt(6)
    v_pk_add_f32 v[144:145], v[144:145], v[48:49]
    v_pk_add_f32 v[146:147], v[146:147], v[50:51]
    v_cvt_pk_bf16_f32 v193, v144, v145
    v_cvt_pk_bf16_f32 v194, v146, v147
    buffer_store_dwordx4 v[192:195], v102, s[24:27], s47 offen offset:1024 sc1
    s_waitcnt lgkmcnt(5)
    v_pk_add_f32 v[148:149], v[148:149], v[52:53]
    v_pk_add_f32 v[150:151], v[150:151], v[54:55]
    v_cvt_pk_bf16_f32 v196, v148, v149
    v_cvt_pk_bf16_f32 v197, v150, v151
    s_waitcnt lgkmcnt(4)
    v_pk_add_f32 v[152:153], v[152:153], v[56:57]
    v_pk_add_f32 v[154:155], v[154:155], v[58:59]
    v_cvt_pk_bf16_f32 v198, v152, v153
    v_cvt_pk_bf16_f32 v200, v154, v155
    buffer_store_dwordx4 v[196:199], v102, s[24:27], s47 offen offset:2048 sc1
    s_waitcnt lgkmcnt(3)
    v_pk_add_f32 v[156:157], v[156:157], v[60:61]
    v_pk_add_f32 v[158:159], v[158:159], v[62:63]
    v_cvt_pk_bf16_f32 v201, v156, v157
    v_cvt_pk_bf16_f32 v202, v158, v159
    buffer_store_dwordx4 v[200:203], v102, s[24:27], s47 offen offset:3072 sc1
    s_add_u32 s47, s47, 4096
    s_waitcnt lgkmcnt(2)
    v_pk_add_f32 v[160:161], v[160:161], v[64:65]
    v_pk_add_f32 v[162:163], v[162:163], v[66:67]
    v_cvt_pk_bf16_f32 v204, v160, v161
    v_cvt_pk_bf16_f32 v205, v162, v163
    s_waitcnt lgkmcnt(1)
    v_pk_add_f32 v[164:165], v[164:165], v[68:69]
    v_pk_add_f32 v[166:167], v[166:167], v[70:71]
    v_cvt_pk_bf16_f32 v206, v164, v165
    v_cvt_pk_bf16_f32 v208, v166, v167
    buffer_store_dwordx4 v[204:207], v102, s[24:27], s47 offen offset:0 sc1
    s_waitcnt lgkmcnt(0)
    v_pk_add_f32 v[168:169], v[168:169], v[72:73]
    v_pk_add_f32 v[170:171], v[170:171], v[74:75]
    v_cvt_pk_bf16_f32 v209, v168, v169
    v_cvt_pk_bf16_f32 v210, v170, v171
    buffer_store_dwordx4 v[208:211], v102, s[24:27], s47 offen offset:1024 sc1
    v_and_b32 v10, 15, v1
    v_mul_u32_u24 v10, 2304, v10
    v_lshrrev_b32 v11, 4, v1
    v_lshl_add_u32 v10, v11, 3, v10
    v_and_b32 v13, 3, v1
    v_mul_u32_u24 v13, 40960, v13
    s_mul_i32 s52, s52, 163840
    s_add_u32 s52, s52, 16777216
    s_mul_i32 s53, s31, 221184
    s_mul_i32 s3, s29, 1152
    s_add_u32 s53, s53, s3
    s_mul_i32 s3, s32, 288
    s_add_u32 s53, s53, s3
    s_lshl_b32 s54, s30, 2
    s_add_u32 s54, s54, s28
    s_mov_b32 s8, s78
    s_mov_b32 s9, s79
    s_mov_b32 s10, 1769472
    s_mov_b32 s11, 0x20000
    s_add_u32 s3, s54, 0
    s_cmp_ge_u32 s3, 10
    s_cselect_b32 s4, 1, 0
    s_cselect_b32 s5, 10, 0
    s_cselect_b32 s60, 4, 5
    s_sub_u32 s3, s3, s5
    s_cmp_ge_u32 s3, s60
    s_cselect_b32 s5, 1, 0
    s_cselect_b32 s60, s60, 0
    s_sub_u32 s3, s3, s60
    s_lshl_b32 s60, s4, 1
    s_add_u32 s60, s60, s5
    s_mul_i32 s60, s60, 10240
    s_lshl_b32 s61, s3, 11
    s_add_u32 s56, s60, s61
    s_add_u32 s56, s56, s52
    s_mul_i32 s57, s5, 110592
    s_add_u32 s57, s57, s53
    s_sub_u32 s60, 8, s3
    s_cmp_eq_u32 s4, 1
    s_cselect_b32 s3, s60, s3
    s_lshl_b32 s3, s3, 5
    s_add_u32 s57, s57, s3
    s_cmp_lt_u32 s54, 2
    s_cbranch_scc1 L_two
    s_mov_b32 s4, 0x100000
L_pp1:
    buffer_load_dword v12, v13, s[24:27], s56 offen offset:2044 sc1
    s_sub_u32 s4, s4, 1
    s_waitcnt vmcnt(0)
    v_cmp_ne_u32 vcc, s75, v12
    s_cbranch_vccz L_pd1
    s_cmp_lg_u32 s4, 0
    s_sleep 1
    s_cbranch_scc1 L_pp1
L_pd1:
    s_mov_b32 s47, s56
    buffer_load_dwordx4 v[16:19], v102, s[24:27], s47 offen sc1
    buffer_load_dwordx4 v[20:23], v102, s[24:27], s47 offen offset:1024 sc1
    s_add_u32 s47, s47, 40960
    buffer_load_dwordx4 v[24:27], v102, s[24:27], s47 offen sc1
    buffer_load_dwordx4 v[28:31], v102, s[24:27], s47 offen offset:1024 sc1
    s_add_u32 s47, s47, 40960
    buffer_load_dwordx4 v[32:35], v102, s[24:27], s47 offen sc1
    buffer_load_dwordx4 v[36:39], v102, s[24:27], s47 offen offset:1024 sc1
    s_add_u32 s47, s47, 40960
    buffer_load_dwordx4 v[40:43], v102, s[24:27], s47 offen sc1
    buffer_load_dwordx4 v[44:47], v102, s[24:27], s47 offen offset:1024 sc1
    s_waitcnt vmcnt(6)
    v_xor_b32 v19, s75, v19
    v_xor_b32 v23, s75, v23
    v_or_b32 v11, v19, v23
    v_lshlrev_b32 v112, 16, v16
    v_and_b32 v113, 0xffff0000, v16
    v_lshlrev_b32 v114, 16, v17
    v_and_b32 v115, 0xffff0000, v17
    v_lshlrev_b32 v116, 16, v18
    v_and_b32 v117, 0xffff0000, v18
    v_lshlrev_b32 v118, 16, v20
    v_and_b32 v119, 0xffff0000, v20
    v_lshlrev_b32 v120, 16, v21
    v_and_b32 v121, 0xffff0000, v21
    v_lshlrev_b32 v122, 16, v22
    v_and_b32 v123, 0xffff0000, v22
    s_waitcnt vmcnt(4)
    v_xor_b32 v27, s75, v27
    v_xor_b32 v31, s75, v31
    v_or3_b32 v11, v11, v27, v31
    v_lshlrev_b32 v124, 16, v24
    v_and_b32 v24, 0xffff0000, v24
    v_add_f32 v112, v112, v124
    v_add_f32 v113, v113, v24
    v_lshlrev_b32 v124, 16, v25
    v_and_b32 v25, 0xffff0000, v25
    v_add_f32 v114, v114, v124
    v_add_f32 v115, v115, v25
    v_lshlrev_b32 v124, 16, v26
    v_and_b32 v26, 0xffff0000, v26
    v_add_f32 v116, v116, v124
    v_add_f32 v117, v117, v26
    v_lshlrev_b32 v124, 16, v28
    v_and_b32 v28, 0xffff0000, v28
    v_add_f32 v118, v118, v124
    v_add_f32 v119, v119, v28
    v_lshlrev_b32 v124, 16, v29
    v_and_b32 v29, 0xffff0000, v29
    v_add_f32 v120, v120, v124
    v_add_f32 v121, v121, v29
    v_lshlrev_b32 v124, 16, v30
    v_and_b32 v30, 0xffff0000, v30
    v_add_f32 v122, v122, v124
    v_add_f32 v123, v123, v30
    s_waitcnt vmcnt(2)
    v_xor_b32 v35, s75, v35
    v_xor_b32 v39, s75, v39
    v_or3_b32 v11, v11, v35, v39
    v_lshlrev_b32 v124, 16, v32
    v_and_b32 v32, 0xffff0000, v32
    v_add_f32 v112, v112, v124
    v_add_f32 v113, v113, v32
    v_lshlrev_b32 v124, 16, v33
    v_and_b32 v33, 0xffff0000, v33
    v_add_f32 v114, v114, v124
    v_add_f32 v115, v115, v33
    v_lshlrev_b32 v124, 16, v34
    v_and_b32 v34, 0xffff0000, v34
    v_add_f32 v116, v116, v124
    v_add_f32 v117, v117, v34
    v_lshlrev_b32 v124, 16, v36
    v_and_b32 v36, 0xffff0000, v36
    v_add_f32 v118, v118, v124
    v_add_f32 v119, v119, v36
    v_lshlrev_b32 v124, 16, v37
    v_and_b32 v37, 0xffff0000, v37
    v_add_f32 v120, v120, v124
    v_add_f32 v121, v121, v37
    v_lshlrev_b32 v124, 16, v38
    v_and_b32 v38, 0xffff0000, v38
    v_add_f32 v122, v122, v124
    v_add_f32 v123, v123, v38
    s_waitcnt vmcnt(0)
    v_xor_b32 v43, s75, v43
    v_xor_b32 v47, s75, v47
    v_or3_b32 v11, v11, v43, v47
    v_lshlrev_b32 v124, 16, v40
    v_and_b32 v40, 0xffff0000, v40
    v_add_f32 v112, v112, v124
    v_add_f32 v113, v113, v40
    v_lshlrev_b32 v124, 16, v41
    v_and_b32 v41, 0xffff0000, v41
    v_add_f32 v114, v114, v124
    v_add_f32 v115, v115, v41
    v_lshlrev_b32 v124, 16, v42
    v_and_b32 v42, 0xffff0000, v42
    v_add_f32 v116, v116, v124
    v_add_f32 v117, v117, v42
    v_lshlrev_b32 v124, 16, v44
    v_and_b32 v44, 0xffff0000, v44
    v_add_f32 v118, v118, v124
    v_add_f32 v119, v119, v44
    v_lshlrev_b32 v124, 16, v45
    v_and_b32 v45, 0xffff0000, v45
    v_add_f32 v120, v120, v124
    v_add_f32 v121, v121, v45
    v_lshlrev_b32 v124, 16, v46
    v_and_b32 v46, 0xffff0000, v46
    v_add_f32 v122, v122, v124
    v_add_f32 v123, v123, v46
    v_cmp_ne_u32 vcc, 0, v11
    s_cbranch_vccz L_ok1
    s_sub_u32 s4, s4, 1
    s_cmp_gt_i32 s4, 0
    s_cbranch_scc1 L_pd1
L_ok1:
    v_cvt_pk_bf16_f32 v112, v112, v113
    v_cvt_pk_bf16_f32 v113, v114, v115
    v_cvt_pk_bf16_f32 v114, v116, v117
    v_cvt_pk_bf16_f32 v115, v118, v119
    v_cvt_pk_bf16_f32 v116, v120, v121
    v_cvt_pk_bf16_f32 v117, v122, v123
    buffer_store_dwordx2 v[112:113], v10, s[8:11], s57 offen
    s_add_u32 s57, s57, 36864
    buffer_store_dwordx2 v[114:115], v10, s[8:11], s57 offen
    s_add_u32 s57, s57, 36864
    buffer_store_dwordx2 v[116:117], v10, s[8:11], s57 offen
    s_branch L_rd2
L_two:
    s_add_u32 s3, s54, 16
    s_cmp_ge_u32 s3, 10
    s_cselect_b32 s4, 1, 0
    s_cselect_b32 s5, 10, 0
    s_cselect_b32 s60, 4, 5
    s_sub_u32 s3, s3, s5
    s_cmp_ge_u32 s3, s60
    s_cselect_b32 s5, 1, 0
    s_cselect_b32 s60, s60, 0
    s_sub_u32 s3, s3, s60
    s_lshl_b32 s60, s4, 1
    s_add_u32 s60, s60, s5
    s_mul_i32 s60, s60, 10240
    s_lshl_b32 s61, s3, 11
    s_add_u32 s58, s60, s61
    s_add_u32 s58, s58, s52
    s_mul_i32 s59, s5, 110592
    s_add_u32 s59, s59, s53
    s_sub_u32 s60, 8, s3
    s_cmp_eq_u32 s4, 1
    s_cselect_b32 s3, s60, s3
    s_lshl_b32 s3, s3, 5
    s_add_u32 s59, s59, s3
    s_mov_b32 s4, 0x100000
    s_sub_u32 s3, s58, s56
    v_bfe_u32 v11, v1, 2, 1
    v_mul_lo_u32 v11, v11, s3
    v_add_u32 v13, v13, v11
L_pp2:
    buffer_load_dword v12, v13, s[24:27], s56 offen offset:2044 sc1
    s_sub_u32 s4, s4, 1
    s_waitcnt vmcnt(0)
    v_cmp_ne_u32 vcc, s75, v12
    s_cbranch_vccz L_pd2
    s_cmp_lg_u32 s4, 0
    s_sleep 1
    s_cbranch_scc1 L_pp2
L_pd2:
    s_mov_b32 s47, s56
    buffer_load_dwordx4 v[16:19], v102, s[24:27], s47 offen sc1
    buffer_load_dwordx4 v[20:23], v102, s[24:27], s47 offen offset:1024 sc1
    s_add_u32 s47, s47, 40960
    buffer_load_dwordx4 v[24:27], v102, s[24:27], s47 offen sc1
    buffer_load_dwordx4 v[28:31], v102, s[24:27], s47 offen offset:1024 sc1
    s_add_u32 s47, s47, 40960
    buffer_load_dwordx4 v[32:35], v102, s[24:27], s47 offen sc1
    buffer_load_dwordx4 v[36:39], v102, s[24:27], s47 offen offset:1024 sc1
    s_add_u32 s47, s47, 40960
    buffer_load_dwordx4 v[40:43], v102, s[24:27], s47 offen sc1
    buffer_load_dwordx4 v[44:47], v102, s[24:27], s47 offen offset:1024 sc1
    s_mov_b32 s47, s58
    buffer_load_dwordx4 v[48:51], v102, s[24:27], s47 offen sc1
    buffer_load_dwordx4 v[52:55], v102, s[24:27], s47 offen offset:1024 sc1
    s_add_u32 s47, s47, 40960
    buffer_load_dwordx4 v[56:59], v102, s[24:27], s47 offen sc1
    buffer_load_dwordx4 v[60:63], v102, s[24:27], s47 offen offset:1024 sc1
    s_add_u32 s47, s47, 40960
    buffer_load_dwordx4 v[64:67], v102, s[24:27], s47 offen sc1
    buffer_load_dwordx4 v[68:71], v102, s[24:27], s47 offen offset:1024 sc1
    s_add_u32 s47, s47, 40960
    buffer_load_dwordx4 v[72:75], v102, s[24:27], s47 offen sc1
    buffer_load_dwordx4 v[76:79], v102, s[24:27], s47 offen offset:1024 sc1
    s_waitcnt vmcnt(14)
    v_xor_b32 v19, s75, v19
    v_xor_b32 v23, s75, v23
    v_or_b32 v11, v19, v23
    v_lshlrev_b32 v112, 16, v16
    v_and_b32 v113, 0xffff0000, v16
    v_lshlrev_b32 v114, 16, v17
    v_and_b32 v115, 0xffff0000, v17
    v_lshlrev_b32 v116, 16, v18
    v_and_b32 v117, 0xffff0000, v18
    v_lshlrev_b32 v118, 16, v20
    v_and_b32 v119, 0xffff0000, v20
    v_lshlrev_b32 v120, 16, v21
    v_and_b32 v121, 0xffff0000, v21
    v_lshlrev_b32 v122, 16, v22
    v_and_b32 v123, 0xffff0000, v22
    s_waitcnt vmcnt(12)
    v_xor_b32 v27, s75, v27
    v_xor_b32 v31, s75, v31
    v_or3_b32 v11, v11, v27, v31
    v_lshlrev_b32 v124, 16, v24
    v_and_b32 v24, 0xffff0000, v24
    v_add_f32 v112, v112, v124
    v_add_f32 v113, v113, v24
    v_lshlrev_b32 v124, 16, v25
    v_and_b32 v25, 0xffff0000, v25
    v_add_f32 v114, v114, v124
    v_add_f32 v115, v115, v25
    v_lshlrev_b32 v124, 16, v26
    v_and_b32 v26, 0xffff0000, v26
    v_add_f32 v116, v116, v124
    v_add_f32 v117, v117, v26
    v_lshlrev_b32 v124, 16, v28
    v_and_b32 v28, 0xffff0000, v28
    v_add_f32 v118, v118, v124
    v_add_f32 v119, v119, v28
    v_lshlrev_b32 v124, 16, v29
    v_and_b32 v29, 0xffff0000, v29
    v_add_f32 v120, v120, v124
    v_add_f32 v121, v121, v29
    v_lshlrev_b32 v124, 16, v30
    v_and_b32 v30, 0xffff0000, v30
    v_add_f32 v122, v122, v124
    v_add_f32 v123, v123, v30
    s_waitcnt vmcnt(10)
    v_xor_b32 v35, s75, v35
    v_xor_b32 v39, s75, v39
    v_or3_b32 v11, v11, v35, v39
    v_lshlrev_b32 v124, 16, v32
    v_and_b32 v32, 0xffff0000, v32
    v_add_f32 v112, v112, v124
    v_add_f32 v113, v113, v32
    v_lshlrev_b32 v124, 16, v33
    v_and_b32 v33, 0xffff0000, v33
    v_add_f32 v114, v114, v124
    v_add_f32 v115, v115, v33
    v_lshlrev_b32 v124, 16, v34
    v_and_b32 v34, 0xffff0000, v34
    v_add_f32 v116, v116, v124
    v_add_f32 v117, v117, v34
    v_lshlrev_b32 v124, 16, v36
    v_and_b32 v36, 0xffff0000, v36
    v_add_f32 v118, v118, v124
    v_add_f32 v119, v119, v36
    v_lshlrev_b32 v124, 16, v37
    v_and_b32 v37, 0xffff0000, v37
    v_add_f32 v120, v120, v124
    v_add_f32 v121, v121, v37
    v_lshlrev_b32 v124, 16, v38
    v_and_b32 v38, 0xffff0000, v38
    v_add_f32 v122, v122, v124
    v_add_f32 v123, v123, v38
    s_waitcnt vmcnt(8)
    v_xor_b32 v43, s75, v43
    v_xor_b32 v47, s75, v47
    v_or3_b32 v11, v11, v43, v47
    v_lshlrev_b32 v124, 16, v40
    v_and_b32 v40, 0xffff0000, v40
    v_add_f32 v112, v112, v124
    v_add_f32 v113, v113, v40
    v_lshlrev_b32 v124, 16, v41
    v_and_b32 v41, 0xffff0000, v41
    v_add_f32 v114, v114, v124
    v_add_f32 v115, v115, v41
    v_lshlrev_b32 v124, 16, v42
    v_and_b32 v42, 0xffff0000, v42
    v_add_f32 v116, v116, v124
    v_add_f32 v117, v117, v42
    v_lshlrev_b32 v124, 16, v44
    v_and_b32 v44, 0xffff0000, v44
    v_add_f32 v118, v118, v124
    v_add_f32 v119, v119, v44
    v_lshlrev_b32 v124, 16, v45
    v_and_b32 v45, 0xffff0000, v45
    v_add_f32 v120, v120, v124
    v_add_f32 v121, v121, v45
    v_lshlrev_b32 v124, 16, v46
    v_and_b32 v46, 0xffff0000, v46
    v_add_f32 v122, v122, v124
    v_add_f32 v123, v123, v46
    s_waitcnt vmcnt(6)
    v_xor_b32 v51, s75, v51
    v_xor_b32 v55, s75, v55
    v_or3_b32 v11, v11, v51, v55
    v_lshlrev_b32 v128, 16, v48
    v_and_b32 v129, 0xffff0000, v48
    v_lshlrev_b32 v130, 16, v49
    v_and_b32 v131, 0xffff0000, v49
    v_lshlrev_b32 v132, 16, v50
    v_and_b32 v133, 0xffff0000, v50
    v_lshlrev_b32 v134, 16, v52
    v_and_b32 v135, 0xffff0000, v52
    v_lshlrev_b32 v136, 16, v53
    v_and_b32 v137, 0xffff0000, v53
    v_lshlrev_b32 v138, 16, v54
    v_and_b32 v139, 0xffff0000, v54
    s_waitcnt vmcnt(4)
    v_xor_b32 v59, s75, v59
    v_xor_b32 v63, s75, v63
    v_or3_b32 v11, v11, v59, v63
    v_lshlrev_b32 v140, 16, v56
    v_and_b32 v56, 0xffff0000, v56
    v_add_f32 v128, v128, v140
    v_add_f32 v129, v129, v56
    v_lshlrev_b32 v140, 16, v57
    v_and_b32 v57, 0xffff0000, v57
    v_add_f32 v130, v130, v140
    v_add_f32 v131, v131, v57
    v_lshlrev_b32 v140, 16, v58
    v_and_b32 v58, 0xffff0000, v58
    v_add_f32 v132, v132, v140
    v_add_f32 v133, v133, v58
    v_lshlrev_b32 v140, 16, v60
    v_and_b32 v60, 0xffff0000, v60
    v_add_f32 v134, v134, v140
    v_add_f32 v135, v135, v60
    v_lshlrev_b32 v140, 16, v61
    v_and_b32 v61, 0xffff0000, v61
    v_add_f32 v136, v136, v140
    v_add_f32 v137, v137, v61
    v_lshlrev_b32 v140, 16, v62
    v_and_b32 v62, 0xffff0000, v62
    v_add_f32 v138, v138, v140
    v_add_f32 v139, v139, v62
    s_waitcnt vmcnt(2)
    v_xor_b32 v67, s75, v67
    v_xor_b32 v71, s75, v71
    v_or3_b32 v11, v11, v67, v71
    v_lshlrev_b32 v140, 16, v64
    v_and_b32 v64, 0xffff0000, v64
    v_add_f32 v128, v128, v140
    v_add_f32 v129, v129, v64
    v_lshlrev_b32 v140, 16, v65
    v_and_b32 v65, 0xffff0000, v65
    v_add_f32 v130, v130, v140
    v_add_f32 v131, v131, v65
    v_lshlrev_b32 v140, 16, v66
    v_and_b32 v66, 0xffff0000, v66
    v_add_f32 v132, v132, v140
    v_add_f32 v133, v133, v66
    v_lshlrev_b32 v140, 16, v68
    v_and_b32 v68, 0xffff0000, v68
    v_add_f32 v134, v134, v140
    v_add_f32 v135, v135, v68
    v_lshlrev_b32 v140, 16, v69
    v_and_b32 v69, 0xffff0000, v69
    v_add_f32 v136, v136, v140
    v_add_f32 v137, v137, v69
    v_lshlrev_b32 v140, 16, v70
    v_and_b32 v70, 0xffff0000, v70
    v_add_f32 v138, v138, v140
    v_add_f32 v139, v139, v70
    s_waitcnt vmcnt(0)
    v_xor_b32 v75, s75, v75
    v_xor_b32 v79, s75, v79
    v_or3_b32 v11, v11, v75, v79
    v_lshlrev_b32 v140, 16, v72
    v_and_b32 v72, 0xffff0000, v72
    v_add_f32 v128, v128, v140
    v_add_f32 v129, v129, v72
    v_lshlrev_b32 v140, 16, v73
    v_and_b32 v73, 0xffff0000, v73
    v_add_f32 v130, v130, v140
    v_add_f32 v131, v131, v73
    v_lshlrev_b32 v140, 16, v74
    v_and_b32 v74, 0xffff0000, v74
    v_add_f32 v132, v132, v140
    v_add_f32 v133, v133, v74
    v_lshlrev_b32 v140, 16, v76
    v_and_b32 v76, 0xffff0000, v76
    v_add_f32 v134, v134, v140
    v_add_f32 v135, v135, v76
    v_lshlrev_b32 v140, 16, v77
    v_and_b32 v77, 0xffff0000, v77
    v_add_f32 v136, v136, v140
    v_add_f32 v137, v137, v77
    v_lshlrev_b32 v140, 16, v78
    v_and_b32 v78, 0xffff0000, v78
    v_add_f32 v138, v138, v140
    v_add_f32 v139, v139, v78
    v_cmp_ne_u32 vcc, 0, v11
    s_cbranch_vccz L_ok2
    s_sub_u32 s4, s4, 1
    s_cmp_gt_i32 s4, 0
    s_cbranch_scc1 L_pd2
L_ok2:
    v_cvt_pk_bf16_f32 v112, v112, v113
    v_cvt_pk_bf16_f32 v113, v114, v115
    v_cvt_pk_bf16_f32 v114, v116, v117
    v_cvt_pk_bf16_f32 v115, v118, v119
    v_cvt_pk_bf16_f32 v116, v120, v121
    v_cvt_pk_bf16_f32 v117, v122, v123
    buffer_store_dwordx2 v[112:113], v10, s[8:11], s57 offen
    s_add_u32 s57, s57, 36864
    buffer_store_dwordx2 v[114:115], v10, s[8:11], s57 offen
    s_add_u32 s57, s57, 36864
    buffer_store_dwordx2 v[116:117], v10, s[8:11], s57 offen
    v_cvt_pk_bf16_f32 v128, v128, v129
    v_cvt_pk_bf16_f32 v129, v130, v131
    v_cvt_pk_bf16_f32 v130, v132, v133
    v_cvt_pk_bf16_f32 v131, v134, v135
    v_cvt_pk_bf16_f32 v132, v136, v137
    v_cvt_pk_bf16_f32 v133, v138, v139
    buffer_store_dwordx2 v[128:129], v10, s[8:11], s59 offen
    s_add_u32 s59, s59, 36864
    buffer_store_dwordx2 v[130:131], v10, s[8:11], s59 offen
    s_add_u32 s59, s59, 36864
    buffer_store_dwordx2 v[132:133], v10, s[8:11], s59 offen
L_rd2:
L_done:
    s_endpgm
L_end:
L_rare0:
    s_nop 15
    v_mov_b32 v84, v23
    s_nop 1
    v_permlane32_swap_b32 v23, v84
    s_nop 1
    v_max3_f32 v23, v23, v84, 0
    v_sub_f32 v86, 0, v23
    v_exp_f32 v86, v86
    v_sub_f32 v32, v32, v23
    v_sub_f32 v112, v112, v23
    v_sub_f32 v33, v33, v23
    v_sub_f32 v113, v113, v23
    v_sub_f32 v34, v34, v23
    v_sub_f32 v114, v114, v23
    v_sub_f32 v35, v35, v23
    v_sub_f32 v115, v115, v23
    v_sub_f32 v36, v36, v23
    v_sub_f32 v116, v116, v23
    v_sub_f32 v37, v37, v23
    v_sub_f32 v117, v117, v23
    v_sub_f32 v38, v38, v23
    v_sub_f32 v118, v118, v23
    v_sub_f32 v39, v39, v23
    v_sub_f32 v119, v119, v23
    v_sub_f32 v40, v40, v23
    v_sub_f32 v120, v120, v23
    v_sub_f32 v41, v41, v23
    v_sub_f32 v121, v121, v23
    v_sub_f32 v42, v42, v23
    v_sub_f32 v122, v122, v23
    v_sub_f32 v43, v43, v23
    v_sub_f32 v123, v123, v23
    v_sub_f32 v44, v44, v23
    v_sub_f32 v124, v124, v23
    v_sub_f32 v45, v45, v23
    v_sub_f32 v125, v125, v23
    v_sub_f32 v46, v46, v23
    v_sub_f32 v126, v126, v23
    v_sub_f32 v47, v47, v23
    v_sub_f32 v127, v127, v23
    v_mul_f32 v20, v20, v86
    v_accvgpr_read_b32 v84, a0
    v_accvgpr_read_b32 v85, a1
    v_mul_f32 v84, v84, v86
    v_mul_f32 v85, v85, v86
    v_accvgpr_write_b32 a0, v84
    v_accvgpr_write_b32 a1, v85
    v_accvgpr_read_b32 v84, a2
    v_accvgpr_read_b32 v85, a3
    v_mul_f32 v84, v84, v86
    v_mul_f32 v85, v85, v86
    v_accvgpr_write_b32 a2, v84
    v_accvgpr_write_b32 a3, v85
    v_accvgpr_read_b32 v84, a4
    v_accvgpr_read_b32 v85, a5
    v_mul_f32 v84, v84, v86
    v_mul_f32 v85, v85, v86
    v_accvgpr_write_b32 a4, v84
    v_accvgpr_write_b32 a5, v85
    v_accvgpr_read_b32 v84, a6
    v_accvgpr_read_b32 v85, a7
    v_mul_f32 v84, v84, v86
    v_mul_f32 v85, v85, v86
    v_accvgpr_write_b32 a6, v84
    v_accvgpr_write_b32 a7, v85
    v_accvgpr_read_b32 v84, a8
    v_accvgpr_read_b32 v85, a9
    v_mul_f32 v84, v84, v86
    v_mul_f32 v85, v85, v86
    v_accvgpr_write_b32 a8, v84
    v_accvgpr_write_b32 a9, v85
    v_accvgpr_read_b32 v84, a10
    v_accvgpr_read_b32 v85, a11
    v_mul_f32 v84, v84, v86
    v_mul_f32 v85, v85, v86
    v_accvgpr_write_b32 a10, v84
    v_accvgpr_write_b32 a11, v85
    v_accvgpr_read_b32 v84, a12
    v_accvgpr_read_b32 v85, a13
    v_mul_f32 v84, v84, v86
    v_mul_f32 v85, v85, v86
    v_accvgpr_write_b32 a12, v84
    v_accvgpr_write_b32 a13, v85
    v_accvgpr_read_b32 v84, a14
    v_accvgpr_read_b32 v85, a15
    v_mul_f32 v84, v84, v86
    v_mul_f32 v85, v85, v86
    v_accvgpr_write_b32 a14, v84
    v_accvgpr_write_b32 a15, v85
    v_accvgpr_read_b32 v84, a48
    v_accvgpr_read_b32 v85, a49
    v_mul_f32 v84, v84, v86
    v_mul_f32 v85, v85, v86
    v_accvgpr_write_b32 a48, v84
    v_accvgpr_write_b32 a49, v85
    v_accvgpr_read_b32 v84, a50
    v_accvgpr_read_b32 v85, a51
    v_mul_f32 v84, v84, v86
    v_mul_f32 v85, v85, v86
    v_accvgpr_write_b32 a50, v84
    v_accvgpr_write_b32 a51, v85
    v_accvgpr_read_b32 v84, a52
    v_accvgpr_read_b32 v85, a53
    v_mul_f32 v84, v84, v86
    v_mul_f32 v85, v85, v86
    v_accvgpr_write_b32 a52, v84
    v_accvgpr_write_b32 a53, v85
    v_accvgpr_read_b32 v84, a54
    v_accvgpr_read_b32 v85, a55
    v_mul_f32 v84, v84, v86
    v_mul_f32 v85, v85, v86
    v_accvgpr_write_b32 a54, v84
    v_accvgpr_write_b32 a55, v85
    v_accvgpr_read_b32 v84, a56
    v_accvgpr_read_b32 v85, a57
    v_mul_f32 v84, v84, v86
    v_mul_f32 v85, v85, v86
    v_accvgpr_write_b32 a56, v84
    v_accvgpr_write_b32 a57, v85
    v_accvgpr_read_b32 v84, a58
    v_accvgpr_read_b32 v85, a59
    v_mul_f32 v84, v84, v86
    v_mul_f32 v85, v85, v86
    v_accvgpr_write_b32 a58, v84
    v_accvgpr_write_b32 a59, v85
    v_accvgpr_read_b32 v84, a60
    v_accvgpr_read_b32 v85, a61
    v_mul_f32 v84, v84, v86
    v_mul_f32 v85, v85, v86
    v_accvgpr_write_b32 a60, v84
    v_accvgpr_write_b32 a61, v85
    v_accvgpr_read_b32 v84, a62
    v_accvgpr_read_b32 v85, a63
    v_mul_f32 v84, v84, v86
    v_mul_f32 v85, v85, v86
    v_accvgpr_write_b32 a62, v84
    v_accvgpr_write_b32 a63, v85
    v_accvgpr_read_b32 v84, a96
    v_accvgpr_read_b32 v85, a97
    v_mul_f32 v84, v84, v86
    v_mul_f32 v85, v85, v86
    v_accvgpr_write_b32 a96, v84
    v_accvgpr_write_b32 a97, v85
    v_accvgpr_read_b32 v84, a98
    v_accvgpr_read_b32 v85, a99
    v_mul_f32 v84, v84, v86
    v_mul_f32 v85, v85, v86
    v_accvgpr_write_b32 a98, v84
    v_accvgpr_write_b32 a99, v85
    v_accvgpr_read_b32 v84, a100
    v_accvgpr_read_b32 v85, a101
    v_mul_f32 v84, v84, v86
    v_mul_f32 v85, v85, v86
    v_accvgpr_write_b32 a100, v84
    v_accvgpr_write_b32 a101, v85
    v_accvgpr_read_b32 v84, a102
    v_accvgpr_read_b32 v85, a103
    v_mul_f32 v84, v84, v86
    v_mul_f32 v85, v85, v86
    v_accvgpr_write_b32 a102, v84
    v_accvgpr_write_b32 a103, v85
    v_accvgpr_read_b32 v84, a104
    v_accvgpr_read_b32 v85, a105
    v_mul_f32 v84, v84, v86
    v_mul_f32 v85, v85, v86
    v_accvgpr_write_b32 a104, v84
    v_accvgpr_write_b32 a105, v85
    v_accvgpr_read_b32 v84, a106
    v_accvgpr_read_b32 v85, a107
    v_mul_f32 v84, v84, v86
    v_mul_f32 v85, v85, v86
    v_accvgpr_write_b32 a106, v84
    v_accvgpr_write_b32 a107, v85
    v_accvgpr_read_b32 v84, a108
    v_accvgpr_read_b32 v85, a109
    v_mul_f32 v84, v84, v86
    v_mul_f32 v85, v85, v86
    v_accvgpr_write_b32 a108, v84
    v_accvgpr_write_b32 a109, v85
    v_accvgpr_read_b32 v84, a110
    v_accvgpr_read_b32 v85, a111
    v_mul_f32 v84, v84, v86
    v_mul_f32 v85, v85, v86
    v_accvgpr_write_b32 a110, v84
    v_accvgpr_write_b32 a111, v85
    v_accvgpr_read_b32 v84, a144
    v_accvgpr_read_b32 v85, a145
    v_mul_f32 v84, v84, v86
    v_mul_f32 v85, v85, v86
    v_accvgpr_write_b32 a144, v84
    v_accvgpr_write_b32 a145, v85
    v_accvgpr_read_b32 v84, a146
    v_accvgpr_read_b32 v85, a147
    v_mul_f32 v84, v84, v86
    v_mul_f32 v85, v85, v86
    v_accvgpr_write_b32 a146, v84
    v_accvgpr_write_b32 a147, v85
    v_accvgpr_read_b32 v84, a148
    v_accvgpr_read_b32 v85, a149
    v_mul_f32 v84, v84, v86
    v_mul_f32 v85, v85, v86
    v_accvgpr_write_b32 a148, v84
    v_accvgpr_write_b32 a149, v85
    v_accvgpr_read_b32 v84, a150
    v_accvgpr_read_b32 v85, a151
    v_mul_f32 v84, v84, v86
    v_mul_f32 v85, v85, v86
    v_accvgpr_write_b32 a150, v84
    v_accvgpr_write_b32 a151, v85
    v_accvgpr_read_b32 v84, a152
    v_accvgpr_read_b32 v85, a153
    v_mul_f32 v84, v84, v86
    v_mul_f32 v85, v85, v86
    v_accvgpr_write_b32 a152, v84
    v_accvgpr_write_b32 a153, v85
    v_accvgpr_read_b32 v84, a154
    v_accvgpr_read_b32 v85, a155
    v_mul_f32 v84, v84, v86
    v_mul_f32 v85, v85, v86
    v_accvgpr_write_b32 a154, v84
    v_accvgpr_write_b32 a155, v85
    v_accvgpr_read_b32 v84, a156
    v_accvgpr_read_b32 v85, a157
    v_mul_f32 v84, v84, v86
    v_mul_f32 v85, v85, v86
    v_accvgpr_write_b32 a156, v84
    v_accvgpr_write_b32 a157, v85
    v_accvgpr_read_b32 v84, a158
    v_accvgpr_read_b32 v85, a159
    v_mul_f32 v84, v84, v86
    v_mul_f32 v85, v85, v86
    v_accvgpr_write_b32 a158, v84
    v_accvgpr_write_b32 a159, v85
    s_nop 3
    s_setpc_b64 s[40:41]
L_rare1:
    s_nop 15
    v_mov_b32 v84, v24
    s_nop 1
    v_permlane32_swap_b32 v24, v84
    s_nop 1
    v_max3_f32 v24, v24, v84, 0
    v_sub_f32 v86, 0, v24
    v_exp_f32 v86, v86
    v_sub_f32 v48, v48, v24
    v_sub_f32 v128, v128, v24
    v_sub_f32 v49, v49, v24
    v_sub_f32 v129, v129, v24
    v_sub_f32 v50, v50, v24
    v_sub_f32 v130, v130, v24
    v_sub_f32 v51, v51, v24
    v_sub_f32 v131, v131, v24
    v_sub_f32 v52, v52, v24
    v_sub_f32 v132, v132, v24
    v_sub_f32 v53, v53, v24
    v_sub_f32 v133, v133, v24
    v_sub_f32 v54, v54, v24
    v_sub_f32 v134, v134, v24
    v_sub_f32 v55, v55, v24
    v_sub_f32 v135, v135, v24
    v_sub_f32 v56, v56, v24
    v_sub_f32 v136, v136, v24
    v_sub_f32 v57, v57, v24
    v_sub_f32 v137, v137, v24
    v_sub_f32 v58, v58, v24
    v_sub_f32 v138, v138, v24
    v_sub_f32 v59, v59, v24
    v_sub_f32 v139, v139, v24
    v_sub_f32 v60, v60, v24
    v_sub_f32 v140, v140, v24
    v_sub_f32 v61, v61, v24
    v_sub_f32 v141, v141, v24
    v_sub_f32 v62, v62, v24
    v_sub_f32 v142, v142, v24
    v_sub_f32 v63, v63, v24
    v_sub_f32 v143, v143, v24
    v_mul_f32 v21, v21, v86
    v_accvgpr_read_b32 v84, a16
    v_accvgpr_read_b32 v85, a17
    v_mul_f32 v84, v84, v86
    v_mul_f32 v85, v85, v86
    v_accvgpr_write_b32 a16, v84
    v_accvgpr_write_b32 a17, v85
    v_accvgpr_read_b32 v84, a18
    v_accvgpr_read_b32 v85, a19
    v_mul_f32 v84, v84, v86
    v_mul_f32 v85, v85, v86
    v_accvgpr_write_b32 a18, v84
    v_accvgpr_write_b32 a19, v85
    v_accvgpr_read_b32 v84, a20
    v_accvgpr_read_b32 v85, a21
    v_mul_f32 v84, v84, v86
    v_mul_f32 v85, v85, v86
    v_accvgpr_write_b32 a20, v84
    v_accvgpr_write_b32 a21, v85
    v_accvgpr_read_b32 v84, a22
    v_accvgpr_read_b32 v85, a23
    v_mul_f32 v84, v84, v86
    v_mul_f32 v85, v85, v86
    v_accvgpr_write_b32 a22, v84
    v_accvgpr_write_b32 a23, v85
    v_accvgpr_read_b32 v84, a24
    v_accvgpr_read_b32 v85, a25
    v_mul_f32 v84, v84, v86
    v_mul_f32 v85, v85, v86
    v_accvgpr_write_b32 a24, v84
    v_accvgpr_write_b32 a25, v85
    v_accvgpr_read_b32 v84, a26
    v_accvgpr_read_b32 v85, a27
    v_mul_f32 v84, v84, v86
    v_mul_f32 v85, v85, v86
    v_accvgpr_write_b32 a26, v84
    v_accvgpr_write_b32 a27, v85
    v_accvgpr_read_b32 v84, a28
    v_accvgpr_read_b32 v85, a29
    v_mul_f32 v84, v84, v86
    v_mul_f32 v85, v85, v86
    v_accvgpr_write_b32 a28, v84
    v_accvgpr_write_b32 a29, v85
    v_accvgpr_read_b32 v84, a30
    v_accvgpr_read_b32 v85, a31
    v_mul_f32 v84, v84, v86
    v_mul_f32 v85, v85, v86
    v_accvgpr_write_b32 a30, v84
    v_accvgpr_write_b32 a31, v85
    v_accvgpr_read_b32 v84, a64
    v_accvgpr_read_b32 v85, a65
    v_mul_f32 v84, v84, v86
    v_mul_f32 v85, v85, v86
    v_accvgpr_write_b32 a64, v84
    v_accvgpr_write_b32 a65, v85
    v_accvgpr_read_b32 v84, a66
    v_accvgpr_read_b32 v85, a67
    v_mul_f32 v84, v84, v86
    v_mul_f32 v85, v85, v86
    v_accvgpr_write_b32 a66, v84
    v_accvgpr_write_b32 a67, v85
    v_accvgpr_read_b32 v84, a68
    v_accvgpr_read_b32 v85, a69
    v_mul_f32 v84, v84, v86
    v_mul_f32 v85, v85, v86
    v_accvgpr_write_b32 a68, v84
    v_accvgpr_write_b32 a69, v85
    v_accvgpr_read_b32 v84, a70
    v_accvgpr_read_b32 v85, a71
    v_mul_f32 v84, v84, v86
    v_mul_f32 v85, v85, v86
    v_accvgpr_write_b32 a70, v84
    v_accvgpr_write_b32 a71, v85
    v_accvgpr_read_b32 v84, a72
    v_accvgpr_read_b32 v85, a73
    v_mul_f32 v84, v84, v86
    v_mul_f32 v85, v85, v86
    v_accvgpr_write_b32 a72, v84
    v_accvgpr_write_b32 a73, v85
    v_accvgpr_read_b32 v84, a74
    v_accvgpr_read_b32 v85, a75
    v_mul_f32 v84, v84, v86
    v_mul_f32 v85, v85, v86
    v_accvgpr_write_b32 a74, v84
    v_accvgpr_write_b32 a75, v85
    v_accvgpr_read_b32 v84, a76
    v_accvgpr_read_b32 v85, a77
    v_mul_f32 v84, v84, v86
    v_mul_f32 v85, v85, v86
    v_accvgpr_write_b32 a76, v84
    v_accvgpr_write_b32 a77, v85
    v_accvgpr_read_b32 v84, a78
    v_accvgpr_read_b32 v85, a79
    v_mul_f32 v84, v84, v86
    v_mul_f32 v85, v85, v86
    v_accvgpr_write_b32 a78, v84
    v_accvgpr_write_b32 a79, v85
    v_accvgpr_read_b32 v84, a112
    v_accvgpr_read_b32 v85, a113
    v_mul_f32 v84, v84, v86
    v_mul_f32 v85, v85, v86
    v_accvgpr_write_b32 a112, v84
    v_accvgpr_write_b32 a113, v85
    v_accvgpr_read_b32 v84, a114
    v_accvgpr_read_b32 v85, a115
    v_mul_f32 v84, v84, v86
    v_mul_f32 v85, v85, v86
    v_accvgpr_write_b32 a114, v84
    v_accvgpr_write_b32 a115, v85
    v_accvgpr_read_b32 v84, a116
    v_accvgpr_read_b32 v85, a117
    v_mul_f32 v84, v84, v86
    v_mul_f32 v85, v85, v86
    v_accvgpr_write_b32 a116, v84
    v_accvgpr_write_b32 a117, v85
    v_accvgpr_read_b32 v84, a118
    v_accvgpr_read_b32 v85, a119
    v_mul_f32 v84, v84, v86
    v_mul_f32 v85, v85, v86
    v_accvgpr_write_b32 a118, v84
    v_accvgpr_write_b32 a119, v85
    v_accvgpr_read_b32 v84, a120
    v_accvgpr_read_b32 v85, a121
    v_mul_f32 v84, v84, v86
    v_mul_f32 v85, v85, v86
    v_accvgpr_write_b32 a120, v84
    v_accvgpr_write_b32 a121, v85
    v_accvgpr_read_b32 v84, a122
    v_accvgpr_read_b32 v85, a123
    v_mul_f32 v84, v84, v86
    v_mul_f32 v85, v85, v86
    v_accvgpr_write_b32 a122, v84
    v_accvgpr_write_b32 a123, v85
    v_accvgpr_read_b32 v84, a124
    v_accvgpr_read_b32 v85, a125
    v_mul_f32 v84, v84, v86
    v_mul_f32 v85, v85, v86
    v_accvgpr_write_b32 a124, v84
    v_accvgpr_write_b32 a125, v85
    v_accvgpr_read_b32 v84, a126
    v_accvgpr_read_b32 v85, a127
    v_mul_f32 v84, v84, v86
    v_mul_f32 v85, v85, v86
    v_accvgpr_write_b32 a126, v84
    v_accvgpr_write_b32 a127, v85
    v_accvgpr_read_b32 v84, a160
    v_accvgpr_read_b32 v85, a161
    v_mul_f32 v84, v84, v86
    v_mul_f32 v85, v85, v86
    v_accvgpr_write_b32 a160, v84
    v_accvgpr_write_b32 a161, v85
    v_accvgpr_read_b32 v84, a162
    v_accvgpr_read_b32 v85, a163
    v_mul_f32 v84, v84, v86
    v_mul_f32 v85, v85, v86
    v_accvgpr_write_b32 a162, v84
    v_accvgpr_write_b32 a163, v85
    v_accvgpr_read_b32 v84, a164
    v_accvgpr_read_b32 v85, a165
    v_mul_f32 v84, v84, v86
    v_mul_f32 v85, v85, v86
    v_accvgpr_write_b32 a164, v84
    v_accvgpr_write_b32 a165, v85
    v_accvgpr_read_b32 v84, a166
    v_accvgpr_read_b32 v85, a167
    v_mul_f32 v84, v84, v86
    v_mul_f32 v85, v85, v86
    v_accvgpr_write_b32 a166, v84
    v_accvgpr_write_b32 a167, v85
    v_accvgpr_read_b32 v84, a168
    v_accvgpr_read_b32 v85, a169
    v_mul_f32 v84, v84, v86
    v_mul_f32 v85, v85, v86
    v_accvgpr_write_b32 a168, v84
    v_accvgpr_write_b32 a169, v85
    v_accvgpr_read_b32 v84, a170
    v_accvgpr_read_b32 v85, a171
    v_mul_f32 v84, v84, v86
    v_mul_f32 v85, v85, v86
    v_accvgpr_write_b32 a170, v84
    v_accvgpr_write_b32 a171, v85
    v_accvgpr_read_b32 v84, a172
    v_accvgpr_read_b32 v85, a173
    v_mul_f32 v84, v84, v86
    v_mul_f32 v85, v85, v86
    v_accvgpr_write_b32 a172, v84
    v_accvgpr_write_b32 a173, v85
    v_accvgpr_read_b32 v84, a174
    v_accvgpr_read_b32 v85, a175
    v_mul_f32 v84, v84, v86
    v_mul_f32 v85, v85, v86
    v_accvgpr_write_b32 a174, v84
    v_accvgpr_write_b32 a175, v85
    s_nop 3
    s_setpc_b64 s[40:41]
L_rare2:
    s_nop 15
    v_mov_b32 v84, v25
    s_nop 1
    v_permlane32_swap_b32 v25, v84
    s_nop 1
    v_max3_f32 v25, v25, v84, 0
    v_sub_f32 v86, 0, v25
    v_exp_f32 v86, v86
    v_sub_f32 v64, v64, v25
    v_sub_f32 v144, v144, v25
    v_sub_f32 v65, v65, v25
    v_sub_f32 v145, v145, v25
    v_sub_f32 v66, v66, v25
    v_sub_f32 v146, v146, v25
    v_sub_f32 v67, v67, v25
    v_sub_f32 v147, v147, v25
    v_sub_f32 v68, v68, v25
    v_sub_f32 v148, v148, v25
    v_sub_f32 v69, v69, v25
    v_sub_f32 v149, v149, v25
    v_sub_f32 v70, v70, v25
    v_sub_f32 v150, v150, v25
    v_sub_f32 v71, v71, v25
    v_sub_f32 v151, v151, v25
    v_sub_f32 v72, v72, v25
    v_sub_f32 v152, v152, v25
    v_sub_f32 v73, v73, v25
    v_sub_f32 v153, v153, v25
    v_sub_f32 v74, v74, v25
    v_sub_f32 v154, v154, v25
    v_sub_f32 v75, v75, v25
    v_sub_f32 v155, v155, v25
    v_sub_f32 v76, v76, v25
    v_sub_f32 v156, v156, v25
    v_sub_f32 v77, v77, v25
    v_sub_f32 v157, v157, v25
    v_sub_f32 v78, v78, v25
    v_sub_f32 v158, v158, v25
    v_sub_f32 v79, v79, v25
    v_sub_f32 v159, v159, v25
    v_mul_f32 v22, v22, v86
    v_accvgpr_read_b32 v84, a32
    v_accvgpr_read_b32 v85, a33
    v_mul_f32 v84, v84, v86
    v_mul_f32 v85, v85, v86
    v_accvgpr_write_b32 a32, v84
    v_accvgpr_write_b32 a33, v85
    v_accvgpr_read_b32 v84, a34
    v_accvgpr_read_b32 v85, a35
    v_mul_f32 v84, v84, v86
    v_mul_f32 v85, v85, v86
    v_accvgpr_write_b32 a34, v84
    v_accvgpr_write_b32 a35, v85
    v_accvgpr_read_b32 v84, a36
    v_accvgpr_read_b32 v85, a37
    v_mul_f32 v84, v84, v86
    v_mul_f32 v85, v85, v86
    v_accvgpr_write_b32 a36, v84
    v_accvgpr_write_b32 a37, v85
    v_accvgpr_read_b32 v84, a38
    v_accvgpr_read_b32 v85, a39
    v_mul_f32 v84, v84, v86
    v_mul_f32 v85, v85, v86
    v_accvgpr_write_b32 a38, v84
    v_accvgpr_write_b32 a39, v85
    v_accvgpr_read_b32 v84, a40
    v_accvgpr_read_b32 v85, a41
    v_mul_f32 v84, v84, v86
    v_mul_f32 v85, v85, v86
    v_accvgpr_write_b32 a40, v84
    v_accvgpr_write_b32 a41, v85
    v_accvgpr_read_b32 v84, a42
    v_accvgpr_read_b32 v85, a43
    v_mul_f32 v84, v84, v86
    v_mul_f32 v85, v85, v86
    v_accvgpr_write_b32 a42, v84
    v_accvgpr_write_b32 a43, v85
    v_accvgpr_read_b32 v84, a44
    v_accvgpr_read_b32 v85, a45
    v_mul_f32 v84, v84, v86
    v_mul_f32 v85, v85, v86
    v_accvgpr_write_b32 a44, v84
    v_accvgpr_write_b32 a45, v85
    v_accvgpr_read_b32 v84, a46
    v_accvgpr_read_b32 v85, a47
    v_mul_f32 v84, v84, v86
    v_mul_f32 v85, v85, v86
    v_accvgpr_write_b32 a46, v84
    v_accvgpr_write_b32 a47, v85
    v_accvgpr_read_b32 v84, a80
    v_accvgpr_read_b32 v85, a81
    v_mul_f32 v84, v84, v86
    v_mul_f32 v85, v85, v86
    v_accvgpr_write_b32 a80, v84
    v_accvgpr_write_b32 a81, v85
    v_accvgpr_read_b32 v84, a82
    v_accvgpr_read_b32 v85, a83
    v_mul_f32 v84, v84, v86
    v_mul_f32 v85, v85, v86
    v_accvgpr_write_b32 a82, v84
    v_accvgpr_write_b32 a83, v85
    v_accvgpr_read_b32 v84, a84
    v_accvgpr_read_b32 v85, a85
    v_mul_f32 v84, v84, v86
    v_mul_f32 v85, v85, v86
    v_accvgpr_write_b32 a84, v84
    v_accvgpr_write_b32 a85, v85
    v_accvgpr_read_b32 v84, a86
    v_accvgpr_read_b32 v85, a87
    v_mul_f32 v84, v84, v86
    v_mul_f32 v85, v85, v86
    v_accvgpr_write_b32 a86, v84
    v_accvgpr_write_b32 a87, v85
    v_accvgpr_read_b32 v84, a88
    v_accvgpr_read_b32 v85, a89
    v_mul_f32 v84, v84, v86
    v_mul_f32 v85, v85, v86
    v_accvgpr_write_b32 a88, v84
    v_accvgpr_write_b32 a89, v85
    v_accvgpr_read_b32 v84, a90
    v_accvgpr_read_b32 v85, a91
    v_mul_f32 v84, v84, v86
    v_mul_f32 v85, v85, v86
    v_accvgpr_write_b32 a90, v84
    v_accvgpr_write_b32 a91, v85
    v_accvgpr_read_b32 v84, a92
    v_accvgpr_read_b32 v85, a93
    v_mul_f32 v84, v84, v86
    v_mul_f32 v85, v85, v86
    v_accvgpr_write_b32 a92, v84
    v_accvgpr_write_b32 a93, v85
    v_accvgpr_read_b32 v84, a94
    v_accvgpr_read_b32 v85, a95
    v_mul_f32 v84, v84, v86
    v_mul_f32 v85, v85, v86
    v_accvgpr_write_b32 a94, v84
    v_accvgpr_write_b32 a95, v85
    v_accvgpr_read_b32 v84, a128
    v_accvgpr_read_b32 v85, a129
    v_mul_f32 v84, v84, v86
    v_mul_f32 v85, v85, v86
    v_accvgpr_write_b32 a128, v84
    v_accvgpr_write_b32 a129, v85
    v_accvgpr_read_b32 v84, a130
    v_accvgpr_read_b32 v85, a131
    v_mul_f32 v84, v84, v86
    v_mul_f32 v85, v85, v86
    v_accvgpr_write_b32 a130, v84
    v_accvgpr_write_b32 a131, v85
    v_accvgpr_read_b32 v84, a132
    v_accvgpr_read_b32 v85, a133
    v_mul_f32 v84, v84, v86
    v_mul_f32 v85, v85, v86
    v_accvgpr_write_b32 a132, v84
    v_accvgpr_write_b32 a133, v85
    v_accvgpr_read_b32 v84, a134
    v_accvgpr_read_b32 v85, a135
    v_mul_f32 v84, v84, v86
    v_mul_f32 v85, v85, v86
    v_accvgpr_write_b32 a134, v84
    v_accvgpr_write_b32 a135, v85
    v_accvgpr_read_b32 v84, a136
    v_accvgpr_read_b32 v85, a137
    v_mul_f32 v84, v84, v86
    v_mul_f32 v85, v85, v86
    v_accvgpr_write_b32 a136, v84
    v_accvgpr_write_b32 a137, v85
    v_accvgpr_read_b32 v84, a138
    v_accvgpr_read_b32 v85, a139
    v_mul_f32 v84, v84, v86
    v_mul_f32 v85, v85, v86
    v_accvgpr_write_b32 a138, v84
    v_accvgpr_write_b32 a139, v85
    v_accvgpr_read_b32 v84, a140
    v_accvgpr_read_b32 v85, a141
    v_mul_f32 v84, v84, v86
    v_mul_f32 v85, v85, v86
    v_accvgpr_write_b32 a140, v84
    v_accvgpr_write_b32 a141, v85
    v_accvgpr_read_b32 v84, a142
    v_accvgpr_read_b32 v85, a143
    v_mul_f32 v84, v84, v86
    v_mul_f32 v85, v85, v86
    v_accvgpr_write_b32 a142, v84
    v_accvgpr_write_b32 a143, v85
    v_accvgpr_read_b32 v84, a176
    v_accvgpr_read_b32 v85, a177
    v_mul_f32 v84, v84, v86
    v_mul_f32 v85, v85, v86
    v_accvgpr_write_b32 a176, v84
    v_accvgpr_write_b32 a177, v85
    v_accvgpr_read_b32 v84, a178
    v_accvgpr_read_b32 v85, a179
    v_mul_f32 v84, v84, v86
    v_mul_f32 v85, v85, v86
    v_accvgpr_write_b32 a178, v84
    v_accvgpr_write_b32 a179, v85
    v_accvgpr_read_b32 v84, a180
    v_accvgpr_read_b32 v85, a181
    v_mul_f32 v84, v84, v86
    v_mul_f32 v85, v85, v86
    v_accvgpr_write_b32 a180, v84
    v_accvgpr_write_b32 a181, v85
    v_accvgpr_read_b32 v84, a182
    v_accvgpr_read_b32 v85, a183
    v_mul_f32 v84, v84, v86
    v_mul_f32 v85, v85, v86
    v_accvgpr_write_b32 a182, v84
    v_accvgpr_write_b32 a183, v85
    v_accvgpr_read_b32 v84, a184
    v_accvgpr_read_b32 v85, a185
    v_mul_f32 v84, v84, v86
    v_mul_f32 v85, v85, v86
    v_accvgpr_write_b32 a184, v84
    v_accvgpr_write_b32 a185, v85
    v_accvgpr_read_b32 v84, a186
    v_accvgpr_read_b32 v85, a187
    v_mul_f32 v84, v84, v86
    v_mul_f32 v85, v85, v86
    v_accvgpr_write_b32 a186, v84
    v_accvgpr_write_b32 a187, v85
    v_accvgpr_read_b32 v84, a188
    v_accvgpr_read_b32 v85, a189
    v_mul_f32 v84, v84, v86
    v_mul_f32 v85, v85, v86
    v_accvgpr_write_b32 a188, v84
    v_accvgpr_write_b32 a189, v85
    v_accvgpr_read_b32 v84, a190
    v_accvgpr_read_b32 v85, a191
    v_mul_f32 v84, v84, v86
    v_mul_f32 v85, v85, v86
    v_accvgpr_write_b32 a190, v84
    v_accvgpr_write_b32 a191, v85
    s_nop 3
    s_setpc_b64 s[40:41]
.section .rodata,"a"
.p2align 6
.amdhsa_kernel concat_heads__mha_block_cached__gqa_block_cached__near_ridge_kernel
  .amdhsa_next_free_vgpr 512
  .amdhsa_next_free_sgpr 102
  .amdhsa_accum_offset 256
  .amdhsa_group_segment_fixed_size 0
  .amdhsa_kernarg_size 104
  .amdhsa_user_sgpr_count 2
  .amdhsa_user_sgpr_kernarg_segment_ptr 1
  .amdhsa_system_sgpr_workgroup_id_x 1
.end_amdhsa_kernel
```
